```python
import torch

def _softmax(x, axis=-1):
    return torch.softmax(x, dim=axis)
def _gelu(x):
    return torch.nn.functional.gelu(x, approximate="tanh")
def _silu(x):
    return torch.nn.functional.silu(x)
def _sigmoid(x):
    return torch.sigmoid(x)
def _layernorm(x, axis=-1, eps=1e-5):
    m = x.mean(dim=axis, keepdim=True)
    v = x.var(dim=axis, keepdim=True, unbiased=False)
    return (x - m) / torch.sqrt(v + eps)
def _scatter_add(tgt, idx, src, axis=0):
    return tgt.clone().index_add_(axis, idx, src)
def _segment_sum(src, seg, n):
    out = torch.zeros((n,) + src.shape[1:], dtype=src.dtype)
    return out.index_add_(0, seg, src)
def _pad(x, pw):
    flat = tuple(v for pair in reversed(pw) for v in pair)
    return torch.nn.functional.pad(x, flat)

kernel_name = 'sequential_preLN__sliding_local_dilated__glu_gated_reglu__prompt'

def setup_inputs():

    _w = (lambda a: (lambda t: t.to(torch.bfloat16) if t.is_floating_point() else t)(torch.as_tensor(a)))
    def _A_setup():
        B, S, D = 1, 2048, 448
        return {
            "x": _w((lambda *s: torch.randn(*s, dtype=torch.bfloat16) * 0.05)(B, S, D)),
            "wqkv": _w((lambda *s: torch.randn(*s, dtype=torch.bfloat16) * 0.05)(D, 3 * D)),
            "wo": _w((lambda *s: torch.randn(*s, dtype=torch.bfloat16) * 0.05)(D, D)),
        }
    _A_in = _A_setup()

    def _B_setup():
        B, S, D, F = 1, 2048, 448, 1792
        return {
            "x": _w((lambda *s: torch.randn(*s, dtype=torch.bfloat16) * 0.05)(B, S, D)),
            "W_gate": _w((lambda *s: torch.randn(*s, dtype=torch.bfloat16) * 0.8)(D, F) * (2.0 / D) ** 0.5),
            "W_up": _w((lambda *s: torch.randn(*s, dtype=torch.bfloat16) * 0.8)(D, F) * (2.0 / D) ** 0.5),
            "W_down": _w((lambda *s: torch.randn(*s, dtype=torch.bfloat16) * 0.8)(F, D) * (1.0 / F) ** 0.5),
        }
    _B_in = _B_setup()

    return {
        "A_x": _A_in["x"],
        "A_wqkv": _A_in["wqkv"],
        "A_wo": _A_in["wo"],
        "B_x": _B_in["x"],
        "B_W_gate": _B_in["W_gate"],
        "B_W_up": _B_in["W_up"],
        "B_W_down": _B_in["W_down"],
    }

def reference(A_x, A_wqkv, A_wo, B_x, B_W_gate, B_W_up, B_W_down):
    def _A_ref(x, wqkv, wo):
        B, S, D = x.shape
        H = 16; Dh = D // H
        W, dil = 8, 2
        qkv = (lambda x, *d: x.permute(*d))((x @ wqkv).reshape(B, S, 3, H, Dh), 2, 0, 3, 1, 4)
        q, k, v = qkv[0], qkv[1], qkv[2]
        scale = Dh ** -0.5
        pos = torch.arange(S)
        off = torch.arange(W) * dil
        idx = pos[:, None] - off[None, :]
        mask = idx >= 0
        idx_c = torch.where(mask, idx, 0).reshape(-1)
        kg = k[:, :, idx_c, :].reshape(B, H, S, W, Dh)
        vg = v[:, :, idx_c, :].reshape(B, H, S, W, Dh)
        logits = torch.einsum("bhsd,bhswd->bhsw", q, kg) * scale
        logits = torch.where(mask[None, None, :, :], logits, -1e9)
        attn = _softmax(logits, axis=-1)
        o = torch.einsum("bhsw,bhswd->bhsd", attn, vg)
        return (lambda x, *d: x.permute(*d))(o, 0, 2, 1, 3).reshape(B, S, D) @ wo

    def _B_ref(x, W_gate, W_up, W_down):
        gate = torch.einsum("bsd,df->bsf", x, W_gate)
        up = torch.einsum("bsd,df->bsf", x, W_up)
        gate = gate * (lambda x, dt: x.to(dt))(gate > 0, gate.dtype)
        h = gate * up
        return torch.einsum("bsf,fd->bsd", h, W_down)

    x = A_x
    h = x + _A_ref(_layernorm(x, axis=-1), A_wqkv, A_wo)
    h2 = h + _B_ref(_layernorm(h, axis=-1), B_W_gate, B_W_up, B_W_down)
    return h2
```

```asm
; @launch grid=(256,1,1) block=(256,1,1) lds=163840
.amdgcn_target "amdgcn-amd-amdhsa--gfx950"
.text
.globl sequential_preLN__sliding_local_dilated__glu_gated_reglu__prompt_kernel
.p2align 8
.type sequential_preLN__sliding_local_dilated__glu_gated_reglu__prompt_kernel,@function
sequential_preLN__sliding_local_dilated__glu_gated_reglu__prompt_kernel:
    s_load_dwordx16 s[64:79], s[0:1], 0
    s_load_dwordx4 s[80:83], s[0:1], 64
    s_memrealtime s[84:85]
    s_cmp_ge_u32 s2, 256
    s_cbranch_scc1 L_end
    s_getpc_b64 s[52:53]
L_pc0:
    s_lshr_b32 s41, s2, 3
    v_lshrrev_b32 v1, 4, v0
    v_lshl_add_u32 v1, s41, 4, v1
    v_lshlrev_b32_e64 v1, 7, v1
    v_min_u32 v1, L_end-L_pc0, v1
    global_load_dword a255, v1, s[52:53]
    v_lshrrev_b32_e64 v1, 6, v0
    v_and_b32 v0, 63, v0
    s_and_b32 s40, s2, 7
    s_min_u32 s50, s41, 27
    s_mul_i32 s43, s50, 37
    v_readfirstlane_b32 s42, v1
    s_lshr_b32 s43, s43, 8
    s_mul_i32 s44, s43, 7
    s_sub_u32 s44, s50, s44
    s_mov_b32 s10, 1835008
    s_mov_b32 s11, 0x20000
    v_lshrrev_b32 v2, 2, v0
    v_and_b32 v3, 3, v0
    v_mul_u32_u24 v172, 1792, v2
    v_lshl_add_u32 v172, v3, 4, v172
    v_and_b32_e64 v155, 1, v2
    v_lshl_add_u32 v154, v155, 6, v172
    v_xor_b32_e64 v155, 64, v154
    s_lshl_b32 s50, s40, 2
    s_add_u32 s50, s50, s43
    s_lshl_b32 s50, s50, 6
    s_lshr_b32 s51, s42, 1
    s_lshl_b32 s51, s51, 5
    s_add_u32 s50, s50, s51
    s_and_b32 s51, s42, 1
    s_add_u32 s50, s50, s51
    s_mul_i32 s86, s50, 896
    s_lshl_b32 s50, s43, 1
    s_add_u32 s50, s50, s40
    s_add_u32 s50, s50, s44
    s_mul_i32 s51, s50, 37
    s_lshr_b32 s51, s51, 8
    s_mul_i32 s51, s51, 7
    s_sub_u32 s87, s50, s51
    v_lshrrev_b32 v173, 3, v0
    v_and_b32 v166, 7, v0
    v_and_b32 v167, 4, v2
    v_xor_b32_e64 v166, v166, v167
    v_mul_u32_u24 v173, 2688, v173
    v_lshl_add_u32 v173, v166, 4, v173
    v_add_u32 v174, 20480, v173
    v_lshrrev_b32_e64 v166, 5, v0
    v_mul_u32_u24 v166, 1024, v166
    v_and_b32_e64 v167, 3, v2
    v_lshl_add_u32 v166, v167, 7, v166
    v_lshrrev_b32_e64 v167, 1, v167
    v_lshl_add_u32 v166, v167, 6, v166
    v_bfe_u32 v167, v0, 4, 1
    v_lshl_add_u32 v166, v167, 5, v166
    v_bfrev_b32 v167, v3
    v_lshrrev_b32 v167, 27, v167
    v_add_u32 v195, v167, v166
    s_and_b32 s50, s42, 1
    s_lshl_b32 s50, s50, 6
    v_xor_b32 v195, s50, v195
    v_add_u32 v196, 49152, v195
    v_lshrrev_b32 v166, 1, v2
    v_xor_b32 v166, v3, v166
    v_and_b32 v167, 4, v0
    v_xor_b32 v166, v166, v167
    v_lshlrev_b32 v166, 4, v166
    v_lshl_add_u32 v156, v2, 7, v166
    s_lshl_b32 s50, s42, 11
    s_add_u32 s50, s50, 106496
    v_add_u32 v156, s50, v156
    v_xor_b32 v157, 64, v156
    v_and_b32_e64 v166, 31, v0
    v_bfe_u32 v167, v0, 1, 3
    v_lshrrev_b32 v165, 5, v0
    v_xor_b32 v167, v167, v165
    v_lshlrev_b32_e64 v167, 4, v167
    v_lshl_add_u32 v197, v166, 7, v167
    s_lshr_b32 s50, s42, 1
    s_lshl_b32 s50, s50, 12
    s_add_u32 s50, s50, 106496
    v_add_u32 v197, s50, v197
    v_and_b32 v166, 7, v0
    v_xor_b32 v167, v166, v165
    v_lshlrev_b32 v167, 4, v167
    v_lshl_add_u32 v167, v166, 8, v167
    v_bfe_u32 v165, v0, 4, 1
    v_lshl_add_u32 v201, v165, 7, v167
    v_add_u32 v201, 73728, v201
    v_xor_b32 v198, 32, v197
    v_xor_b32 v202, 32, v201
    v_xor_b32 v199, 64, v197
    v_xor_b32 v203, 64, v201
    v_xor_b32 v200, 96, v197
    v_xor_b32 v212, 96, v201
    s_lshl_b32 s50, s42, 2
    v_lshrrev_b32 v164, 4, v0
    v_add_u32 v164, s50, v164
    v_lshrrev_b32 v165, 1, v164
    v_xor_b32 v165, v0, v165
    v_and_b32 v165, 7, v165
    v_lshlrev_b32_e64 v165, 4, v165
    v_lshl_add_u32 v164, v164, 7, v165
    v_bfe_u32 v165, v0, 3, 1
    v_lshl_add_u32 v164, v165, 11, v164
    v_add_u32 v235, 73728, v164
    v_mov_b32 v148, 0x3f803f80
    v_mov_b32 v144, 0
    v_mov_b32 v145, 0
    v_mov_b32 v149, 0
    v_mov_b32 v150, 0
    s_lshl_b32 s50, s41, 1
    s_and_b32 s51, s42, 1
    s_add_u32 s50, s50, s51
    s_mul_i32 s51, s40, 56
    s_add_u32 s51, s51, s50
    s_mul_i32 s51, s51, 10
    s_add_u32 s51, s51, 1760
    s_lshl_b32 s50, s50, 5
    v_mov_b32 v164, s50
    v_mov_b32 v165, s51
    v_cmp_gt_u32 vcc, 32, v0
    s_nop 1
    v_cndmask_b32 v164, v165, v164, vcc
    v_min_u32_e64 v165, 41, v0
    v_add_lshl_u32 v159, v165, v164, 8
    s_waitcnt lgkmcnt(0)
    s_mov_b32 s8, s64
    s_mov_b32 s9, s65
    s_cmp_ge_u32 s41, 28
    s_cbranch_scc1 L_serv
    s_add_u32 s50, s87, 0
    s_sub_u32 s51, s50, 7
    s_min_u32 s50, s50, s51
    s_lshl_b32 s50, s50, 7
    s_add_u32 s50, s50, s86
    buffer_load_dwordx4 v[16:19], v154, s[8:11], s50 offen
    buffer_load_dwordx4 v[20:23], v155, s[8:11], s50 offen
    s_add_u32 s50, s87, 1
    s_sub_u32 s51, s50, 7
    s_min_u32 s50, s50, s51
    s_lshl_b32 s50, s50, 7
    s_add_u32 s50, s50, s86
    buffer_load_dwordx4 v[24:27], v154, s[8:11], s50 offen
    buffer_load_dwordx4 v[28:31], v155, s[8:11], s50 offen
    s_cmp_lg_u32 s43, 0
    s_cbranch_scc1 L_1
    s_lshl_b32 s50, s40, 8
    s_sub_u32 s50, s50, 16
    s_lshl_b32 s51, s42, 2
    s_add_u32 s50, s50, s51
    v_lshrrev_b32 v12, 4, v0
    v_add_u32 v12, s50, v12
    v_max_i32 v12, 0, v12
    v_mul_u32_u24 v12, 896, v12
    v_and_b32_e64 v13, 7, v0
    v_lshl_add_u32 v12, v13, 4, v12
    v_bfe_u32 v13, v0, 3, 1
    v_add_u32 v13, s87, v13
    v_add_u32 v14, 0, v13
    v_subrev_u32 v15, 7, v14
    v_min_u32 v14, v14, v15
    v_lshl_add_u32 v14, v14, 7, v12
    buffer_load_dwordx4 v[72:75], v14, s[8:11], 0 offen
    v_add_u32 v14, 2, v13
    v_subrev_u32 v15, 7, v14
    v_min_u32_e64 v14, v14, v15
    v_lshl_add_u32 v14, v14, 7, v12
    buffer_load_dwordx4 v[76:79], v14, s[8:11], 0 offen
    v_add_u32 v14, 4, v13
    v_subrev_u32 v15, 7, v14
    v_min_u32_e64 v14, v14, v15
    v_lshl_add_u32 v14, v14, 7, v12
    buffer_load_dwordx4 v[80:83], v14, s[8:11], 0 offen
    v_add_u32 v14, 6, v13
    v_subrev_u32 v15, 7, v14
    v_min_u32_e64 v14, v14, v15
    v_lshl_add_u32 v14, v14, 7, v12
    v_and_b32_e64 v15, 8, v0
    v_lshl_add_u32 v14, v15, 24, v14
    buffer_load_dwordx4 v[84:87], v14, s[8:11], 0 offen
L_1:
    s_mov_b32 s14, 1204224
    s_mov_b32 s15, 0x20000
    s_mov_b32 s18, 401408
    s_mov_b32 s19, 0x20000
    s_mov_b32 s22, 1605632
    s_mov_b32 s23, 0x20000
    s_mov_b32 s26, 1605632
    s_mov_b32 s27, 0x20000
    s_mov_b32 s30, 1835008
    s_mov_b32 s31, 0x20000
    s_mov_b32 s34, 4194304
    s_mov_b32 s35, 0x20000
    s_mov_b32 s38, 256
    s_mov_b32 s39, 0x20000
    s_mov_b32 s12, s66
    s_mov_b32 s13, s67
    s_mov_b32 s16, s68
    s_mov_b32 s17, s69
    s_mov_b32 s24, s76
    s_mov_b32 s25, s77
    s_mov_b32 s28, s78
    s_mov_b32 s29, s79
    s_mov_b32 s36, s80
    s_mov_b32 s37, s81
    s_cmp_lt_u32 s42, 2
    s_cselect_b32 s20, s72, s74
    s_cselect_b32 s21, s73, s75
    s_lshl_b32 s50, s40, 23
    s_add_u32 s32, s82, s50
    s_addc_u32 s33, s83, 0
    s_getreg_b32 s48, hwreg(HW_REG_XCC_ID, 0, 3)
    v_lshlrev_b32 v253, 4, v0
    s_mov_b32 s61, 0xffff0000
    s_lshl_b32 s89, s42, 13
    s_lshl_b32 s49, s40, 5
    s_mul_i32 s78, s42, 43008
    s_lshl_b32 s50, s44, 7
    s_add_u32 s78, s78, s50
    s_lshl_b32 s79, s42, 11
    s_add_u32 s50, s87, 0
    s_sub_u32 s51, s50, 7
    s_min_u32 s50, s50, s51
    s_mul_i32 s71, s50, 172032
    s_add_u32 s71, s71, s78
    s_add_u32 s50, s87, 1
    s_sub_u32 s51, s50, 7
    s_min_u32 s50, s50, s51
    s_mul_i32 s72, s50, 172032
    s_add_u32 s72, s72, s78
    s_add_u32 s50, s87, 2
    s_sub_u32 s51, s50, 7
    s_min_u32 s50, s50, s51
    s_mul_i32 s73, s50, 172032
    s_add_u32 s73, s73, s78
    s_add_u32 s50, s87, 3
    s_sub_u32 s51, s50, 7
    s_min_u32 s50, s50, s51
    s_mul_i32 s74, s50, 172032
    s_add_u32 s74, s74, s78
    s_add_u32 s50, s87, 4
    s_sub_u32 s51, s50, 7
    s_min_u32 s50, s50, s51
    s_mul_i32 s75, s50, 172032
    s_add_u32 s75, s75, s78
    s_add_u32 s50, s87, 5
    s_sub_u32 s51, s50, 7
    s_min_u32 s50, s50, s51
    s_mul_i32 s76, s50, 172032
    s_add_u32 s76, s76, s78
    s_add_u32 s50, s87, 6
    s_sub_u32 s51, s50, 7
    s_min_u32 s50, s50, s51
    s_mul_i32 s77, s50, 172032
    s_add_u32 s77, s77, s78
    v_and_b32 v193, 7, v0
    v_lshlrev_b32_e64 v193, 2, v193
    s_lshr_b32 s54, s41, 3
    s_bfe_u32 s50, s41, 0x10002
    s_and_b32 s55, s41, 3
    s_lshl_b32 s55, s55, 2
    s_add_u32 s55, s55, s42
    s_lshl_b32 s51, s54, 2
    s_add_u32 s51, s51, s50
    s_mul_i32 s51, s51, 14336
    s_mul_i32 s50, s55, 896
    s_add_u32 s50, s50, s51
    s_and_b32 s56, s42, 1
    s_lshl_b32 s56, s56, 7
    s_add_u32 s97, s50, 65536
    s_add_u32 s98, s50, 94208
    s_sub_u32 s50, s50, s56
    s_add_u32 s91, s50, 65536
    s_add_u32 s93, s50, 294912
    s_add_u32 s95, s51, 557056
    s_add_u32 s92, s50, 94208
    s_add_u32 s94, s50, 323584
    s_add_u32 s96, s51, 585728
    s_mul_i32 s52, s55, 28
    s_add_u32 s51, s52, 27
    s_lshr_b32 s50, s52, 5
    s_lshr_b32 s51, s51, 5
    s_sub_u32 s51, s51, s50
    s_lshl_b32 s53, s54, 1
    s_sub_u32 s53, s53, 1
    v_min_u32 v176, 2, v3
    v_add_u32 v176, s53, v176
    v_max_i32 v176, 0, v176
    v_lshlrev_b32 v176, 7, v176
    v_and_b32 v160, 1, v2
    v_mul_u32_u24 v160, s51, v160
    v_add_u32 v160, s50, v160
    v_lshl_add_u32 v176, v160, 2, v176
    v_and_b32_e64 v160, 15, v0
    v_bfe_u32 v163, v0, 4, 1
    v_lshrrev_b32_e64 v161, 5, v0
    v_bfe_u32 v162, v0, 3, 1
    v_mul_u32_u24 v162, 28672, v162
    v_and_b32_e64 v177, 0x37, v0
    v_lshl_add_u32 v177, v177, 4, v162
    v_mul_u32_u24 v162, 28672, v161
    v_lshl_add_u32 v162, v163, 9, v162
    v_add_u32 v164, 0, v160
    v_min_u32 v164, 27, v164
    v_add_u32 v164, s52, v164
    v_lshrrev_b32 v165, 5, v164
    v_and_b32_e64 v164, 31, v164
    v_lshl_add_u32 v164, v164, 4, v162
    v_lshl_add_u32 v178, v165, 10, v164
    v_add_u32 v164, 16, v160
    v_min_u32 v164, 27, v164
    v_add_u32 v164, s52, v164
    v_lshrrev_b32 v165, 5, v164
    v_and_b32_e64 v164, 31, v164
    v_lshl_add_u32 v164, v164, 4, v162
    v_lshl_add_u32 v179, v165, 10, v164
    s_mov_b32 s0, -1
    s_mov_b32 s1, 0xffff
    s_cmp_eq_u32 s56, 0
    s_cselect_b32 s2, -1, 0xffff0000
    s_cselect_b32 s5, 0xffff, -1
    s_mov_b32 s3, -1
    s_mov_b32 s4, -1
    v_add_u32 v164, 752896, v253
    v_add_u32 v165, 128, v253
    v_cndmask_b32 v181, v164, v253, s[0:1]
    v_cndmask_b32 v182, v164, v165, s[0:1]
    v_add_u32_e64 v165, s56, v253
    v_cndmask_b32 v180, v164, v165, s[0:1]
    v_subrev_u32 v165, 256, v253
    v_cndmask_b32 v183, v165, v253, s[0:1]
    s_lshr_b32 s7, s41, 2
    s_lshl_b32 s7, s7, 7
    s_lshl_b32 s50, s55, 2
    s_add_u32 s7, s7, s50
    s_add_u32 s7, s7, 2048
    v_lshlrev_b32 v164, 2, v163
    v_sub_u32 v164, v160, v164
    v_xor_b32 v165, 1, v161
    v_lshl_add_u32 v164, v165, 4, v164
    s_or_b32 s50, s40, s54
    s_cmp_eq_u32 s50, 0
    s_cselect_b32 s50, 64, 0
    v_mad_u32_u24 v165, v165, s50, v164
    v_mov_b32 v162, 0xf149f2ca
    v_subrev_u32_e64 v166, 0, v164
    v_subrev_u32 v167, 0, v165
    v_cmp_lt_u32 vcc, 7, v166
    v_cmp_lt_u32 s[52:53], 7, v167
    s_nop 0
    v_cndmask_b32 v216, 0, v162, vcc
    v_cndmask_b32 v224, 0, v162, s[52:53]
    v_subrev_u32_e64 v166, 1, v164
    v_subrev_u32 v167, 1, v165
    v_cmp_lt_u32 vcc, 7, v166
    v_cmp_lt_u32 s[52:53], 7, v167
    s_nop 0
    v_cndmask_b32 v217, 0, v162, vcc
    v_cndmask_b32 v225, 0, v162, s[52:53]
    v_subrev_u32_e64 v166, 2, v164
    v_subrev_u32 v167, 2, v165
    v_cmp_lt_u32 vcc, 7, v166
    v_cmp_lt_u32 s[52:53], 7, v167
    s_nop 0
    v_cndmask_b32 v218, 0, v162, vcc
    v_cndmask_b32 v226, 0, v162, s[52:53]
    v_subrev_u32_e64 v166, 3, v164
    v_subrev_u32 v167, 3, v165
    v_cmp_lt_u32 vcc, 7, v166
    v_cmp_lt_u32 s[52:53], 7, v167
    s_nop 0
    v_cndmask_b32 v219, 0, v162, vcc
    v_cndmask_b32 v227, 0, v162, s[52:53]
    v_subrev_u32_e64 v166, 8, v164
    v_subrev_u32 v167, 8, v165
    v_cmp_lt_u32 vcc, 7, v166
    v_cmp_lt_u32 s[52:53], 7, v167
    s_nop 0
    v_cndmask_b32 v220, 0, v162, vcc
    v_cndmask_b32 v228, 0, v162, s[52:53]
    v_subrev_u32_e64 v166, 9, v164
    v_subrev_u32 v167, 9, v165
    v_cmp_lt_u32 vcc, 7, v166
    v_cmp_lt_u32 s[52:53], 7, v167
    s_nop 0
    v_cndmask_b32 v221, 0, v162, vcc
    v_cndmask_b32 v229, 0, v162, s[52:53]
    v_subrev_u32_e64 v166, 10, v164
    v_subrev_u32 v167, 10, v165
    v_cmp_lt_u32 vcc, 7, v166
    v_cmp_lt_u32 s[52:53], 7, v167
    s_nop 0
    v_cndmask_b32 v222, 0, v162, vcc
    v_cndmask_b32 v230, 0, v162, s[52:53]
    v_subrev_u32_e64 v166, 11, v164
    v_subrev_u32 v167, 11, v165
    v_cmp_lt_u32 vcc, 7, v166
    v_cmp_lt_u32 s[52:53], 7, v167
    s_nop 0
    v_cndmask_b32 v223, 0, v162, vcc
    v_cndmask_b32 v231, 0, v162, s[52:53]
    v_lshrrev_b32 v164, 1, v2
    v_and_b32 v164, 3, v164
    v_lshlrev_b32_e64 v164, 5, v164
    v_lshl_add_u32 v164, v2, 7, v164
    v_lshl_add_u32 v184, v3, 3, v164
    v_add_u32 v184, 106496, v184
    v_add_u32 v164, 2048, v184
    v_add_u32 v165, 1536, v184
    v_xor_b32_e64 v165, 64, v165
    v_cndmask_b32 v188, v165, v164, s[0:1]
    v_xor_b32 v185, 32, v184
    v_xor_b32 v189, 32, v188
    v_xor_b32 v186, 64, v184
    v_xor_b32 v190, 64, v188
    v_xor_b32 v187, 96, v184
    v_xor_b32 v191, 96, v188
    v_lshrrev_b32 v14, 3, v0
    v_and_b32 v15, 6, v14
    v_xor_b32 v15, v0, v15
    v_and_b32 v15, 7, v15
    v_mul_u32_u24 v14, 3584, v14
    v_lshl_add_u32 v240, v15, 4, v14
    v_add_u32 v241, 27648, v240
    v_add_u32 v242, 55296, v240
    v_add_u32 v243, 82944, v240
    s_min_u32 s50, s41, 27
    s_cmp_ge_u32 s50, 14
    s_cselect_b32 s57, 4, 0
    s_cselect_b32 s51, 14, 0
    s_sub_u32 s58, s50, s51
    s_add_u32 s57, s57, s42
    s_lshl_b32 s88, s58, 8
    s_and_b32 s50, s42, 1
    s_mul_i32 s51, s50, 114688
    s_add_u32 s88, s88, s51
    v_mul_u32_u24 v164, 14336, v163
    v_lshl_add_u32 v164, v161, 8, v164
    v_lshl_add_u32 v254, v160, 4, v164
    s_add_u32 s50, s87, 2
    s_sub_u32 s51, s50, 7
    s_min_u32 s50, s50, s51
    s_lshl_b32 s50, s50, 7
    s_add_u32 s50, s50, s86
    buffer_load_dwordx4 v[32:35], v154, s[8:11], s50 offen
    buffer_load_dwordx4 v[36:39], v155, s[8:11], s50 offen
    s_add_u32 s50, s87, 3
    s_sub_u32 s51, s50, 7
    s_min_u32 s50, s50, s51
    s_lshl_b32 s50, s50, 7
    s_add_u32 s50, s50, s86
    buffer_load_dwordx4 v[40:43], v154, s[8:11], s50 offen
    buffer_load_dwordx4 v[44:47], v155, s[8:11], s50 offen
    s_add_u32 s50, s87, 4
    s_sub_u32 s51, s50, 7
    s_min_u32 s50, s50, s51
    s_lshl_b32 s50, s50, 7
    s_add_u32 s50, s50, s86
    buffer_load_dwordx4 v[48:51], v154, s[8:11], s50 offen
    buffer_load_dwordx4 v[52:55], v155, s[8:11], s50 offen
    s_add_u32 s50, s87, 5
    s_sub_u32 s51, s50, 7
    s_min_u32 s50, s50, s51
    s_lshl_b32 s50, s50, 7
    s_add_u32 s50, s50, s86
    buffer_load_dwordx4 v[56:59], v154, s[8:11], s50 offen
    buffer_load_dwordx4 v[60:63], v155, s[8:11], s50 offen
    s_add_u32 s50, s87, 6
    s_sub_u32 s51, s50, 7
    s_min_u32 s50, s50, s51
    s_lshl_b32 s50, s50, 7
    s_add_u32 s50, s50, s86
    buffer_load_dwordx4 v[64:67], v154, s[8:11], s50 offen
    buffer_load_dwordx4 v[68:71], v155, s[8:11], s50 offen
    s_lshl_b32 s53, s43, 1
    s_lshr_b32 s51, s42, 1
    s_add_u32 s53, s53, s51
    s_and_b32 s51, s42, 1
    s_lshl_b32 s50, s44, 1
    s_add_u32 s50, s50, s51
    s_mul_i32 s82, s53, 28672
    s_lshl_b32 s52, s50, 10
    s_add_u32 s82, s82, s52
    s_lshl_b32 s6, s53, 5
    s_add_u32 s6, s6, s50
    s_lshl_b32 s6, s6, 2
    s_mov_b32 s81, s53
    v_and_b32 v14, 3, v2
    v_bfrev_b32 v14, v14
    v_lshrrev_b32 v14, 28, v14
    v_and_b32 v15, 0x33, v0
    v_or_b32 v14, v14, v15
    v_lshlrev_b32 v175, 4, v14
    v_lshrrev_b32 v14, 3, v0
    v_and_b32 v15, 7, v0
    v_and_b32 v164, 6, v14
    v_xor_b32 v15, v15, v164
    v_mul_u32_u24 v14, 896, v14
    v_lshl_add_u32 v192, v15, 4, v14
    s_mul_i32 s83, s42, 7168
    s_lshl_b32 s50, s44, 7
    s_add_u32 s83, s83, s50
    s_lshl_b32 s85, s42, 10
    s_add_u32 m0, s79, 7296
    s_nop 0
    buffer_load_dwordx4 v173, s[12:15], s71 offen offset:896 lds
    buffer_load_dwordx4 v174, s[12:15], s71 offen offset:1920 lds
    s_add_u32 m0, s79, 14592
    s_nop 0
    buffer_load_dwordx4 v173, s[12:15], s71 offen offset:1792 lds
    buffer_load_dwordx4 v174, s[12:15], s71 offen offset:2816 lds
    s_add_u32 m0, s79, 0
    s_nop 0
    buffer_load_dwordx4 v173, s[12:15], s71 offen offset:0 lds
    buffer_load_dwordx4 v174, s[12:15], s71 offen offset:1024 lds
    s_cmp_lg_u32 s43, 0
    s_cbranch_scc1 L_2
    s_waitcnt vmcnt(16)
    v_dot2c_f32_bf16 v149, v72, v148
    v_dot2c_f32_bf16 v150, v72, v72
    v_dot2c_f32_bf16 v149, v73, v148
    v_dot2c_f32_bf16 v150, v73, v73
    v_dot2c_f32_bf16 v149, v74, v148
    v_dot2c_f32_bf16 v150, v74, v74
    v_dot2c_f32_bf16 v149, v75, v148
    v_dot2c_f32_bf16 v150, v75, v75
    v_dot2c_f32_bf16 v149, v76, v148
    v_dot2c_f32_bf16 v150, v76, v76
    v_dot2c_f32_bf16 v149, v77, v148
    v_dot2c_f32_bf16 v150, v77, v77
    v_dot2c_f32_bf16 v149, v78, v148
    v_dot2c_f32_bf16 v150, v78, v78
    v_dot2c_f32_bf16 v149, v79, v148
    v_dot2c_f32_bf16 v150, v79, v79
    v_dot2c_f32_bf16 v149, v80, v148
    v_dot2c_f32_bf16 v150, v80, v80
    v_dot2c_f32_bf16 v149, v81, v148
    v_dot2c_f32_bf16 v150, v81, v81
    v_dot2c_f32_bf16 v149, v82, v148
    v_dot2c_f32_bf16 v150, v82, v82
    v_dot2c_f32_bf16 v149, v83, v148
    v_dot2c_f32_bf16 v150, v83, v83
    v_dot2c_f32_bf16 v149, v84, v148
    v_dot2c_f32_bf16 v150, v84, v84
    v_dot2c_f32_bf16 v149, v85, v148
    v_dot2c_f32_bf16 v150, v85, v85
    v_dot2c_f32_bf16 v149, v86, v148
    v_dot2c_f32_bf16 v150, v86, v86
    v_dot2c_f32_bf16 v149, v87, v148
    v_dot2c_f32_bf16 v150, v87, v87
L_2:
    s_waitcnt vmcnt(19)
    v_dot2c_f32_bf16 v144, v16, v148
    v_dot2c_f32_bf16 v145, v16, v16
    v_dot2c_f32_bf16 v144, v17, v148
    v_dot2c_f32_bf16 v145, v17, v17
    v_dot2c_f32_bf16 v144, v18, v148
    v_dot2c_f32_bf16 v145, v18, v18
    v_dot2c_f32_bf16 v144, v19, v148
    v_dot2c_f32_bf16 v145, v19, v19
    s_waitcnt vmcnt(18)
    v_dot2c_f32_bf16 v144, v20, v148
    v_dot2c_f32_bf16 v145, v20, v20
    v_dot2c_f32_bf16 v144, v21, v148
    v_dot2c_f32_bf16 v145, v21, v21
    v_dot2c_f32_bf16 v144, v22, v148
    v_dot2c_f32_bf16 v145, v22, v22
    v_dot2c_f32_bf16 v144, v23, v148
    v_dot2c_f32_bf16 v145, v23, v23
    s_waitcnt vmcnt(17)
    v_dot2c_f32_bf16 v144, v24, v148
    v_dot2c_f32_bf16 v145, v24, v24
    v_dot2c_f32_bf16 v144, v25, v148
    v_dot2c_f32_bf16 v145, v25, v25
    v_dot2c_f32_bf16 v144, v26, v148
    v_dot2c_f32_bf16 v145, v26, v26
    v_dot2c_f32_bf16 v144, v27, v148
    v_dot2c_f32_bf16 v145, v27, v27
    s_waitcnt vmcnt(16)
    v_dot2c_f32_bf16 v144, v28, v148
    v_dot2c_f32_bf16 v145, v28, v28
    v_dot2c_f32_bf16 v144, v29, v148
    v_dot2c_f32_bf16 v145, v29, v29
    v_dot2c_f32_bf16 v144, v30, v148
    v_dot2c_f32_bf16 v145, v30, v30
    v_dot2c_f32_bf16 v144, v31, v148
    v_dot2c_f32_bf16 v145, v31, v31
    s_waitcnt vmcnt(15)
    v_dot2c_f32_bf16 v144, v32, v148
    v_dot2c_f32_bf16 v145, v32, v32
    v_dot2c_f32_bf16 v144, v33, v148
    v_dot2c_f32_bf16 v145, v33, v33
    v_dot2c_f32_bf16 v144, v34, v148
    v_dot2c_f32_bf16 v145, v34, v34
    v_dot2c_f32_bf16 v144, v35, v148
    v_dot2c_f32_bf16 v145, v35, v35
    s_waitcnt vmcnt(14)
    v_dot2c_f32_bf16 v144, v36, v148
    v_dot2c_f32_bf16 v145, v36, v36
    v_dot2c_f32_bf16 v144, v37, v148
    v_dot2c_f32_bf16 v145, v37, v37
    v_dot2c_f32_bf16 v144, v38, v148
    v_dot2c_f32_bf16 v145, v38, v38
    v_dot2c_f32_bf16 v144, v39, v148
    v_dot2c_f32_bf16 v145, v39, v39
    s_waitcnt vmcnt(13)
    v_dot2c_f32_bf16 v144, v40, v148
    v_dot2c_f32_bf16 v145, v40, v40
    v_dot2c_f32_bf16 v144, v41, v148
    v_dot2c_f32_bf16 v145, v41, v41
    v_dot2c_f32_bf16 v144, v42, v148
    v_dot2c_f32_bf16 v145, v42, v42
    v_dot2c_f32_bf16 v144, v43, v148
    v_dot2c_f32_bf16 v145, v43, v43
    s_waitcnt vmcnt(12)
    v_dot2c_f32_bf16 v144, v44, v148
    v_dot2c_f32_bf16 v145, v44, v44
    v_dot2c_f32_bf16 v144, v45, v148
    v_dot2c_f32_bf16 v145, v45, v45
    v_dot2c_f32_bf16 v144, v46, v148
    v_dot2c_f32_bf16 v145, v46, v46
    v_dot2c_f32_bf16 v144, v47, v148
    v_dot2c_f32_bf16 v145, v47, v47
    s_waitcnt vmcnt(11)
    v_dot2c_f32_bf16 v144, v48, v148
    v_dot2c_f32_bf16 v145, v48, v48
    v_dot2c_f32_bf16 v144, v49, v148
    v_dot2c_f32_bf16 v145, v49, v49
    v_dot2c_f32_bf16 v144, v50, v148
    v_dot2c_f32_bf16 v145, v50, v50
    v_dot2c_f32_bf16 v144, v51, v148
    v_dot2c_f32_bf16 v145, v51, v51
    s_waitcnt vmcnt(10)
    v_dot2c_f32_bf16 v144, v52, v148
    v_dot2c_f32_bf16 v145, v52, v52
    v_dot2c_f32_bf16 v144, v53, v148
    v_dot2c_f32_bf16 v145, v53, v53
    v_dot2c_f32_bf16 v144, v54, v148
    v_dot2c_f32_bf16 v145, v54, v54
    v_dot2c_f32_bf16 v144, v55, v148
    v_dot2c_f32_bf16 v145, v55, v55
    s_waitcnt vmcnt(9)
    v_dot2c_f32_bf16 v144, v56, v148
    v_dot2c_f32_bf16 v145, v56, v56
    v_dot2c_f32_bf16 v144, v57, v148
    v_dot2c_f32_bf16 v145, v57, v57
    v_dot2c_f32_bf16 v144, v58, v148
    v_dot2c_f32_bf16 v145, v58, v58
    v_dot2c_f32_bf16 v144, v59, v148
    v_dot2c_f32_bf16 v145, v59, v59
    s_waitcnt vmcnt(8)
    v_dot2c_f32_bf16 v144, v60, v148
    v_dot2c_f32_bf16 v145, v60, v60
    v_dot2c_f32_bf16 v144, v61, v148
    v_dot2c_f32_bf16 v145, v61, v61
    v_dot2c_f32_bf16 v144, v62, v148
    v_dot2c_f32_bf16 v145, v62, v62
    v_dot2c_f32_bf16 v144, v63, v148
    v_dot2c_f32_bf16 v145, v63, v63
    s_waitcnt vmcnt(7)
    v_dot2c_f32_bf16 v144, v64, v148
    v_dot2c_f32_bf16 v145, v64, v64
    v_dot2c_f32_bf16 v144, v65, v148
    v_dot2c_f32_bf16 v145, v65, v65
    v_dot2c_f32_bf16 v144, v66, v148
    v_dot2c_f32_bf16 v145, v66, v66
    v_dot2c_f32_bf16 v144, v67, v148
    v_dot2c_f32_bf16 v145, v67, v67
    s_waitcnt vmcnt(6)
    v_dot2c_f32_bf16 v144, v68, v148
    v_dot2c_f32_bf16 v145, v68, v68
    v_dot2c_f32_bf16 v144, v69, v148
    v_dot2c_f32_bf16 v145, v69, v69
    v_dot2c_f32_bf16 v144, v70, v148
    v_dot2c_f32_bf16 v145, v70, v70
    v_dot2c_f32_bf16 v144, v71, v148
    v_dot2c_f32_bf16 v145, v71, v71
    v_add_f32_dpp v149, v149, v149 row_half_mirror row_mask:0xf bank_mask:0xf
    v_add_f32_dpp v150, v150, v150 row_half_mirror row_mask:0xf bank_mask:0xf
    v_add_f32_dpp v144, v144, v144 quad_perm:[1,0,3,2] row_mask:0xf bank_mask:0xf
    v_add_f32_dpp v145, v145, v145 quad_perm:[1,0,3,2] row_mask:0xf bank_mask:0xf
    v_add_f32_dpp v149, v149, v149 quad_perm:[1,0,3,2] row_mask:0xf bank_mask:0xf
    v_add_f32_dpp v150, v150, v150 quad_perm:[1,0,3,2] row_mask:0xf bank_mask:0xf
    v_add_f32_dpp v144, v144, v144 quad_perm:[2,3,0,1] row_mask:0xf bank_mask:0xf
    v_add_f32_dpp v145, v145, v145 quad_perm:[2,3,0,1] row_mask:0xf bank_mask:0xf
    v_add_f32_dpp v149, v149, v149 quad_perm:[2,3,0,1] row_mask:0xf bank_mask:0xf
    v_add_f32_dpp v150, v150, v150 quad_perm:[2,3,0,1] row_mask:0xf bank_mask:0xf
    s_nop 0
    v_add_f32_dpp v149, v149, v149 row_mirror row_mask:0xf bank_mask:0xf
    v_add_f32_dpp v150, v150, v150 row_mirror row_mask:0xf bank_mask:0xf
    s_cmp_lg_u32 s42, 0
    s_cbranch_scc1 L_3
    s_lshl_b32 s50, s41, 2
    s_lshr_b32 s50, s84, s50
    s_and_b32 s50, s50, 15
    s_cmp_lt_u32 s41, 8
    s_cselect_b32 s50, s50, 0
    s_lshl_b32 s50, s50, 3
    s_or_b32 s54, s50, s48
    s_or_b32 s54, s54, 0x80
    s_add_u32 s51, s49, s41
    s_and_b32 s51, s51, 0xfc
    s_and_b32 s50, s41, 3
    s_lshl_b32 s50, s50, 3
    s_lshl_b32 s50, s54, s50
    v_mov_b32_e64 v252, s50
    s_mov_b64 exec, 1
    buffer_atomic_or v252, off, s[36:39], s51 sc1
    s_mov_b64 exec, -1
L_3:
    v_mul_f32 v144, 0x3b124925, v144
    v_mul_f32 v149, 0x3b124925, v149
    v_mul_f32 v145, 0x3b124925, v145
    v_mul_f32 v150, 0x3b124925, v150
    v_fma_f32 v145, -v144, v144, v145
    v_fma_f32 v150, -v149, v149, v150
    v_max_f32 v145, 0, v145
    v_max_f32 v150, 0, v150
    v_cvt_pk_bf16_f32 v145, v145, v145
    v_cvt_pk_bf16_f32 v150, v150, v150
    v_and_b32 v145, s61, v145
    v_and_b32 v150, s61, v150
    v_add_f32 v145, 0x3727c5ac, v145
    v_add_f32 v150, 0x3727c5ac, v150
    v_cvt_pk_bf16_f32 v145, v145, v145
    v_cvt_pk_bf16_f32 v150, v150, v150
    v_and_b32 v145, s61, v145
    v_and_b32 v150, s61, v150
    v_sqrt_f32 v145, v145
    v_sqrt_f32 v150, v150
    v_cvt_pk_bf16_f32 v144, v144, v144
    v_cvt_pk_bf16_f32 v149, v149, v149
    v_and_b32 v144, s61, v144
    v_and_b32 v149, s61, v149
    v_cvt_pk_bf16_f32 v145, v145, v145
    v_cvt_pk_bf16_f32 v150, v150, v150
    v_and_b32 v145, s61, v145
    v_and_b32 v150, s61, v150
    v_rcp_f32 v146, v145
    v_rcp_f32 v236, v150
    v_mul_f32_e64 v147, -v144, v146
    v_mul_f32_e64 v237, -v149, v236
    s_cmp_lg_u32 s43, 0
    s_cbranch_scc1 L_4
    v_lshlrev_b32 v136, 16, v72
    v_and_b32 v137, s61, v72
    v_lshlrev_b32 v138, 16, v73
    v_and_b32 v139, s61, v73
    v_lshlrev_b32 v140, 16, v74
    v_and_b32 v141, s61, v74
    v_lshlrev_b32 v142, 16, v75
    v_and_b32 v143, s61, v75
    v_pk_fma_f32 v[136:137], v[136:137], v[236:237], v[236:237] op_sel:[0,0,1] op_sel_hi:[1,0,1]
    v_pk_fma_f32 v[138:139], v[138:139], v[236:237], v[236:237] op_sel:[0,0,1] op_sel_hi:[1,0,1]
    v_pk_fma_f32 v[140:141], v[140:141], v[236:237], v[236:237] op_sel:[0,0,1] op_sel_hi:[1,0,1]
    v_pk_fma_f32 v[142:143], v[142:143], v[236:237], v[236:237] op_sel:[0,0,1] op_sel_hi:[1,0,1]
    v_cvt_pk_bf16_f32 v72, v136, v137
    v_cvt_pk_bf16_f32 v73, v138, v139
    v_cvt_pk_bf16_f32 v74, v140, v141
    v_cvt_pk_bf16_f32 v75, v142, v143
    ds_write_b128 v235, v[72:75] offset:0
    v_lshlrev_b32 v136, 16, v76
    v_and_b32 v137, s61, v76
    v_lshlrev_b32 v138, 16, v77
    v_and_b32 v139, s61, v77
    v_lshlrev_b32 v140, 16, v78
    v_and_b32 v141, s61, v78
    v_lshlrev_b32 v142, 16, v79
    v_and_b32 v143, s61, v79
    v_pk_fma_f32 v[136:137], v[136:137], v[236:237], v[236:237] op_sel:[0,0,1] op_sel_hi:[1,0,1]
    v_pk_fma_f32 v[138:139], v[138:139], v[236:237], v[236:237] op_sel:[0,0,1] op_sel_hi:[1,0,1]
    v_pk_fma_f32 v[140:141], v[140:141], v[236:237], v[236:237] op_sel:[0,0,1] op_sel_hi:[1,0,1]
    v_pk_fma_f32 v[142:143], v[142:143], v[236:237], v[236:237] op_sel:[0,0,1] op_sel_hi:[1,0,1]
    v_cvt_pk_bf16_f32 v76, v136, v137
    v_cvt_pk_bf16_f32 v77, v138, v139
    v_cvt_pk_bf16_f32 v78, v140, v141
    v_cvt_pk_bf16_f32 v79, v142, v143
    ds_write_b128 v235, v[76:79] offset:4096
    v_lshlrev_b32 v136, 16, v80
    v_and_b32 v137, s61, v80
    v_lshlrev_b32 v138, 16, v81
    v_and_b32 v139, s61, v81
    v_lshlrev_b32 v140, 16, v82
    v_and_b32 v141, s61, v82
    v_lshlrev_b32 v142, 16, v83
    v_and_b32 v143, s61, v83
    v_pk_fma_f32 v[136:137], v[136:137], v[236:237], v[236:237] op_sel:[0,0,1] op_sel_hi:[1,0,1]
    v_pk_fma_f32 v[138:139], v[138:139], v[236:237], v[236:237] op_sel:[0,0,1] op_sel_hi:[1,0,1]
    v_pk_fma_f32 v[140:141], v[140:141], v[236:237], v[236:237] op_sel:[0,0,1] op_sel_hi:[1,0,1]
    v_pk_fma_f32 v[142:143], v[142:143], v[236:237], v[236:237] op_sel:[0,0,1] op_sel_hi:[1,0,1]
    v_cvt_pk_bf16_f32 v80, v136, v137
    v_cvt_pk_bf16_f32 v81, v138, v139
    v_cvt_pk_bf16_f32 v82, v140, v141
    v_cvt_pk_bf16_f32 v83, v142, v143
    ds_write_b128 v235, v[80:83] offset:8192
    v_lshlrev_b32 v136, 16, v84
    v_and_b32 v137, s61, v84
    v_lshlrev_b32 v138, 16, v85
    v_and_b32 v139, s61, v85
    v_lshlrev_b32 v140, 16, v86
    v_and_b32 v141, s61, v86
    v_lshlrev_b32 v142, 16, v87
    v_and_b32 v143, s61, v87
    v_pk_fma_f32 v[136:137], v[136:137], v[236:237], v[236:237] op_sel:[0,0,1] op_sel_hi:[1,0,1]
    v_pk_fma_f32 v[138:139], v[138:139], v[236:237], v[236:237] op_sel:[0,0,1] op_sel_hi:[1,0,1]
    v_pk_fma_f32 v[140:141], v[140:141], v[236:237], v[236:237] op_sel:[0,0,1] op_sel_hi:[1,0,1]
    v_pk_fma_f32 v[142:143], v[142:143], v[236:237], v[236:237] op_sel:[0,0,1] op_sel_hi:[1,0,1]
    v_cvt_pk_bf16_f32 v84, v136, v137
    v_cvt_pk_bf16_f32 v85, v138, v139
    v_cvt_pk_bf16_f32 v86, v140, v141
    v_cvt_pk_bf16_f32 v87, v142, v143
    ds_write_b128 v235, v[84:87] offset:12288
L_4:
    v_lshlrev_b32 v136, 16, v16
    v_and_b32 v137, s61, v16
    v_lshlrev_b32 v138, 16, v17
    v_and_b32 v139, s61, v17
    v_lshlrev_b32 v140, 16, v18
    v_and_b32 v141, s61, v18
    v_lshlrev_b32 v142, 16, v19
    v_and_b32 v143, s61, v19
    v_pk_fma_f32 v[136:137], v[136:137], v[146:147], v[146:147] op_sel:[0,0,1] op_sel_hi:[1,0,1]
    v_pk_fma_f32 v[138:139], v[138:139], v[146:147], v[146:147] op_sel:[0,0,1] op_sel_hi:[1,0,1]
    v_pk_fma_f32 v[140:141], v[140:141], v[146:147], v[146:147] op_sel:[0,0,1] op_sel_hi:[1,0,1]
    v_pk_fma_f32 v[142:143], v[142:143], v[146:147], v[146:147] op_sel:[0,0,1] op_sel_hi:[1,0,1]
    v_cvt_pk_bf16_f32 v16, v136, v137
    v_cvt_pk_bf16_f32 v17, v138, v139
    v_cvt_pk_bf16_f32 v18, v140, v141
    v_cvt_pk_bf16_f32 v19, v142, v143
    ds_write_b128 v156, v[16:19] offset:0
    v_lshlrev_b32 v136, 16, v20
    v_and_b32 v137, s61, v20
    v_lshlrev_b32 v138, 16, v21
    v_and_b32 v139, s61, v21
    v_lshlrev_b32 v140, 16, v22
    v_and_b32 v141, s61, v22
    v_lshlrev_b32 v142, 16, v23
    v_and_b32 v143, s61, v23
    v_pk_fma_f32 v[136:137], v[136:137], v[146:147], v[146:147] op_sel:[0,0,1] op_sel_hi:[1,0,1]
    v_pk_fma_f32 v[138:139], v[138:139], v[146:147], v[146:147] op_sel:[0,0,1] op_sel_hi:[1,0,1]
    v_pk_fma_f32 v[140:141], v[140:141], v[146:147], v[146:147] op_sel:[0,0,1] op_sel_hi:[1,0,1]
    v_pk_fma_f32 v[142:143], v[142:143], v[146:147], v[146:147] op_sel:[0,0,1] op_sel_hi:[1,0,1]
    v_cvt_pk_bf16_f32 v20, v136, v137
    v_cvt_pk_bf16_f32 v21, v138, v139
    v_cvt_pk_bf16_f32 v22, v140, v141
    v_cvt_pk_bf16_f32 v23, v142, v143
    ds_write_b128 v157, v[20:23] offset:0
    v_lshlrev_b32 v136, 16, v24
    v_and_b32 v137, s61, v24
    v_lshlrev_b32 v138, 16, v25
    v_and_b32 v139, s61, v25
    v_lshlrev_b32 v140, 16, v26
    v_and_b32 v141, s61, v26
    v_lshlrev_b32 v142, 16, v27
    v_and_b32 v143, s61, v27
    v_pk_fma_f32 v[136:137], v[136:137], v[146:147], v[146:147] op_sel:[0,0,1] op_sel_hi:[1,0,1]
    v_pk_fma_f32 v[138:139], v[138:139], v[146:147], v[146:147] op_sel:[0,0,1] op_sel_hi:[1,0,1]
    v_pk_fma_f32 v[140:141], v[140:141], v[146:147], v[146:147] op_sel:[0,0,1] op_sel_hi:[1,0,1]
    v_pk_fma_f32 v[142:143], v[142:143], v[146:147], v[146:147] op_sel:[0,0,1] op_sel_hi:[1,0,1]
    v_cvt_pk_bf16_f32 v24, v136, v137
    v_cvt_pk_bf16_f32 v25, v138, v139
    v_cvt_pk_bf16_f32 v26, v140, v141
    v_cvt_pk_bf16_f32 v27, v142, v143
    ds_write_b128 v156, v[24:27] offset:8192
    v_lshlrev_b32 v136, 16, v28
    v_and_b32 v137, s61, v28
    v_lshlrev_b32 v138, 16, v29
    v_and_b32 v139, s61, v29
    v_lshlrev_b32 v140, 16, v30
    v_and_b32 v141, s61, v30
    v_lshlrev_b32 v142, 16, v31
    v_and_b32 v143, s61, v31
    v_pk_fma_f32 v[136:137], v[136:137], v[146:147], v[146:147] op_sel:[0,0,1] op_sel_hi:[1,0,1]
    v_pk_fma_f32 v[138:139], v[138:139], v[146:147], v[146:147] op_sel:[0,0,1] op_sel_hi:[1,0,1]
    v_pk_fma_f32 v[140:141], v[140:141], v[146:147], v[146:147] op_sel:[0,0,1] op_sel_hi:[1,0,1]
    v_pk_fma_f32 v[142:143], v[142:143], v[146:147], v[146:147] op_sel:[0,0,1] op_sel_hi:[1,0,1]
    v_cvt_pk_bf16_f32 v28, v136, v137
    v_cvt_pk_bf16_f32 v29, v138, v139
    v_cvt_pk_bf16_f32 v30, v140, v141
    v_cvt_pk_bf16_f32 v31, v142, v143
    ds_write_b128 v157, v[28:31] offset:8192
    v_lshlrev_b32 v136, 16, v32
    v_and_b32 v137, s61, v32
    v_lshlrev_b32 v138, 16, v33
    v_and_b32 v139, s61, v33
    v_lshlrev_b32 v140, 16, v34
    v_and_b32 v141, s61, v34
    v_lshlrev_b32 v142, 16, v35
    v_and_b32 v143, s61, v35
    v_pk_fma_f32 v[136:137], v[136:137], v[146:147], v[146:147] op_sel:[0,0,1] op_sel_hi:[1,0,1]
    v_pk_fma_f32 v[138:139], v[138:139], v[146:147], v[146:147] op_sel:[0,0,1] op_sel_hi:[1,0,1]
    v_pk_fma_f32 v[140:141], v[140:141], v[146:147], v[146:147] op_sel:[0,0,1] op_sel_hi:[1,0,1]
    v_pk_fma_f32 v[142:143], v[142:143], v[146:147], v[146:147] op_sel:[0,0,1] op_sel_hi:[1,0,1]
    v_cvt_pk_bf16_f32 v32, v136, v137
    v_cvt_pk_bf16_f32 v33, v138, v139
    v_cvt_pk_bf16_f32 v34, v140, v141
    v_cvt_pk_bf16_f32 v35, v142, v143
    ds_write_b128 v156, v[32:35] offset:16384
    v_lshlrev_b32 v136, 16, v36
    v_and_b32 v137, s61, v36
    v_lshlrev_b32 v138, 16, v37
    v_and_b32 v139, s61, v37
    v_lshlrev_b32 v140, 16, v38
    v_and_b32 v141, s61, v38
    v_lshlrev_b32 v142, 16, v39
    v_and_b32 v143, s61, v39
    v_pk_fma_f32 v[136:137], v[136:137], v[146:147], v[146:147] op_sel:[0,0,1] op_sel_hi:[1,0,1]
    v_pk_fma_f32 v[138:139], v[138:139], v[146:147], v[146:147] op_sel:[0,0,1] op_sel_hi:[1,0,1]
    v_pk_fma_f32 v[140:141], v[140:141], v[146:147], v[146:147] op_sel:[0,0,1] op_sel_hi:[1,0,1]
    v_pk_fma_f32 v[142:143], v[142:143], v[146:147], v[146:147] op_sel:[0,0,1] op_sel_hi:[1,0,1]
    v_cvt_pk_bf16_f32 v36, v136, v137
    v_cvt_pk_bf16_f32 v37, v138, v139
    v_cvt_pk_bf16_f32 v38, v140, v141
    v_cvt_pk_bf16_f32 v39, v142, v143
    ds_write_b128 v157, v[36:39] offset:16384
    s_add_u32 m0, s79, 31872
    s_nop 0
    buffer_load_dwordx4 v173, s[12:15], s72 offen offset:896 lds
    buffer_load_dwordx4 v174, s[12:15], s72 offen offset:1920 lds
    v_lshlrev_b32 v136, 16, v40
    v_and_b32 v137, s61, v40
    v_lshlrev_b32 v138, 16, v41
    v_and_b32 v139, s61, v41
    v_lshlrev_b32 v140, 16, v42
    v_and_b32 v141, s61, v42
    v_lshlrev_b32 v142, 16, v43
    v_and_b32_e64 v143, s61, v43
    v_pk_fma_f32 v[136:137], v[136:137], v[146:147], v[146:147] op_sel:[0,0,1] op_sel_hi:[1,0,1]
    v_pk_fma_f32 v[138:139], v[138:139], v[146:147], v[146:147] op_sel:[0,0,1] op_sel_hi:[1,0,1]
    v_pk_fma_f32 v[140:141], v[140:141], v[146:147], v[146:147] op_sel:[0,0,1] op_sel_hi:[1,0,1]
    v_pk_fma_f32 v[142:143], v[142:143], v[146:147], v[146:147] op_sel:[0,0,1] op_sel_hi:[1,0,1]
    v_cvt_pk_bf16_f32 v40, v136, v137
    v_cvt_pk_bf16_f32 v41, v138, v139
    v_cvt_pk_bf16_f32 v42, v140, v141
    v_cvt_pk_bf16_f32 v43, v142, v143
    ds_write_b128 v156, v[40:43] offset:24576
    s_add_u32 m0, s79, 39168
    s_nop 0
    buffer_load_dwordx4 v173, s[12:15], s72 offen offset:1792 lds
    buffer_load_dwordx4 v174, s[12:15], s72 offen offset:2816 lds
    v_lshlrev_b32 v136, 16, v44
    v_and_b32 v137, s61, v44
    v_lshlrev_b32 v138, 16, v45
    v_and_b32 v139, s61, v45
    v_lshlrev_b32 v140, 16, v46
    v_and_b32 v141, s61, v46
    v_lshlrev_b32 v142, 16, v47
    v_and_b32_e64 v143, s61, v47
    v_pk_fma_f32 v[136:137], v[136:137], v[146:147], v[146:147] op_sel:[0,0,1] op_sel_hi:[1,0,1]
    v_pk_fma_f32 v[138:139], v[138:139], v[146:147], v[146:147] op_sel:[0,0,1] op_sel_hi:[1,0,1]
    v_pk_fma_f32 v[140:141], v[140:141], v[146:147], v[146:147] op_sel:[0,0,1] op_sel_hi:[1,0,1]
    v_pk_fma_f32 v[142:143], v[142:143], v[146:147], v[146:147] op_sel:[0,0,1] op_sel_hi:[1,0,1]
    v_cvt_pk_bf16_f32 v44, v136, v137
    v_cvt_pk_bf16_f32 v45, v138, v139
    v_cvt_pk_bf16_f32 v46, v140, v141
    v_cvt_pk_bf16_f32 v47, v142, v143
    ds_write_b128 v157, v[44:47] offset:24576
    s_add_u32 m0, s79, 24576
    s_nop 0
    buffer_load_dwordx4 v173, s[12:15], s72 offen offset:0 lds
    buffer_load_dwordx4 v174, s[12:15], s72 offen offset:1024 lds
    v_lshlrev_b32 v136, 16, v48
    v_and_b32 v137, s61, v48
    v_lshlrev_b32 v138, 16, v49
    v_and_b32 v139, s61, v49
    v_lshlrev_b32 v140, 16, v50
    v_and_b32 v141, s61, v50
    v_lshlrev_b32 v142, 16, v51
    v_and_b32_e64 v143, s61, v51
    v_pk_fma_f32 v[136:137], v[136:137], v[146:147], v[146:147] op_sel:[0,0,1] op_sel_hi:[1,0,1]
    v_pk_fma_f32 v[138:139], v[138:139], v[146:147], v[146:147] op_sel:[0,0,1] op_sel_hi:[1,0,1]
    v_pk_fma_f32 v[140:141], v[140:141], v[146:147], v[146:147] op_sel:[0,0,1] op_sel_hi:[1,0,1]
    v_pk_fma_f32 v[142:143], v[142:143], v[146:147], v[146:147] op_sel:[0,0,1] op_sel_hi:[1,0,1]
    v_cvt_pk_bf16_f32 v48, v136, v137
    v_cvt_pk_bf16_f32 v49, v138, v139
    v_cvt_pk_bf16_f32 v50, v140, v141
    v_cvt_pk_bf16_f32 v51, v142, v143
    ds_write_b128 v156, v[48:51] offset:32768
    s_add_u32 m0, s79, 56448
    s_nop 0
    buffer_load_dwordx4 v173, s[12:15], s73 offen offset:896 lds
    buffer_load_dwordx4 v174, s[12:15], s73 offen offset:1920 lds
    v_lshlrev_b32 v136, 16, v52
    v_and_b32 v137, s61, v52
    v_lshlrev_b32 v138, 16, v53
    v_and_b32 v139, s61, v53
    v_lshlrev_b32 v140, 16, v54
    v_and_b32 v141, s61, v54
    v_lshlrev_b32 v142, 16, v55
    v_and_b32_e64 v143, s61, v55
    v_pk_fma_f32 v[136:137], v[136:137], v[146:147], v[146:147] op_sel:[0,0,1] op_sel_hi:[1,0,1]
    v_pk_fma_f32 v[138:139], v[138:139], v[146:147], v[146:147] op_sel:[0,0,1] op_sel_hi:[1,0,1]
    v_pk_fma_f32 v[140:141], v[140:141], v[146:147], v[146:147] op_sel:[0,0,1] op_sel_hi:[1,0,1]
    v_pk_fma_f32 v[142:143], v[142:143], v[146:147], v[146:147] op_sel:[0,0,1] op_sel_hi:[1,0,1]
    v_cvt_pk_bf16_f32 v52, v136, v137
    v_cvt_pk_bf16_f32 v53, v138, v139
    v_cvt_pk_bf16_f32 v54, v140, v141
    v_cvt_pk_bf16_f32 v55, v142, v143
    ds_write_b128 v157, v[52:55] offset:32768
    s_add_u32 m0, s79, 63744
    s_nop 0
    buffer_load_dwordx4 v173, s[12:15], s73 offen offset:1792 lds
    buffer_load_dwordx4 v174, s[12:15], s73 offen offset:2816 lds
    v_lshlrev_b32 v136, 16, v56
    v_and_b32 v137, s61, v56
    v_lshlrev_b32 v138, 16, v57
    v_and_b32 v139, s61, v57
    v_lshlrev_b32 v140, 16, v58
    v_and_b32 v141, s61, v58
    v_lshlrev_b32 v142, 16, v59
    v_and_b32_e64 v143, s61, v59
    v_pk_fma_f32 v[136:137], v[136:137], v[146:147], v[146:147] op_sel:[0,0,1] op_sel_hi:[1,0,1]
    v_pk_fma_f32 v[138:139], v[138:139], v[146:147], v[146:147] op_sel:[0,0,1] op_sel_hi:[1,0,1]
    v_pk_fma_f32 v[140:141], v[140:141], v[146:147], v[146:147] op_sel:[0,0,1] op_sel_hi:[1,0,1]
    v_pk_fma_f32 v[142:143], v[142:143], v[146:147], v[146:147] op_sel:[0,0,1] op_sel_hi:[1,0,1]
    v_cvt_pk_bf16_f32 v56, v136, v137
    v_cvt_pk_bf16_f32 v57, v138, v139
    v_cvt_pk_bf16_f32 v58, v140, v141
    v_cvt_pk_bf16_f32 v59, v142, v143
    ds_write_b128 v156, v[56:59] offset:40960
    s_add_u32 m0, s79, 49152
    s_nop 0
    buffer_load_dwordx4 v173, s[12:15], s73 offen offset:0 lds
    buffer_load_dwordx4 v174, s[12:15], s73 offen offset:1024 lds
    v_lshlrev_b32 v136, 16, v60
    v_and_b32 v137, s61, v60
    v_lshlrev_b32 v138, 16, v61
    v_and_b32 v139, s61, v61
    v_lshlrev_b32 v140, 16, v62
    v_and_b32 v141, s61, v62
    v_lshlrev_b32 v142, 16, v63
    v_and_b32_e64 v143, s61, v63
    v_pk_fma_f32 v[136:137], v[136:137], v[146:147], v[146:147] op_sel:[0,0,1] op_sel_hi:[1,0,1]
    v_pk_fma_f32 v[138:139], v[138:139], v[146:147], v[146:147] op_sel:[0,0,1] op_sel_hi:[1,0,1]
    v_pk_fma_f32 v[140:141], v[140:141], v[146:147], v[146:147] op_sel:[0,0,1] op_sel_hi:[1,0,1]
    v_pk_fma_f32 v[142:143], v[142:143], v[146:147], v[146:147] op_sel:[0,0,1] op_sel_hi:[1,0,1]
    v_cvt_pk_bf16_f32 v60, v136, v137
    v_cvt_pk_bf16_f32 v61, v138, v139
    v_cvt_pk_bf16_f32 v62, v140, v141
    v_cvt_pk_bf16_f32 v63, v142, v143
    ds_write_b128 v157, v[60:63] offset:40960
    buffer_load_dword a255, v159, s[20:23], 0 offen
    v_lshlrev_b32 v136, 16, v64
    v_and_b32 v137, s61, v64
    v_lshlrev_b32 v138, 16, v65
    v_and_b32 v139, s61, v65
    v_lshlrev_b32 v140, 16, v66
    v_and_b32 v141, s61, v66
    v_lshlrev_b32 v142, 16, v67
    v_and_b32 v143, s61, v67
    v_pk_fma_f32 v[136:137], v[136:137], v[146:147], v[146:147] op_sel:[0,0,1] op_sel_hi:[1,0,1]
    v_pk_fma_f32 v[138:139], v[138:139], v[146:147], v[146:147] op_sel:[0,0,1] op_sel_hi:[1,0,1]
    v_pk_fma_f32 v[140:141], v[140:141], v[146:147], v[146:147] op_sel:[0,0,1] op_sel_hi:[1,0,1]
    v_pk_fma_f32 v[142:143], v[142:143], v[146:147], v[146:147] op_sel:[0,0,1] op_sel_hi:[1,0,1]
    v_cvt_pk_bf16_f32 v64, v136, v137
    v_cvt_pk_bf16_f32 v65, v138, v139
    v_cvt_pk_bf16_f32 v66, v140, v141
    v_cvt_pk_bf16_f32 v67, v142, v143
    ds_write_b128 v156, v[64:67] offset:49152
    v_lshlrev_b32 v136, 16, v68
    v_and_b32 v137, s61, v68
    v_lshlrev_b32 v138, 16, v69
    v_and_b32 v139, s61, v69
    v_lshlrev_b32 v140, 16, v70
    v_and_b32 v141, s61, v70
    v_lshlrev_b32 v142, 16, v71
    v_and_b32 v143, s61, v71
    v_pk_fma_f32 v[136:137], v[136:137], v[146:147], v[146:147] op_sel:[0,0,1] op_sel_hi:[1,0,1]
    v_pk_fma_f32 v[138:139], v[138:139], v[146:147], v[146:147] op_sel:[0,0,1] op_sel_hi:[1,0,1]
    v_pk_fma_f32 v[140:141], v[140:141], v[146:147], v[146:147] op_sel:[0,0,1] op_sel_hi:[1,0,1]
    v_pk_fma_f32 v[142:143], v[142:143], v[146:147], v[146:147] op_sel:[0,0,1] op_sel_hi:[1,0,1]
    v_cvt_pk_bf16_f32 v68, v136, v137
    v_cvt_pk_bf16_f32 v69, v138, v139
    v_cvt_pk_bf16_f32 v70, v140, v141
    v_cvt_pk_bf16_f32 v71, v142, v143
    ds_write_b128 v157, v[68:71] offset:49152
    s_waitcnt vmcnt(13)
    s_waitcnt lgkmcnt(0)
    s_barrier
    s_cmp_eq_u32 s81, 0
    s_cbranch_scc1 L_Ak
    s_cmp_eq_u32 s81, 1
    s_cbranch_scc1 L_Av
    s_nop 0
    ds_read_b128 a[0:3], v197 offset:0
    ds_read_b64_tr_b16 v[136:137], v195 offset:8192
    ds_read_b64_tr_b16 v[138:139], v195 offset:8704
    ds_read_b64_tr_b16 v[140:141], v195 offset:16384
    ds_read_b64_tr_b16 v[142:143], v195 offset:16896
    ds_read_b64_tr_b16 a[112:113], v195 offset:0
    ds_read_b64_tr_b16 a[114:115], v195 offset:512
    ds_read_b128 a[4:7], v198 offset:0
    ds_read_b64_tr_b16 v[148:149], v195 offset:10240
    ds_read_b64_tr_b16 v[150:151], v195 offset:10752
    ds_read_b64_tr_b16 v[152:153], v195 offset:18432
    ds_read_b64_tr_b16 v[154:155], v195 offset:18944
    ds_read_b64_tr_b16 a[116:117], v195 offset:2048
    ds_read_b64_tr_b16 a[118:119], v195 offset:2560
    s_waitcnt lgkmcnt(9)
    s_nop 0
    v_mfma_f32_32x32x16_bf16 v[88:103], v[136:139], a[0:3], 0
    ds_read_b128 a[8:11], v199 offset:0
    ds_read_b64_tr_b16 v[160:161], v195 offset:12288
    ds_read_b64_tr_b16 v[162:163], v195 offset:12800
    ds_read_b64_tr_b16 v[164:165], v195 offset:20480
    v_mfma_f32_32x32x16_bf16 v[104:119], a[0:3], v[140:143], 0
    ds_read_b64_tr_b16 v[166:167], v195 offset:20992
    ds_read_b64_tr_b16 a[120:121], v195 offset:4096
    ds_read_b64_tr_b16 a[122:123], v195 offset:4608
    s_waitcnt lgkmcnt(9)
    s_nop 0
    v_mfma_f32_32x32x16_bf16 v[88:103], v[148:151], a[4:7], v[88:103]
    ds_read_b128 a[12:15], v200 offset:0
    ds_read_b64_tr_b16 v[136:137], v195 offset:14336
    ds_read_b64_tr_b16 v[138:139], v195 offset:14848
    ds_read_b64_tr_b16 v[140:141], v195 offset:22528
    v_mfma_f32_32x32x16_bf16 v[104:119], a[4:7], v[152:155], v[104:119]
    ds_read_b64_tr_b16 v[142:143], v195 offset:23040
    ds_read_b64_tr_b16 a[124:125], v195 offset:6144
    ds_read_b64_tr_b16 a[126:127], v195 offset:6656
    v_and_b32_e64 v64, 15, v0
    v_lshrrev_b32 v65, 5, v0
    v_bfe_u32 v67, v0, 4, 1
    s_lshl_b32 s62, s57, 7
    s_add_u32 s62, s62, 4096
    s_mul_i32 s68, s57, 28672
    s_add_u32 s68, s68, 323584
    s_waitcnt vmcnt(7)
    s_waitcnt lgkmcnt(0)
    s_barrier
    s_waitcnt lgkmcnt(9)
    v_mfma_f32_32x32x16_bf16 v[88:103], v[160:163], a[8:11], v[88:103]
    ds_read_b128 a[16:19], v197 offset:8192
    ds_read_b64_tr_b16 v[148:149], v195 offset:32768
    ds_read_b64_tr_b16 v[150:151], v195 offset:33280
    ds_read_b64_tr_b16 v[152:153], v195 offset:40960
    s_add_u32 m0, s79, 7296
    s_nop 0
    s_nop 0
    buffer_load_dwordx4 v173, s[12:15], s74 offen offset:896 lds
    v_mfma_f32_32x32x16_bf16 v[104:119], a[8:11], v[164:167], v[104:119]
    ds_read_b64_tr_b16 v[154:155], v195 offset:41472
    ds_read_b64_tr_b16 a[128:129], v195 offset:24576
    ds_read_b64_tr_b16 a[130:131], v195 offset:25088
    buffer_load_dwordx4 v174, s[12:15], s74 offen offset:1920 lds
    s_mul_i32 s69, s57, 7
    s_add_u32 s69, s69, s58
    s_cmp_ge_u32 s58, 7
    s_cselect_b32 s50, 49, 0
    s_add_u32 s69, s69, s50
    s_lshl_b32 s69, s69, 12
    s_add_u32 s69, s69, 1048576
    s_lshr_b32 s59, s57, 1
    s_lshl_b32 s59, s59, 4
    s_add_u32 s59, s59, s58
    s_lshl_b32 s59, s59, 1
    s_and_b32 s50, s42, 1
    s_add_u32 s59, s59, s50
    s_lshl_b32 s59, s59, 2
    s_add_u32 s59, s59, 6144
    s_waitcnt lgkmcnt(9)
    v_mfma_f32_32x32x16_bf16 v[88:103], v[136:139], a[12:15], v[88:103]
    ds_read_b128 a[20:23], v198 offset:8192
    ds_read_b64_tr_b16 v[160:161], v195 offset:34816
    ds_read_b64_tr_b16 v[162:163], v195 offset:35328
    ds_read_b64_tr_b16 v[164:165], v195 offset:43008
    s_add_u32 m0, s79, 14592
    s_nop 0
    s_nop 0
    buffer_load_dwordx4 v173, s[12:15], s74 offen offset:1792 lds
    v_mfma_f32_32x32x16_bf16 v[104:119], a[12:15], v[140:143], v[104:119]
    ds_read_b64_tr_b16 v[166:167], v195 offset:43520
    ds_read_b64_tr_b16 a[132:133], v195 offset:26624
    ds_read_b64_tr_b16 a[134:135], v195 offset:27136
    buffer_load_dwordx4 v174, s[12:15], s74 offen offset:2816 lds
    v_subrev_u32 v4, 106496, v184
    v_xor_b32 v5, 32, v4
    s_waitcnt lgkmcnt(9)
    v_mfma_f32_32x32x16_bf16 v[88:103], v[148:151], a[16:19], v[88:103]
    ds_read_b128 a[24:27], v199 offset:8192
    ds_read_b64_tr_b16 v[136:137], v195 offset:36864
    ds_read_b64_tr_b16 v[138:139], v195 offset:37376
    ds_read_b64_tr_b16 v[140:141], v195 offset:45056
    s_add_u32 m0, s79, 0
    s_nop 0
    buffer_load_dwordx4 v173, s[12:15], s74 offen offset:0 lds
    v_mfma_f32_32x32x16_bf16 v[104:119], a[16:19], v[152:155], v[104:119]
    ds_read_b64_tr_b16 v[142:143], v195 offset:45568
    ds_read_b64_tr_b16 a[136:137], v195 offset:28672
    ds_read_b64_tr_b16 a[138:139], v195 offset:29184
    buffer_load_dwordx4 v174, s[12:15], s74 offen offset:1024 lds
    v_xor_b32 v6, 64, v4
    v_xor_b32 v7, 96, v4
    s_waitcnt lgkmcnt(9)
    v_mfma_f32_32x32x16_bf16 v[88:103], v[160:163], a[20:23], v[88:103]
    ds_read_b128 a[28:31], v200 offset:8192
    ds_read_b64_tr_b16 v[148:149], v195 offset:38912
    ds_read_b64_tr_b16 v[150:151], v195 offset:39424
    ds_read_b64_tr_b16 v[152:153], v195 offset:47104
    v_mfma_f32_32x32x16_bf16 v[104:119], a[20:23], v[164:167], v[104:119]
    ds_read_b64_tr_b16 v[154:155], v195 offset:47616
    ds_read_b64_tr_b16 a[140:141], v195 offset:30720
    ds_read_b64_tr_b16 a[142:143], v195 offset:31232
    v_add_u32 v8, 65536, v4
    v_add_u32 v9, 65536, v5
    s_waitcnt vmcnt(7)
    s_waitcnt lgkmcnt(0)
    s_barrier
    s_waitcnt lgkmcnt(9)
    v_mfma_f32_32x32x16_bf16 v[88:103], v[136:139], a[24:27], v[88:103]
    ds_read_b128 a[32:35], v197 offset:16384
    ds_read_b64_tr_b16 v[160:161], v196 offset:8192
    ds_read_b64_tr_b16 v[162:163], v196 offset:8704
    ds_read_b64_tr_b16 v[164:165], v196 offset:16384
    s_add_u32 m0, s79, 31872
    s_nop 0
    s_nop 0
    buffer_load_dwordx4 v173, s[12:15], s75 offen offset:896 lds
    v_mfma_f32_32x32x16_bf16 v[104:119], a[24:27], v[140:143], v[104:119]
    ds_read_b64_tr_b16 v[166:167], v196 offset:16896
    ds_read_b64_tr_b16 a[144:145], v196 offset:0
    ds_read_b64_tr_b16 a[146:147], v196 offset:512
    buffer_load_dwordx4 v174, s[12:15], s75 offen offset:1920 lds
    v_add_u32 v10, 65536, v6
    v_add_u32 v11, 65536, v7
    s_waitcnt lgkmcnt(9)
    v_mfma_f32_32x32x16_bf16 v[88:103], v[148:151], a[28:31], v[88:103]
    ds_read_b128 a[36:39], v198 offset:16384
    ds_read_b64_tr_b16 v[136:137], v196 offset:10240
    ds_read_b64_tr_b16 v[138:139], v196 offset:10752
    ds_read_b64_tr_b16 v[140:141], v196 offset:18432
    s_add_u32 m0, s79, 39168
    s_nop 0
    buffer_load_dwordx4 v173, s[12:15], s75 offen offset:1792 lds
    v_mfma_f32_32x32x16_bf16 v[104:119], a[28:31], v[152:155], v[104:119]
    ds_read_b64_tr_b16 v[142:143], v196 offset:18944
    ds_read_b64_tr_b16 a[148:149], v196 offset:2048
    ds_read_b64_tr_b16 a[150:151], v196 offset:2560
    buffer_load_dwordx4 v174, s[12:15], s75 offen offset:2816 lds
    v_and_b32 v14, 7, v0
    v_min_u32 v14, 6, v14
    v_and_b32 v15, 8, v0
    v_or_b32 v14, v14, v15
    v_lshlrev_b32 v234, 2, v14
    v_lshrrev_b32 v14, 3, v0
    v_and_b32 v15, 6, v14
    v_xor_b32 v15, v0, v15
    v_and_b32 v15, 7, v15
    v_mul_u32_u24 v14, 896, v14
    v_lshl_add_u32 v244, v15, 4, v14
    s_waitcnt lgkmcnt(9)
    v_mfma_f32_32x32x16_bf16 v[88:103], v[160:163], a[32:35], v[88:103]
    ds_read_b128 a[40:43], v199 offset:16384
    ds_read_b64_tr_b16 v[148:149], v196 offset:12288
    ds_read_b64_tr_b16 v[150:151], v196 offset:12800
    ds_read_b64_tr_b16 v[152:153], v196 offset:20480
    s_add_u32 m0, s79, 24576
    s_nop 0
    s_nop 0
    buffer_load_dwordx4 v173, s[12:15], s75 offen offset:0 lds
    v_mfma_f32_32x32x16_bf16 v[104:119], a[32:35], v[164:167], v[104:119]
    ds_read_b64_tr_b16 v[154:155], v196 offset:20992
    ds_read_b64_tr_b16 a[152:153], v196 offset:4096
    ds_read_b64_tr_b16 a[154:155], v196 offset:4608
    buffer_load_dwordx4 v174, s[12:15], s75 offen offset:1024 lds
    v_add_u32 v245, 6144, v244
    v_add_u32 v246, 12288, v244
    s_waitcnt lgkmcnt(9)
    s_nop 0
    v_mfma_f32_32x32x16_bf16 v[88:103], v[136:139], a[36:39], v[88:103]
    ds_read_b128 a[44:47], v200 offset:16384
    ds_read_b64_tr_b16 v[160:161], v196 offset:14336
    ds_read_b64_tr_b16 v[162:163], v196 offset:14848
    ds_read_b64_tr_b16 v[164:165], v196 offset:22528
    v_mfma_f32_32x32x16_bf16 v[104:119], a[36:39], v[140:143], v[104:119]
    ds_read_b64_tr_b16 v[166:167], v196 offset:23040
    ds_read_b64_tr_b16 a[156:157], v196 offset:6144
    ds_read_b64_tr_b16 a[158:159], v196 offset:6656
    v_add_u32 v247, 18432, v244
    s_mul_i32 s70, s42, 401408
    s_lshl_b32 s50, s44, 7
    s_add_u32 s70, s70, s50
    s_add_u32 s50, s89, 131072
    v_add_u32 v12, 14336, v253
    v_add_u32 v248, s50, v4
    v_add_u32 v249, s50, v5
    v_add_u32 v250, s50, v6
    v_add_u32 v251, s50, v7
    s_waitcnt vmcnt(6)
    s_waitcnt lgkmcnt(0)
    s_barrier
    s_waitcnt lgkmcnt(9)
    v_mfma_f32_32x32x16_bf16 v[88:103], v[148:151], a[40:43], v[88:103]
    ds_read_b128 a[48:51], v197 offset:24576
    ds_read_b64_tr_b16 v[136:137], v195 offset:8192
    ds_read_b64_tr_b16 v[138:139], v195 offset:8704
    ds_read_b64_tr_b16 v[140:141], v195 offset:16384
    s_add_u32 m0, s79, 56448
    s_nop 0
    s_nop 0
    buffer_load_dwordx4 v173, s[12:15], s76 offen offset:896 lds
    v_mfma_f32_32x32x16_bf16 v[104:119], a[40:43], v[152:155], v[104:119]
    ds_read_b64_tr_b16 v[142:143], v195 offset:16896
    ds_read_b64_tr_b16 a[160:161], v195 offset:0
    ds_read_b64_tr_b16 a[162:163], v195 offset:512
    buffer_load_dwordx4 v174, s[12:15], s76 offen offset:1920 lds
    s_add_u32 s50, s89, 131072
    v_mul_u32_u24 v213, 144, v2
    v_lshl_add_u32 v213, v3, 4, v213
    v_add_u32_e64 v213, s50, v213
    v_mul_u32_u24 v214, 144, v64
    v_lshrrev_b32_e64 v14, 4, v0
    v_lshl_add_u32 v214, v14, 3, v214
    v_add_u32 v214, s50, v214
    s_waitcnt lgkmcnt(9)
    v_mfma_f32_32x32x16_bf16 v[88:103], v[160:163], a[44:47], v[88:103]
    ds_read_b128 a[52:55], v198 offset:24576
    ds_read_b64_tr_b16 v[148:149], v195 offset:10240
    ds_read_b64_tr_b16 v[150:151], v195 offset:10752
    ds_read_b64_tr_b16 v[152:153], v195 offset:18432
    s_add_u32 m0, s79, 63744
    s_nop 0
    s_nop 0
    buffer_load_dwordx4 v173, s[12:15], s76 offen offset:1792 lds
    v_mfma_f32_32x32x16_bf16 v[104:119], a[44:47], v[164:167], v[104:119]
    ds_read_b64_tr_b16 v[154:155], v195 offset:18944
    ds_read_b64_tr_b16 a[164:165], v195 offset:2048
    ds_read_b64_tr_b16 a[166:167], v195 offset:2560
    buffer_load_dwordx4 v174, s[12:15], s76 offen offset:2816 lds
    v_lshrrev_b32_e64 v14, 3, v0
    v_mul_u32_u24 v215, 144, v14
    v_and_b32_e64 v14, 7, v0
    v_lshl_add_u32 v215, v14, 4, v215
    v_add_u32 v215, s50, v215
    v_lshlrev_b32 v232, 4, v64
    s_lshl_b32 s52, s43, 2
    s_add_u32 s52, s52, s42
    s_mul_i32 s64, s52, 14336
    s_lshl_b32 s50, s44, 11
    s_add_u32 s65, s64, s50
    s_add_u32 s65, s65, 323584
    s_add_u32 s64, s64, 65536
    s_waitcnt lgkmcnt(9)
    v_mfma_f32_32x32x16_bf16 v[88:103], v[136:139], a[48:51], v[88:103]
    ds_read_b128 a[56:59], v199 offset:24576
    ds_read_b64_tr_b16 v[160:161], v195 offset:12288
    ds_read_b64_tr_b16 v[162:163], v195 offset:12800
    ds_read_b64_tr_b16 v[164:165], v195 offset:20480
    s_add_u32 m0, s79, 49152
    s_nop 0
    buffer_load_dwordx4 v173, s[12:15], s76 offen offset:0 lds
    v_mfma_f32_32x32x16_bf16 v[104:119], a[48:51], v[140:143], v[104:119]
    ds_read_b64_tr_b16 v[166:167], v195 offset:20992
    ds_read_b64_tr_b16 a[168:169], v195 offset:4096
    ds_read_b64_tr_b16 a[170:171], v195 offset:4608
    buffer_load_dwordx4 v174, s[12:15], s76 offen offset:1024 lds
    s_mul_i32 s67, s52, 1792
    s_add_u32 s67, s67, 16384
    s_lshl_b32 s50, s44, 8
    s_add_u32 s66, s67, s50
    s_lshr_b32 s53, s52, 1
    s_and_b32 s51, s42, 1
    s_lshl_b32 s47, s53, 2
    s_add_u32 s47, s47, s51
    s_lshl_b32 s47, s47, 3
    s_add_u32 s47, s47, s44
    s_lshl_b32 s47, s47, 2
    s_add_u32 s47, s47, 4096
    s_waitcnt lgkmcnt(9)
    v_mfma_f32_32x32x16_bf16 v[88:103], v[148:151], a[52:55], v[88:103]
    ds_read_b128 a[60:63], v200 offset:24576
    ds_read_b64_tr_b16 v[136:137], v195 offset:14336
    ds_read_b64_tr_b16 v[138:139], v195 offset:14848
    ds_read_b64_tr_b16 v[140:141], v195 offset:22528
    s_lshl_b32 s55, s44, 7
    s_add_u32 s55, s55, s86
    buffer_load_dwordx4 v[204:207], v172, s[8:11], s55 offen offset:0
    v_mfma_f32_32x32x16_bf16 v[104:119], a[52:55], v[152:155], v[104:119]
    ds_read_b64_tr_b16 v[142:143], v195 offset:23040
    ds_read_b64_tr_b16 a[172:173], v195 offset:6144
    ds_read_b64_tr_b16 a[174:175], v195 offset:6656
    buffer_load_dwordx4 v[208:211], v172, s[8:11], s55 offen offset:64
    s_lshl_b32 s60, s43, 1
    s_add_u32 s60, s60, s51
    s_lshl_b32 s60, s60, 7
    s_add_u32 s60, s60, 2048
    s_cmp_lt_u32 s43, 3
    s_cselect_b32 s50, 16, 0
    v_and_b32 v14, s50, v0
    v_lshlrev_b32_e64 v233, 2, v64
    v_lshl_add_u32 v233, v14, 4, v233
    s_waitcnt vmcnt(8)
    s_waitcnt lgkmcnt(0)
    s_barrier
    s_waitcnt lgkmcnt(9)
    v_mfma_f32_32x32x16_bf16 v[88:103], v[160:163], a[56:59], v[88:103]
    ds_read_b128 a[64:67], v197 offset:32768
    ds_read_b64_tr_b16 v[148:149], v195 offset:32768
    ds_read_b64_tr_b16 v[150:151], v195 offset:33280
    ds_read_b64_tr_b16 v[152:153], v195 offset:40960
    s_add_u32 m0, s79, 7296
    s_nop 0
    buffer_load_dwordx4 v173, s[12:15], s77 offen offset:896 lds
    v_mfma_f32_32x32x16_bf16 v[104:119], a[56:59], v[164:167], v[104:119]
    ds_read_b64_tr_b16 v[154:155], v195 offset:41472
    ds_read_b64_tr_b16 a[176:177], v195 offset:24576
    ds_read_b64_tr_b16 a[178:179], v195 offset:25088
    buffer_load_dwordx4 v174, s[12:15], s77 offen offset:1920 lds
    s_waitcnt lgkmcnt(9)
    v_mfma_f32_32x32x16_bf16 v[88:103], v[136:139], a[60:63], v[88:103]
    ds_read_b128 a[68:71], v198 offset:32768
    ds_read_b64_tr_b16 v[160:161], v195 offset:34816
    ds_read_b64_tr_b16 v[162:163], v195 offset:35328
    ds_read_b64_tr_b16 v[164:165], v195 offset:43008
    s_add_u32 m0, s79, 14592
    s_nop 0
    buffer_load_dwordx4 v173, s[12:15], s77 offen offset:1792 lds
    v_mfma_f32_32x32x16_bf16 v[104:119], a[60:63], v[140:143], v[104:119]
    ds_read_b64_tr_b16 v[166:167], v195 offset:43520
    ds_read_b64_tr_b16 a[180:181], v195 offset:26624
    ds_read_b64_tr_b16 a[182:183], v195 offset:27136
    buffer_load_dwordx4 v174, s[12:15], s77 offen offset:2816 lds
    s_waitcnt lgkmcnt(9)
    v_mfma_f32_32x32x16_bf16 v[88:103], v[148:151], a[64:67], v[88:103]
    ds_read_b128 a[72:75], v199 offset:32768
    ds_read_b64_tr_b16 v[136:137], v195 offset:36864
    ds_read_b64_tr_b16 v[138:139], v195 offset:37376
    ds_read_b64_tr_b16 v[140:141], v195 offset:45056
    s_add_u32 m0, s79, 0
    s_nop 0
    buffer_load_dwordx4 v173, s[12:15], s77 offen offset:0 lds
    v_mfma_f32_32x32x16_bf16 v[104:119], a[64:67], v[152:155], v[104:119]
    ds_read_b64_tr_b16 v[142:143], v195 offset:45568
    ds_read_b64_tr_b16 a[184:185], v195 offset:28672
    ds_read_b64_tr_b16 a[186:187], v195 offset:29184
    buffer_load_dwordx4 v174, s[12:15], s77 offen offset:1024 lds
    s_waitcnt lgkmcnt(9)
    s_nop 0
    v_mfma_f32_32x32x16_bf16 v[88:103], v[160:163], a[68:71], v[88:103]
    ds_read_b128 a[76:79], v200 offset:32768
    ds_read_b64_tr_b16 v[148:149], v195 offset:38912
    ds_read_b64_tr_b16 v[150:151], v195 offset:39424
    ds_read_b64_tr_b16 v[152:153], v195 offset:47104
    buffer_load_dword v194, v193, s[36:39], s49 offen sc1
    v_mfma_f32_32x32x16_bf16 v[104:119], a[68:71], v[164:167], v[104:119]
    ds_read_b64_tr_b16 v[154:155], v195 offset:47616
    ds_read_b64_tr_b16 a[188:189], v195 offset:30720
    ds_read_b64_tr_b16 a[190:191], v195 offset:31232
    s_add_u32 m0, s85, 106496
    s_add_u32 s56, s83, 0
    s_nop 0
    buffer_load_dwordx4 v192, s[16:19], s56 offen lds
    s_waitcnt vmcnt(10)
    s_waitcnt lgkmcnt(0)
    s_barrier
    s_waitcnt lgkmcnt(9)
    v_mfma_f32_32x32x16_bf16 v[88:103], v[136:139], a[72:75], v[88:103]
    ds_read_b128 a[80:83], v197 offset:40960
    ds_read_b64_tr_b16 v[160:161], v196 offset:8192
    ds_read_b64_tr_b16 v[162:163], v196 offset:8704
    ds_read_b64_tr_b16 v[164:165], v196 offset:16384
    s_add_u32 m0, s85, 110592
    s_add_u32 s56, s83, 28672
    buffer_load_dwordx4 v192, s[16:19], s56 offen lds
    v_mfma_f32_32x32x16_bf16 v[104:119], a[72:75], v[140:143], v[104:119]
    ds_read_b64_tr_b16 v[166:167], v196 offset:16896
    ds_read_b64_tr_b16 a[192:193], v196 offset:0
    ds_read_b64_tr_b16 a[194:195], v196 offset:512
    s_add_u32 m0, s85, 114688
    s_add_u32 s56, s83, 57344
    buffer_load_dwordx4 v192, s[16:19], s56 offen lds
    s_waitcnt lgkmcnt(9)
    s_nop 0
    v_mfma_f32_32x32x16_bf16 v[88:103], v[148:151], a[76:79], v[88:103]
    ds_read_b128 a[84:87], v198 offset:40960
    ds_read_b64_tr_b16 v[136:137], v196 offset:10240
    ds_read_b64_tr_b16 v[138:139], v196 offset:10752
    ds_read_b64_tr_b16 v[140:141], v196 offset:18432
    s_add_u32 m0, s85, 118784
    s_add_u32 s56, s83, 86016
    buffer_load_dwordx4 v192, s[16:19], s56 offen lds
    v_mfma_f32_32x32x16_bf16 v[104:119], a[76:79], v[152:155], v[104:119]
    ds_read_b64_tr_b16 v[142:143], v196 offset:18944
    ds_read_b64_tr_b16 a[196:197], v196 offset:2048
    ds_read_b64_tr_b16 a[198:199], v196 offset:2560
    s_add_u32 m0, s85, 122880
    s_add_u32 s56, s83, 114688
    buffer_load_dwordx4 v192, s[16:19], s56 offen lds
    s_waitcnt lgkmcnt(9)
    s_nop 0
    v_mfma_f32_32x32x16_bf16 v[88:103], v[160:163], a[80:83], v[88:103]
    ds_read_b128 a[88:91], v199 offset:40960
    ds_read_b64_tr_b16 v[148:149], v196 offset:12288
    ds_read_b64_tr_b16 v[150:151], v196 offset:12800
    ds_read_b64_tr_b16 v[152:153], v196 offset:20480
    s_add_u32 m0, s85, 126976
    s_add_u32 s56, s83, 143360
    buffer_load_dwordx4 v192, s[16:19], s56 offen lds
    v_mfma_f32_32x32x16_bf16 v[104:119], a[80:83], v[164:167], v[104:119]
    ds_read_b64_tr_b16 v[154:155], v196 offset:20992
    ds_read_b64_tr_b16 a[200:201], v196 offset:4096
    ds_read_b64_tr_b16 a[202:203], v196 offset:4608
    s_add_u32 m0, s85, 131072
    s_add_u32 s56, s83, 172032
    buffer_load_dwordx4 v192, s[16:19], s56 offen lds
    s_waitcnt lgkmcnt(9)
    s_nop 0
    v_mfma_f32_32x32x16_bf16 v[88:103], v[136:139], a[84:87], v[88:103]
    ds_read_b128 a[92:95], v200 offset:40960
    ds_read_b64_tr_b16 v[160:161], v196 offset:14336
    ds_read_b64_tr_b16 v[162:163], v196 offset:14848
    ds_read_b64_tr_b16 v[164:165], v196 offset:22528
    s_add_u32 m0, s85, 135168
    s_add_u32 s56, s83, 200704
    buffer_load_dwordx4 v192, s[16:19], s56 offen lds
    v_mfma_f32_32x32x16_bf16 v[104:119], a[84:87], v[140:143], v[104:119]
    ds_read_b64_tr_b16 v[166:167], v196 offset:23040
    ds_read_b64_tr_b16 a[204:205], v196 offset:6144
    ds_read_b64_tr_b16 a[206:207], v196 offset:6656
    s_add_u32 m0, s85, 139264
    s_add_u32 s56, s83, 229376
    buffer_load_dwordx4 v192, s[16:19], s56 offen lds
    s_waitcnt vmcnt(10)
    s_waitcnt lgkmcnt(0)
    s_barrier
    s_waitcnt lgkmcnt(9)
    v_mfma_f32_32x32x16_bf16 v[88:103], v[148:151], a[88:91], v[88:103]
    ds_read_b128 a[96:99], v197 offset:49152
    ds_read_b64_tr_b16 v[136:137], v195 offset:8192
    ds_read_b64_tr_b16 v[138:139], v195 offset:8704
    ds_read_b64_tr_b16 v[140:141], v195 offset:16384
    s_add_u32 m0, s85, 143360
    s_add_u32 s56, s83, 258048
    buffer_load_dwordx4 v192, s[16:19], s56 offen lds
    v_mfma_f32_32x32x16_bf16 v[104:119], a[88:91], v[152:155], v[104:119]
    ds_read_b64_tr_b16 v[142:143], v195 offset:16896
    ds_read_b64_tr_b16 a[208:209], v195 offset:0
    ds_read_b64_tr_b16 a[210:211], v195 offset:512
    s_add_u32 m0, s85, 147456
    s_add_u32 s56, s83, 286720
    buffer_load_dwordx4 v192, s[16:19], s56 offen lds
    s_waitcnt lgkmcnt(9)
    s_nop 0
    v_mfma_f32_32x32x16_bf16 v[88:103], v[160:163], a[92:95], v[88:103]
    ds_read_b128 a[100:103], v198 offset:49152
    ds_read_b64_tr_b16 v[148:149], v195 offset:10240
    ds_read_b64_tr_b16 v[150:151], v195 offset:10752
    ds_read_b64_tr_b16 v[152:153], v195 offset:18432
    s_add_u32 m0, s85, 151552
    s_add_u32 s56, s83, 315392
    buffer_load_dwordx4 v192, s[16:19], s56 offen lds
    v_mfma_f32_32x32x16_bf16 v[104:119], a[92:95], v[164:167], v[104:119]
    ds_read_b64_tr_b16 v[154:155], v195 offset:18944
    ds_read_b64_tr_b16 a[212:213], v195 offset:2048
    ds_read_b64_tr_b16 a[214:215], v195 offset:2560
    s_waitcnt lgkmcnt(9)
    s_nop 0
    v_mfma_f32_32x32x16_bf16 v[88:103], v[136:139], a[96:99], v[88:103]
    ds_read_b128 a[104:107], v199 offset:49152
    ds_read_b64_tr_b16 v[160:161], v195 offset:12288
    ds_read_b64_tr_b16 v[162:163], v195 offset:12800
    ds_read_b64_tr_b16 v[164:165], v195 offset:20480
    v_mfma_f32_32x32x16_bf16 v[104:119], a[96:99], v[140:143], v[104:119]
    ds_read_b64_tr_b16 v[166:167], v195 offset:20992
    ds_read_b64_tr_b16 a[216:217], v195 offset:4096
    ds_read_b64_tr_b16 a[218:219], v195 offset:4608
    s_waitcnt lgkmcnt(9)
    s_nop 0
    v_mfma_f32_32x32x16_bf16 v[88:103], v[148:151], a[100:103], v[88:103]
    ds_read_b128 a[108:111], v200 offset:49152
    ds_read_b64_tr_b16 v[136:137], v195 offset:14336
    ds_read_b64_tr_b16 v[138:139], v195 offset:14848
    ds_read_b64_tr_b16 v[140:141], v195 offset:22528
    v_mfma_f32_32x32x16_bf16 v[104:119], a[100:103], v[152:155], v[104:119]
    ds_read_b64_tr_b16 v[142:143], v195 offset:23040
    ds_read_b64_tr_b16 a[220:221], v195 offset:6144
    ds_read_b64_tr_b16 a[222:223], v195 offset:6656
    s_waitcnt vmcnt(12)
    s_mov_b32 s50, 0
Lt_5:
    v_and_b32 v14, 0x80808080, v194
    v_cmp_ne_u32 vcc, 0x80808080, v14
    s_cbranch_vccz Lt_6
    s_add_u32 s50, s50, 1
    s_cmp_ge_u32 s50, 0x40000
    s_cbranch_scc1 Lt_6
    s_sleep 16
    buffer_load_dword v194, v193, s[36:39], s49 offen sc1
    s_waitcnt vmcnt(0)
    s_branch Lt_5
Lt_6:
    s_mul_i32 s51, s48, 0x01010101
    v_and_b32 v14, 0x07070707, v194
    v_cmp_ne_u32 vcc, s51, v14
    s_nop 0
    v_readlane_b32 s52, v194, 0
    v_readlane_b32 s53, v194, 1
    s_cmp_eq_u64 vcc, 0
    s_cselect_b32 s45, 1, 0
    s_cselect_b32 s51, 0, 4194304
    s_add_u32 s32, s32, s51
    s_addc_u32 s33, s33, 0
    s_and_b32 s52, s52, 0x78787878
    s_lshr_b32 s52, s52, 3
    s_and_b32 s53, s53, 0x78787878
    s_lshl_b32 s53, s53, 1
    s_or_b32 s46, s52, s53
    s_lshl_b32 s49, s42, 12
    s_add_u32 s71, s82, 65536
    s_add_u32 s72, s82, 323584
    s_add_u32 s73, s82, 585728
    s_add_u32 s74, s82, 600064
    s_add_u32 s75, s82, 294912
    s_add_u32 s76, s82, 528384
    s_add_u32 s77, s82, 542720
    s_waitcnt vmcnt(4)
    s_waitcnt lgkmcnt(0)
    s_barrier
    s_waitcnt lgkmcnt(9)
    v_mfma_f32_32x32x16_bf16 v[88:103], v[160:163], a[104:107], v[88:103]
    s_add_u32 m0, s85, 155648
    s_add_u32 s56, s83, 344064
    buffer_load_dwordx4 v192, s[16:19], s56 offen lds
    v_mfma_f32_32x32x16_bf16 v[104:119], a[104:107], v[164:167], v[104:119]
    s_add_u32 m0, s85, 159744
    s_add_u32 s56, s83, 372736
    buffer_load_dwordx4 v192, s[16:19], s56 offen lds
    s_waitcnt lgkmcnt(2)
    s_nop 0
    v_mfma_f32_32x32x16_bf16 v[88:103], v[136:139], a[108:111], v[88:103]
    v_mfma_f32_32x32x16_bf16 v[104:119], a[108:111], v[140:143], v[104:119]
    v_mfma_f32_32x32x16_bf16 v[72:87], a[112:115], a[0:3], 0
    ds_read_b64_tr_b16 a[224:225], v184 offset:0
    ds_read_b64_tr_b16 a[226:227], v188 offset:0
    ds_read_b64_tr_b16 a[228:229], v185 offset:0
    ds_read_b64_tr_b16 a[230:231], v189 offset:0
    v_mfma_f32_32x32x16_bf16 v[72:87], a[116:119], a[4:7], v[72:87]
    ds_read_b64_tr_b16 a[232:233], v186 offset:0
    ds_read_b64_tr_b16 a[234:235], v190 offset:0
    ds_read_b64_tr_b16 a[236:237], v187 offset:0
    ds_read_b64_tr_b16 a[238:239], v191 offset:0
    v_mfma_f32_32x32x16_bf16 v[72:87], a[120:123], a[8:11], v[72:87]
    v_cvt_pk_bf16_f32 v24, v88, v89
    v_cvt_pk_bf16_f32 v25, v90, v91
    v_cvt_pk_bf16_f32 v26, v92, v93
    v_cvt_pk_bf16_f32 v27, v94, v95
    buffer_store_dwordx4 v[24:27], v254, s[32:35], s72 offen offset:0 sc1
    v_mfma_f32_32x32x16_bf16 v[72:87], a[124:127], a[12:15], v[72:87]
    v_cvt_pk_bf16_f32 v28, v96, v97
    v_cvt_pk_bf16_f32 v29, v98, v99
    v_cvt_pk_bf16_f32 v30, v100, v101
    v_cvt_pk_bf16_f32 v31, v102, v103
    buffer_store_dwordx4 v[28:31], v254, s[32:35], s72 offen offset:512 sc1
    v_mfma_f32_32x32x16_bf16 v[72:87], a[128:131], a[16:19], v[72:87]
    v_cvt_pk_bf16_f32 v32, v104, v105
    v_cvt_pk_bf16_f32 v33, v106, v107
    v_cvt_pk_bf16_f32 v34, v108, v109
    v_cvt_pk_bf16_f32 v35, v110, v111
    buffer_store_dwordx4 v[32:35], v175, s[32:35], s73 offen sc1
    v_mfma_f32_32x32x16_bf16 v[72:87], a[132:135], a[20:23], v[72:87]
    v_cvt_pk_bf16_f32 v36, v112, v113
    v_cvt_pk_bf16_f32 v37, v114, v115
    v_cvt_pk_bf16_f32 v38, v116, v117
    v_cvt_pk_bf16_f32 v39, v118, v119
    buffer_store_dwordx4 v[36:39], v175, s[32:35], s74 offen sc1
    v_mfma_f32_32x32x16_bf16 v[72:87], a[136:139], a[24:27], v[72:87]
    ds_read_b64_tr_b16 a[240:241], v186 offset:3584
    ds_read_b64_tr_b16 a[242:243], v190 offset:3584
    ds_read_b64_tr_b16 a[244:245], v187 offset:3584
    ds_read_b64_tr_b16 a[246:247], v191 offset:3584
    v_mfma_f32_32x32x16_bf16 v[72:87], a[140:143], a[28:31], v[72:87]
    ds_read_b64_tr_b16 a[248:249], v184 offset:3584
    ds_read_b64_tr_b16 a[250:251], v188 offset:3584
    ds_read_b64_tr_b16 a[252:253], v185 offset:3584
    ds_read_b64_tr_b16 a[254:255], v189 offset:3584
    v_mfma_f32_32x32x16_bf16 v[72:87], a[144:147], a[32:35], v[72:87]
    ds_read_b64_tr_b16 a[0:1], v184 offset:7168
    ds_read_b64_tr_b16 a[2:3], v188 offset:7168
    ds_read_b64_tr_b16 a[112:113], v185 offset:7168
    ds_read_b64_tr_b16 a[114:115], v189 offset:7168
    v_mfma_f32_32x32x16_bf16 v[72:87], a[148:151], a[36:39], v[72:87]
    ds_read_b64_tr_b16 a[4:5], v186 offset:7168
    ds_read_b64_tr_b16 a[6:7], v190 offset:7168
    ds_read_b64_tr_b16 a[116:117], v187 offset:7168
    ds_read_b64_tr_b16 a[118:119], v191 offset:7168
    v_mfma_f32_32x32x16_bf16 v[72:87], a[152:155], a[40:43], v[72:87]
    ds_read_b64_tr_b16 a[8:9], v186 offset:10752
    ds_read_b64_tr_b16 a[10:11], v190 offset:10752
    ds_read_b64_tr_b16 a[120:121], v187 offset:10752
    ds_read_b64_tr_b16 a[122:123], v191 offset:10752
    v_mfma_f32_32x32x16_bf16 v[72:87], a[156:159], a[44:47], v[72:87]
    ds_read_b64_tr_b16 a[12:13], v184 offset:10752
    ds_read_b64_tr_b16 a[14:15], v188 offset:10752
    ds_read_b64_tr_b16 a[124:125], v185 offset:10752
    ds_read_b64_tr_b16 a[126:127], v189 offset:10752
    v_mfma_f32_32x32x16_bf16 v[72:87], a[160:163], a[48:51], v[72:87]
    ds_read_b64_tr_b16 a[16:17], v184 offset:14336
    ds_read_b64_tr_b16 a[18:19], v188 offset:14336
    ds_read_b64_tr_b16 a[128:129], v185 offset:14336
    ds_read_b64_tr_b16 a[130:131], v189 offset:14336
    v_mfma_f32_32x32x16_bf16 v[72:87], a[164:167], a[52:55], v[72:87]
    ds_read_b64_tr_b16 a[20:21], v186 offset:14336
    ds_read_b64_tr_b16 a[22:23], v190 offset:14336
    ds_read_b64_tr_b16 a[132:133], v187 offset:14336
    ds_read_b64_tr_b16 a[134:135], v191 offset:14336
    v_mfma_f32_32x32x16_bf16 v[72:87], a[168:171], a[56:59], v[72:87]
    ds_read_b64_tr_b16 a[24:25], v186 offset:17920
    ds_read_b64_tr_b16 a[26:27], v190 offset:17920
    ds_read_b64_tr_b16 a[136:137], v187 offset:17920
    ds_read_b64_tr_b16 a[138:139], v191 offset:17920
    v_mfma_f32_32x32x16_bf16 v[72:87], a[172:175], a[60:63], v[72:87]
    ds_read_b64_tr_b16 a[28:29], v184 offset:17920
    ds_read_b64_tr_b16 a[30:31], v188 offset:17920
    ds_read_b64_tr_b16 a[140:141], v185 offset:17920
    ds_read_b64_tr_b16 a[142:143], v189 offset:17920
    v_mfma_f32_32x32x16_bf16 v[72:87], a[176:179], a[64:67], v[72:87]
    ds_read_b64_tr_b16 a[32:33], v184 offset:21504
    ds_read_b64_tr_b16 a[34:35], v188 offset:21504
    ds_read_b64_tr_b16 a[144:145], v185 offset:21504
    ds_read_b64_tr_b16 a[146:147], v189 offset:21504
    v_mfma_f32_32x32x16_bf16 v[72:87], a[180:183], a[68:71], v[72:87]
    ds_read_b64_tr_b16 a[36:37], v186 offset:21504
    ds_read_b64_tr_b16 a[38:39], v190 offset:21504
    ds_read_b64_tr_b16 a[148:149], v187 offset:21504
    ds_read_b64_tr_b16 a[150:151], v191 offset:21504
    v_mfma_f32_32x32x16_bf16 v[72:87], a[184:187], a[72:75], v[72:87]
    ds_read_b64_tr_b16 a[40:41], v186 offset:25088
    ds_read_b64_tr_b16 a[42:43], v190 offset:25088
    ds_read_b64_tr_b16 a[152:153], v187 offset:25088
    ds_read_b64_tr_b16 a[154:155], v191 offset:25088
    v_mfma_f32_32x32x16_bf16 v[72:87], a[188:191], a[76:79], v[72:87]
    ds_read_b64_tr_b16 a[44:45], v184 offset:25088
    ds_read_b64_tr_b16 a[46:47], v188 offset:25088
    ds_read_b64_tr_b16 a[156:157], v185 offset:25088
    ds_read_b64_tr_b16 a[158:159], v189 offset:25088
    v_mfma_f32_32x32x16_bf16 v[72:87], a[192:195], a[80:83], v[72:87]
    ds_read_b64_tr_b16 a[48:49], v184 offset:28672
    ds_read_b64_tr_b16 a[50:51], v188 offset:28672
    ds_read_b64_tr_b16 a[160:161], v185 offset:28672
    ds_read_b64_tr_b16 a[162:163], v189 offset:28672
    v_mfma_f32_32x32x16_bf16 v[72:87], a[196:199], a[84:87], v[72:87]
    ds_read_b64_tr_b16 a[52:53], v186 offset:28672
    ds_read_b64_tr_b16 a[54:55], v190 offset:28672
    ds_read_b64_tr_b16 a[164:165], v187 offset:28672
    ds_read_b64_tr_b16 a[166:167], v191 offset:28672
    v_mfma_f32_32x32x16_bf16 v[72:87], a[200:203], a[88:91], v[72:87]
    v_mfma_f32_32x32x16_bf16 v[72:87], a[204:207], a[92:95], v[72:87]
    v_mfma_f32_32x32x16_bf16 v[72:87], a[208:211], a[96:99], v[72:87]
    v_mfma_f32_32x32x16_bf16 v[72:87], a[212:215], a[100:103], v[72:87]
    v_mfma_f32_32x32x16_bf16 v[72:87], a[216:219], a[104:107], v[72:87]
    v_mfma_f32_32x32x16_bf16 v[72:87], a[220:223], a[108:111], v[72:87]
    s_cmp_eq_u32 s45, 0
    s_cbranch_scc1 Ls_7
    s_nop 9
    s_nop 0
    v_cvt_pk_bf16_f32 v16, v72, v73
    v_cvt_pk_bf16_f32 v17, v74, v75
    v_cvt_pk_bf16_f32 v18, v76, v77
    v_cvt_pk_bf16_f32 v19, v78, v79
    buffer_store_dwordx4 v[16:19], v254, s[32:35], s71 offen offset:0
    v_cvt_pk_bf16_f32 v20, v80, v81
    v_cvt_pk_bf16_f32 v21, v82, v83
    v_cvt_pk_bf16_f32 v22, v84, v85
    v_cvt_pk_bf16_f32 v23, v86, v87
    buffer_store_dwordx4 v[20:23], v254, s[32:35], s71 offen offset:512
    s_branch Ls_8
Ls_7:
    s_nop 7
    s_nop 3
    s_nop 0
    v_cvt_pk_bf16_f32 v16, v72, v73
    v_cvt_pk_bf16_f32 v17, v74, v75
    v_cvt_pk_bf16_f32 v18, v76, v77
    v_cvt_pk_bf16_f32 v19, v78, v79
    buffer_store_dwordx4 v[16:19], v254, s[32:35], s71 offen offset:0 sc1
    v_cvt_pk_bf16_f32 v20, v80, v81
    v_cvt_pk_bf16_f32 v21, v82, v83
    v_cvt_pk_bf16_f32 v22, v84, v85
    v_cvt_pk_bf16_f32 v23, v86, v87
    buffer_store_dwordx4 v[20:23], v254, s[32:35], s71 offen offset:512 sc1
Ls_8:
    s_branch L_att
L_Ak:
    s_nop 0
    ds_read_b128 a[0:3], v197 offset:0
    ds_read_b64_tr_b16 v[136:137], v195 offset:8192
    ds_read_b64_tr_b16 v[138:139], v195 offset:8704
    ds_read_b64_tr_b16 v[140:141], v195 offset:16384
    ds_read_b64_tr_b16 v[142:143], v195 offset:16896
    ds_read_b128 v[144:147], v201 offset:0
    ds_read_b64_tr_b16 a[112:113], v195 offset:0
    ds_read_b64_tr_b16 a[114:115], v195 offset:512
    ds_read_b128 a[4:7], v198 offset:0
    ds_read_b64_tr_b16 v[148:149], v195 offset:10240
    ds_read_b64_tr_b16 v[150:151], v195 offset:10752
    ds_read_b64_tr_b16 v[152:153], v195 offset:18432
    ds_read_b64_tr_b16 v[154:155], v195 offset:18944
    ds_read_b128 v[156:159], v202 offset:0
    ds_read_b64_tr_b16 a[116:117], v195 offset:2048
    ds_read_b64_tr_b16 a[118:119], v195 offset:2560
    s_waitcnt lgkmcnt(10)
    s_nop 0
    v_mfma_f32_32x32x16_bf16 v[88:103], v[136:139], a[0:3], 0
    ds_read_b128 a[8:11], v199 offset:0
    ds_read_b64_tr_b16 v[160:161], v195 offset:12288
    ds_read_b64_tr_b16 v[162:163], v195 offset:12800
    ds_read_b64_tr_b16 v[164:165], v195 offset:20480
    v_mfma_f32_32x32x16_bf16 v[104:119], a[0:3], v[140:143], 0
    ds_read_b64_tr_b16 v[166:167], v195 offset:20992
    ds_read_b128 v[168:171], v203 offset:0
    ds_read_b64_tr_b16 a[120:121], v195 offset:4096
    ds_read_b64_tr_b16 a[122:123], v195 offset:4608
    v_mfma_f32_32x32x16_bf16 v[120:135], v[136:139], v[144:147], 0
    s_waitcnt lgkmcnt(10)
    s_nop 0
    v_mfma_f32_32x32x16_bf16 v[88:103], v[148:151], a[4:7], v[88:103]
    ds_read_b128 a[12:15], v200 offset:0
    ds_read_b64_tr_b16 v[136:137], v195 offset:14336
    ds_read_b64_tr_b16 v[138:139], v195 offset:14848
    ds_read_b64_tr_b16 v[140:141], v195 offset:22528
    v_mfma_f32_32x32x16_bf16 v[104:119], a[4:7], v[152:155], v[104:119]
    ds_read_b64_tr_b16 v[142:143], v195 offset:23040
    ds_read_b128 v[144:147], v212 offset:0
    ds_read_b64_tr_b16 a[124:125], v195 offset:6144
    ds_read_b64_tr_b16 a[126:127], v195 offset:6656
    v_and_b32_e64 v64, 15, v0
    v_lshrrev_b32 v65, 5, v0
    v_bfe_u32 v67, v0, 4, 1
    s_lshl_b32 s62, s57, 7
    s_add_u32 s62, s62, 4096
    s_mul_i32 s68, s57, 28672
    s_add_u32 s68, s68, 323584
    v_mfma_f32_32x32x16_bf16 v[120:135], v[148:151], v[156:159], v[120:135]
    s_waitcnt vmcnt(7)
    s_waitcnt lgkmcnt(0)
    s_barrier
    s_waitcnt lgkmcnt(10)
    v_mfma_f32_32x32x16_bf16 v[88:103], v[160:163], a[8:11], v[88:103]
    ds_read_b128 a[16:19], v197 offset:8192
    ds_read_b64_tr_b16 v[148:149], v195 offset:32768
    ds_read_b64_tr_b16 v[150:151], v195 offset:33280
    ds_read_b64_tr_b16 v[152:153], v195 offset:40960
    s_add_u32 m0, s79, 7296
    s_nop 0
    s_nop 0
    buffer_load_dwordx4 v173, s[12:15], s74 offen offset:896 lds
    v_mfma_f32_32x32x16_bf16 v[104:119], a[8:11], v[164:167], v[104:119]
    ds_read_b64_tr_b16 v[154:155], v195 offset:41472
    ds_read_b128 v[156:159], v201 offset:2048
    ds_read_b64_tr_b16 a[128:129], v195 offset:24576
    ds_read_b64_tr_b16 a[130:131], v195 offset:25088
    buffer_load_dwordx4 v174, s[12:15], s74 offen offset:1920 lds
    s_mul_i32 s69, s57, 7
    s_add_u32 s69, s69, s58
    s_cmp_ge_u32 s58, 7
    s_cselect_b32 s50, 49, 0
    s_add_u32 s69, s69, s50
    s_lshl_b32 s69, s69, 12
    s_add_u32 s69, s69, 1048576
    s_lshr_b32 s59, s57, 1
    s_lshl_b32 s59, s59, 4
    s_add_u32 s59, s59, s58
    s_lshl_b32 s59, s59, 1
    s_and_b32 s50, s42, 1
    s_add_u32 s59, s59, s50
    s_lshl_b32 s59, s59, 2
    s_add_u32 s59, s59, 6144
    v_mfma_f32_32x32x16_bf16 v[120:135], v[160:163], v[168:171], v[120:135]
    s_waitcnt lgkmcnt(10)
    v_mfma_f32_32x32x16_bf16 v[88:103], v[136:139], a[12:15], v[88:103]
    ds_read_b128 a[20:23], v198 offset:8192
    ds_read_b64_tr_b16 v[160:161], v195 offset:34816
    ds_read_b64_tr_b16 v[162:163], v195 offset:35328
    ds_read_b64_tr_b16 v[164:165], v195 offset:43008
    s_add_u32 m0, s79, 14592
    s_nop 0
    s_nop 0
    buffer_load_dwordx4 v173, s[12:15], s74 offen offset:1792 lds
    v_mfma_f32_32x32x16_bf16 v[104:119], a[12:15], v[140:143], v[104:119]
    ds_read_b64_tr_b16 v[166:167], v195 offset:43520
    ds_read_b128 v[168:171], v202 offset:2048
    ds_read_b64_tr_b16 a[132:133], v195 offset:26624
    ds_read_b64_tr_b16 a[134:135], v195 offset:27136
    buffer_load_dwordx4 v174, s[12:15], s74 offen offset:2816 lds
    v_subrev_u32 v4, 106496, v184
    v_xor_b32 v5, 32, v4
    v_mfma_f32_32x32x16_bf16 v[120:135], v[136:139], v[144:147], v[120:135]
    s_waitcnt lgkmcnt(10)
    v_mfma_f32_32x32x16_bf16 v[88:103], v[148:151], a[16:19], v[88:103]
    ds_read_b128 a[24:27], v199 offset:8192
    ds_read_b64_tr_b16 v[136:137], v195 offset:36864
    ds_read_b64_tr_b16 v[138:139], v195 offset:37376
    ds_read_b64_tr_b16 v[140:141], v195 offset:45056
    s_add_u32 m0, s79, 0
    s_nop 0
    buffer_load_dwordx4 v173, s[12:15], s74 offen offset:0 lds
    v_mfma_f32_32x32x16_bf16 v[104:119], a[16:19], v[152:155], v[104:119]
    ds_read_b64_tr_b16 v[142:143], v195 offset:45568
    ds_read_b128 v[144:147], v203 offset:2048
    ds_read_b64_tr_b16 a[136:137], v195 offset:28672
    ds_read_b64_tr_b16 a[138:139], v195 offset:29184
    buffer_load_dwordx4 v174, s[12:15], s74 offen offset:1024 lds
    v_xor_b32 v6, 64, v4
    v_xor_b32 v7, 96, v4
    v_mfma_f32_32x32x16_bf16 v[120:135], v[148:151], v[156:159], v[120:135]
    s_waitcnt lgkmcnt(10)
    v_mfma_f32_32x32x16_bf16 v[88:103], v[160:163], a[20:23], v[88:103]
    ds_read_b128 a[28:31], v200 offset:8192
    ds_read_b64_tr_b16 v[148:149], v195 offset:38912
    ds_read_b64_tr_b16 v[150:151], v195 offset:39424
    ds_read_b64_tr_b16 v[152:153], v195 offset:47104
    v_mfma_f32_32x32x16_bf16 v[104:119], a[20:23], v[164:167], v[104:119]
    ds_read_b64_tr_b16 v[154:155], v195 offset:47616
    ds_read_b128 v[156:159], v212 offset:2048
    ds_read_b64_tr_b16 a[140:141], v195 offset:30720
    ds_read_b64_tr_b16 a[142:143], v195 offset:31232
    v_add_u32 v8, 65536, v4
    v_add_u32 v9, 65536, v5
    v_mfma_f32_32x32x16_bf16 v[120:135], v[160:163], v[168:171], v[120:135]
    s_waitcnt vmcnt(7)
    s_waitcnt lgkmcnt(0)
    s_barrier
    s_waitcnt lgkmcnt(10)
    v_mfma_f32_32x32x16_bf16 v[88:103], v[136:139], a[24:27], v[88:103]
    ds_read_b128 a[32:35], v197 offset:16384
    ds_read_b64_tr_b16 v[160:161], v196 offset:8192
    ds_read_b64_tr_b16 v[162:163], v196 offset:8704
    ds_read_b64_tr_b16 v[164:165], v196 offset:16384
    s_add_u32 m0, s79, 31872
    s_nop 0
    s_nop 0
    buffer_load_dwordx4 v173, s[12:15], s75 offen offset:896 lds
    v_mfma_f32_32x32x16_bf16 v[104:119], a[24:27], v[140:143], v[104:119]
    ds_read_b64_tr_b16 v[166:167], v196 offset:16896
    ds_read_b128 v[168:171], v201 offset:4096
    ds_read_b64_tr_b16 a[144:145], v196 offset:0
    ds_read_b64_tr_b16 a[146:147], v196 offset:512
    buffer_load_dwordx4 v174, s[12:15], s75 offen offset:1920 lds
    v_add_u32 v10, 65536, v6
    v_add_u32 v11, 65536, v7
    v_mfma_f32_32x32x16_bf16 v[120:135], v[136:139], v[144:147], v[120:135]
    s_waitcnt lgkmcnt(10)
    v_mfma_f32_32x32x16_bf16 v[88:103], v[148:151], a[28:31], v[88:103]
    ds_read_b128 a[36:39], v198 offset:16384
    ds_read_b64_tr_b16 v[136:137], v196 offset:10240
    ds_read_b64_tr_b16 v[138:139], v196 offset:10752
    ds_read_b64_tr_b16 v[140:141], v196 offset:18432
    s_add_u32 m0, s79, 39168
    s_nop 0
    buffer_load_dwordx4 v173, s[12:15], s75 offen offset:1792 lds
    v_mfma_f32_32x32x16_bf16 v[104:119], a[28:31], v[152:155], v[104:119]
    ds_read_b64_tr_b16 v[142:143], v196 offset:18944
    ds_read_b128 v[144:147], v202 offset:4096
    ds_read_b64_tr_b16 a[148:149], v196 offset:2048
    ds_read_b64_tr_b16 a[150:151], v196 offset:2560
    buffer_load_dwordx4 v174, s[12:15], s75 offen offset:2816 lds
    v_and_b32 v14, 7, v0
    v_min_u32 v14, 6, v14
    v_and_b32 v15, 8, v0
    v_or_b32 v14, v14, v15
    v_lshlrev_b32 v234, 2, v14
    v_lshrrev_b32 v14, 3, v0
    v_and_b32 v15, 6, v14
    v_xor_b32 v15, v0, v15
    v_and_b32 v15, 7, v15
    v_mul_u32_u24 v14, 896, v14
    v_lshl_add_u32 v244, v15, 4, v14
    v_mfma_f32_32x32x16_bf16 v[120:135], v[148:151], v[156:159], v[120:135]
    s_waitcnt lgkmcnt(10)
    v_mfma_f32_32x32x16_bf16 v[88:103], v[160:163], a[32:35], v[88:103]
    ds_read_b128 a[40:43], v199 offset:16384
    ds_read_b64_tr_b16 v[148:149], v196 offset:12288
    ds_read_b64_tr_b16 v[150:151], v196 offset:12800
    ds_read_b64_tr_b16 v[152:153], v196 offset:20480
    s_add_u32 m0, s79, 24576
    s_nop 0
    s_nop 0
    buffer_load_dwordx4 v173, s[12:15], s75 offen offset:0 lds
    v_mfma_f32_32x32x16_bf16 v[104:119], a[32:35], v[164:167], v[104:119]
    ds_read_b64_tr_b16 v[154:155], v196 offset:20992
    ds_read_b128 v[156:159], v203 offset:4096
    ds_read_b64_tr_b16 a[152:153], v196 offset:4096
    ds_read_b64_tr_b16 a[154:155], v196 offset:4608
    buffer_load_dwordx4 v174, s[12:15], s75 offen offset:1024 lds
    v_add_u32 v245, 6144, v244
    v_add_u32 v246, 12288, v244
    v_mfma_f32_32x32x16_bf16 v[120:135], v[160:163], v[168:171], v[120:135]
    s_waitcnt lgkmcnt(10)
    s_nop 0
    v_mfma_f32_32x32x16_bf16 v[88:103], v[136:139], a[36:39], v[88:103]
    ds_read_b128 a[44:47], v200 offset:16384
    ds_read_b64_tr_b16 v[160:161], v196 offset:14336
    ds_read_b64_tr_b16 v[162:163], v196 offset:14848
    ds_read_b64_tr_b16 v[164:165], v196 offset:22528
    v_mfma_f32_32x32x16_bf16 v[104:119], a[36:39], v[140:143], v[104:119]
    ds_read_b64_tr_b16 v[166:167], v196 offset:23040
    ds_read_b128 v[168:171], v212 offset:4096
    ds_read_b64_tr_b16 a[156:157], v196 offset:6144
    ds_read_b64_tr_b16 a[158:159], v196 offset:6656
    v_add_u32 v247, 18432, v244
    s_mul_i32 s70, s42, 401408
    s_lshl_b32 s50, s44, 7
    s_add_u32 s70, s70, s50
    s_add_u32 s50, s89, 131072
    v_add_u32 v12, 14336, v253
    v_add_u32 v248, s50, v4
    v_add_u32 v249, s50, v5
    v_add_u32 v250, s50, v6
    v_add_u32 v251, s50, v7
    v_mfma_f32_32x32x16_bf16 v[120:135], v[136:139], v[144:147], v[120:135]
    s_waitcnt vmcnt(6)
    s_waitcnt lgkmcnt(0)
    s_barrier
    s_waitcnt lgkmcnt(10)
    v_mfma_f32_32x32x16_bf16 v[88:103], v[148:151], a[40:43], v[88:103]
    ds_read_b128 a[48:51], v197 offset:24576
    ds_read_b64_tr_b16 v[136:137], v195 offset:8192
    ds_read_b64_tr_b16 v[138:139], v195 offset:8704
    ds_read_b64_tr_b16 v[140:141], v195 offset:16384
    s_add_u32 m0, s79, 56448
    s_nop 0
    s_nop 0
    buffer_load_dwordx4 v173, s[12:15], s76 offen offset:896 lds
    v_mfma_f32_32x32x16_bf16 v[104:119], a[40:43], v[152:155], v[104:119]
    ds_read_b64_tr_b16 v[142:143], v195 offset:16896
    ds_read_b128 v[144:147], v201 offset:6144
    ds_read_b64_tr_b16 a[160:161], v195 offset:0
    ds_read_b64_tr_b16 a[162:163], v195 offset:512
    buffer_load_dwordx4 v174, s[12:15], s76 offen offset:1920 lds
    s_add_u32 s50, s89, 131072
    v_mul_u32_u24 v213, 144, v2
    v_lshl_add_u32 v213, v3, 4, v213
    v_add_u32_e64 v213, s50, v213
    v_mul_u32_u24 v214, 144, v64
    v_lshrrev_b32_e64 v14, 4, v0
    v_lshl_add_u32 v214, v14, 3, v214
    v_add_u32 v214, s50, v214
    v_mfma_f32_32x32x16_bf16 v[120:135], v[148:151], v[156:159], v[120:135]
    s_waitcnt lgkmcnt(10)
    v_mfma_f32_32x32x16_bf16 v[88:103], v[160:163], a[44:47], v[88:103]
    ds_read_b128 a[52:55], v198 offset:24576
    ds_read_b64_tr_b16 v[148:149], v195 offset:10240
    ds_read_b64_tr_b16 v[150:151], v195 offset:10752
    ds_read_b64_tr_b16 v[152:153], v195 offset:18432
    s_add_u32 m0, s79, 63744
    s_nop 0
    s_nop 0
    buffer_load_dwordx4 v173, s[12:15], s76 offen offset:1792 lds
    v_mfma_f32_32x32x16_bf16 v[104:119], a[44:47], v[164:167], v[104:119]
    ds_read_b64_tr_b16 v[154:155], v195 offset:18944
    ds_read_b128 v[156:159], v202 offset:6144
    ds_read_b64_tr_b16 a[164:165], v195 offset:2048
    ds_read_b64_tr_b16 a[166:167], v195 offset:2560
    buffer_load_dwordx4 v174, s[12:15], s76 offen offset:2816 lds
    v_lshrrev_b32_e64 v14, 3, v0
    v_mul_u32_u24 v215, 144, v14
    v_and_b32_e64 v14, 7, v0
    v_lshl_add_u32 v215, v14, 4, v215
    v_add_u32 v215, s50, v215
    v_lshlrev_b32 v232, 4, v64
    s_lshl_b32 s52, s43, 2
    s_add_u32 s52, s52, s42
    s_mul_i32 s64, s52, 14336
    s_lshl_b32 s50, s44, 11
    s_add_u32 s65, s64, s50
    s_add_u32 s65, s65, 323584
    s_add_u32 s64, s64, 65536
    v_mfma_f32_32x32x16_bf16 v[120:135], v[160:163], v[168:171], v[120:135]
    s_waitcnt lgkmcnt(10)
    v_mfma_f32_32x32x16_bf16 v[88:103], v[136:139], a[48:51], v[88:103]
    ds_read_b128 a[56:59], v199 offset:24576
    ds_read_b64_tr_b16 v[160:161], v195 offset:12288
    ds_read_b64_tr_b16 v[162:163], v195 offset:12800
    ds_read_b64_tr_b16 v[164:165], v195 offset:20480
    s_add_u32 m0, s79, 49152
    s_nop 0
    buffer_load_dwordx4 v173, s[12:15], s76 offen offset:0 lds
    v_mfma_f32_32x32x16_bf16 v[104:119], a[48:51], v[140:143], v[104:119]
    ds_read_b64_tr_b16 v[166:167], v195 offset:20992
    ds_read_b128 v[168:171], v203 offset:6144
    ds_read_b64_tr_b16 a[168:169], v195 offset:4096
    ds_read_b64_tr_b16 a[170:171], v195 offset:4608
    buffer_load_dwordx4 v174, s[12:15], s76 offen offset:1024 lds
    s_mul_i32 s67, s52, 1792
    s_add_u32 s67, s67, 16384
    s_lshl_b32 s50, s44, 8
    s_add_u32 s66, s67, s50
    s_lshr_b32 s53, s52, 1
    s_and_b32 s51, s42, 1
    s_lshl_b32 s47, s53, 2
    s_add_u32 s47, s47, s51
    s_lshl_b32 s47, s47, 3
    s_add_u32 s47, s47, s44
    s_lshl_b32 s47, s47, 2
    s_add_u32 s47, s47, 4096
    v_mfma_f32_32x32x16_bf16 v[120:135], v[136:139], v[144:147], v[120:135]
    s_waitcnt lgkmcnt(10)
    v_mfma_f32_32x32x16_bf16 v[88:103], v[148:151], a[52:55], v[88:103]
    ds_read_b128 a[60:63], v200 offset:24576
    ds_read_b64_tr_b16 v[136:137], v195 offset:14336
    ds_read_b64_tr_b16 v[138:139], v195 offset:14848
    ds_read_b64_tr_b16 v[140:141], v195 offset:22528
    s_lshl_b32 s55, s44, 7
    s_add_u32 s55, s55, s86
    buffer_load_dwordx4 v[204:207], v172, s[8:11], s55 offen offset:0
    v_mfma_f32_32x32x16_bf16 v[104:119], a[52:55], v[152:155], v[104:119]
    ds_read_b64_tr_b16 v[142:143], v195 offset:23040
    ds_read_b128 v[144:147], v212 offset:6144
    ds_read_b64_tr_b16 a[172:173], v195 offset:6144
    ds_read_b64_tr_b16 a[174:175], v195 offset:6656
    buffer_load_dwordx4 v[208:211], v172, s[8:11], s55 offen offset:64
    s_lshl_b32 s60, s43, 1
    s_add_u32 s60, s60, s51
    s_lshl_b32 s60, s60, 7
    s_add_u32 s60, s60, 2048
    s_cmp_lt_u32 s43, 3
    s_cselect_b32 s50, 16, 0
    v_and_b32 v14, s50, v0
    v_lshlrev_b32_e64 v233, 2, v64
    v_lshl_add_u32 v233, v14, 4, v233
    v_mfma_f32_32x32x16_bf16 v[120:135], v[148:151], v[156:159], v[120:135]
    s_waitcnt vmcnt(8)
    s_waitcnt lgkmcnt(0)
    s_barrier
    s_waitcnt lgkmcnt(10)
    v_mfma_f32_32x32x16_bf16 v[88:103], v[160:163], a[56:59], v[88:103]
    ds_read_b128 a[64:67], v197 offset:32768
    ds_read_b64_tr_b16 v[148:149], v195 offset:32768
    ds_read_b64_tr_b16 v[150:151], v195 offset:33280
    ds_read_b64_tr_b16 v[152:153], v195 offset:40960
    s_add_u32 m0, s79, 7296
    s_nop 0
    s_nop 0
    buffer_load_dwordx4 v173, s[12:15], s77 offen offset:896 lds
    v_mfma_f32_32x32x16_bf16 v[104:119], a[56:59], v[164:167], v[104:119]
    ds_read_b64_tr_b16 v[154:155], v195 offset:41472
    ds_read_b128 v[156:159], v201 offset:8192
    ds_read_b64_tr_b16 a[176:177], v195 offset:24576
    ds_read_b64_tr_b16 a[178:179], v195 offset:25088
    buffer_load_dwordx4 v174, s[12:15], s77 offen offset:1920 lds
    v_mfma_f32_32x32x16_bf16 v[120:135], v[160:163], v[168:171], v[120:135]
    s_waitcnt lgkmcnt(10)
    v_mfma_f32_32x32x16_bf16 v[88:103], v[136:139], a[60:63], v[88:103]
    ds_read_b128 a[68:71], v198 offset:32768
    ds_read_b64_tr_b16 v[160:161], v195 offset:34816
    ds_read_b64_tr_b16 v[162:163], v195 offset:35328
    ds_read_b64_tr_b16 v[164:165], v195 offset:43008
    s_add_u32 m0, s79, 14592
    s_nop 0
    buffer_load_dwordx4 v173, s[12:15], s77 offen offset:1792 lds
    v_mfma_f32_32x32x16_bf16 v[104:119], a[60:63], v[140:143], v[104:119]
    ds_read_b64_tr_b16 v[166:167], v195 offset:43520
    ds_read_b128 v[168:171], v202 offset:8192
    ds_read_b64_tr_b16 a[180:181], v195 offset:26624
    ds_read_b64_tr_b16 a[182:183], v195 offset:27136
    buffer_load_dwordx4 v174, s[12:15], s77 offen offset:2816 lds
    v_mfma_f32_32x32x16_bf16 v[120:135], v[136:139], v[144:147], v[120:135]
    s_waitcnt lgkmcnt(10)
    s_nop 0
    v_mfma_f32_32x32x16_bf16 v[88:103], v[148:151], a[64:67], v[88:103]
    ds_read_b128 a[72:75], v199 offset:32768
    ds_read_b64_tr_b16 v[136:137], v195 offset:36864
    ds_read_b64_tr_b16 v[138:139], v195 offset:37376
    ds_read_b64_tr_b16 v[140:141], v195 offset:45056
    s_add_u32 m0, s79, 0
    s_nop 0
    buffer_load_dwordx4 v173, s[12:15], s77 offen offset:0 lds
    v_mfma_f32_32x32x16_bf16 v[104:119], a[64:67], v[152:155], v[104:119]
    ds_read_b64_tr_b16 v[142:143], v195 offset:45568
    ds_read_b128 v[144:147], v203 offset:8192
    ds_read_b64_tr_b16 a[184:185], v195 offset:28672
    ds_read_b64_tr_b16 a[186:187], v195 offset:29184
    buffer_load_dwordx4 v174, s[12:15], s77 offen offset:1024 lds
    v_mfma_f32_32x32x16_bf16 v[120:135], v[148:151], v[156:159], v[120:135]
    s_waitcnt lgkmcnt(10)
    s_nop 0
    v_mfma_f32_32x32x16_bf16 v[88:103], v[160:163], a[68:71], v[88:103]
    ds_read_b128 a[76:79], v200 offset:32768
    ds_read_b64_tr_b16 v[148:149], v195 offset:38912
    ds_read_b64_tr_b16 v[150:151], v195 offset:39424
    ds_read_b64_tr_b16 v[152:153], v195 offset:47104
    buffer_load_dword v194, v193, s[36:39], s49 offen sc1
    v_mfma_f32_32x32x16_bf16 v[104:119], a[68:71], v[164:167], v[104:119]
    ds_read_b64_tr_b16 v[154:155], v195 offset:47616
    ds_read_b128 v[156:159], v212 offset:8192
    ds_read_b64_tr_b16 a[188:189], v195 offset:30720
    ds_read_b64_tr_b16 a[190:191], v195 offset:31232
    s_add_u32 m0, s85, 106496
    s_add_u32 s56, s83, 0
    s_nop 0
    buffer_load_dwordx4 v192, s[16:19], s56 offen lds
    v_mfma_f32_32x32x16_bf16 v[120:135], v[160:163], v[168:171], v[120:135]
    s_waitcnt vmcnt(10)
    s_waitcnt lgkmcnt(0)
    s_barrier
    s_waitcnt lgkmcnt(10)
    v_mfma_f32_32x32x16_bf16 v[88:103], v[136:139], a[72:75], v[88:103]
    ds_read_b128 a[80:83], v197 offset:40960
    ds_read_b64_tr_b16 v[160:161], v196 offset:8192
    ds_read_b64_tr_b16 v[162:163], v196 offset:8704
    ds_read_b64_tr_b16 v[164:165], v196 offset:16384
    s_add_u32 m0, s85, 110592
    s_add_u32 s56, s83, 28672
    buffer_load_dwordx4 v192, s[16:19], s56 offen lds
    v_mfma_f32_32x32x16_bf16 v[104:119], a[72:75], v[140:143], v[104:119]
    ds_read_b64_tr_b16 v[166:167], v196 offset:16896
    ds_read_b128 v[168:171], v201 offset:10240
    ds_read_b64_tr_b16 a[192:193], v196 offset:0
    ds_read_b64_tr_b16 a[194:195], v196 offset:512
    s_add_u32 m0, s85, 114688
    s_add_u32 s56, s83, 57344
    buffer_load_dwordx4 v192, s[16:19], s56 offen lds
    v_mfma_f32_32x32x16_bf16 v[120:135], v[136:139], v[144:147], v[120:135]
    s_waitcnt lgkmcnt(10)
    s_nop 0
    v_mfma_f32_32x32x16_bf16 v[88:103], v[148:151], a[76:79], v[88:103]
    ds_read_b128 a[84:87], v198 offset:40960
    ds_read_b64_tr_b16 v[136:137], v196 offset:10240
    ds_read_b64_tr_b16 v[138:139], v196 offset:10752
    ds_read_b64_tr_b16 v[140:141], v196 offset:18432
    s_add_u32 m0, s85, 118784
    s_add_u32 s56, s83, 86016
    buffer_load_dwordx4 v192, s[16:19], s56 offen lds
    v_mfma_f32_32x32x16_bf16 v[104:119], a[76:79], v[152:155], v[104:119]
    ds_read_b64_tr_b16 v[142:143], v196 offset:18944
    ds_read_b128 v[144:147], v202 offset:10240
    ds_read_b64_tr_b16 a[196:197], v196 offset:2048
    ds_read_b64_tr_b16 a[198:199], v196 offset:2560
    s_add_u32 m0, s85, 122880
    s_add_u32 s56, s83, 114688
    buffer_load_dwordx4 v192, s[16:19], s56 offen lds
    v_mfma_f32_32x32x16_bf16 v[120:135], v[148:151], v[156:159], v[120:135]
    s_waitcnt lgkmcnt(10)
    s_nop 0
    v_mfma_f32_32x32x16_bf16 v[88:103], v[160:163], a[80:83], v[88:103]
    ds_read_b128 a[88:91], v199 offset:40960
    ds_read_b64_tr_b16 v[148:149], v196 offset:12288
    ds_read_b64_tr_b16 v[150:151], v196 offset:12800
    ds_read_b64_tr_b16 v[152:153], v196 offset:20480
    s_add_u32 m0, s85, 126976
    s_add_u32 s56, s83, 143360
    buffer_load_dwordx4 v192, s[16:19], s56 offen lds
    v_mfma_f32_32x32x16_bf16 v[104:119], a[80:83], v[164:167], v[104:119]
    ds_read_b64_tr_b16 v[154:155], v196 offset:20992
    ds_read_b128 v[156:159], v203 offset:10240
    ds_read_b64_tr_b16 a[200:201], v196 offset:4096
    ds_read_b64_tr_b16 a[202:203], v196 offset:4608
    s_add_u32 m0, s85, 131072
    s_add_u32 s56, s83, 172032
    buffer_load_dwordx4 v192, s[16:19], s56 offen lds
    v_mfma_f32_32x32x16_bf16 v[120:135], v[160:163], v[168:171], v[120:135]
    s_waitcnt lgkmcnt(10)
    s_nop 0
    v_mfma_f32_32x32x16_bf16 v[88:103], v[136:139], a[84:87], v[88:103]
    ds_read_b128 a[92:95], v200 offset:40960
    ds_read_b64_tr_b16 v[160:161], v196 offset:14336
    ds_read_b64_tr_b16 v[162:163], v196 offset:14848
    ds_read_b64_tr_b16 v[164:165], v196 offset:22528
    s_add_u32 m0, s85, 135168
    s_add_u32 s56, s83, 200704
    buffer_load_dwordx4 v192, s[16:19], s56 offen lds
    v_mfma_f32_32x32x16_bf16 v[104:119], a[84:87], v[140:143], v[104:119]
    ds_read_b64_tr_b16 v[166:167], v196 offset:23040
    ds_read_b128 v[168:171], v212 offset:10240
    ds_read_b64_tr_b16 a[204:205], v196 offset:6144
    ds_read_b64_tr_b16 a[206:207], v196 offset:6656
    s_add_u32 m0, s85, 139264
    s_add_u32 s56, s83, 229376
    buffer_load_dwordx4 v192, s[16:19], s56 offen lds
    v_mfma_f32_32x32x16_bf16 v[120:135], v[136:139], v[144:147], v[120:135]
    s_waitcnt vmcnt(10)
    s_waitcnt lgkmcnt(0)
    s_barrier
    s_waitcnt lgkmcnt(10)
    v_mfma_f32_32x32x16_bf16 v[88:103], v[148:151], a[88:91], v[88:103]
    ds_read_b128 a[96:99], v197 offset:49152
    ds_read_b64_tr_b16 v[136:137], v195 offset:8192
    ds_read_b64_tr_b16 v[138:139], v195 offset:8704
    ds_read_b64_tr_b16 v[140:141], v195 offset:16384
    s_add_u32 m0, s85, 143360
    s_add_u32 s56, s83, 258048
    buffer_load_dwordx4 v192, s[16:19], s56 offen lds
    v_mfma_f32_32x32x16_bf16 v[104:119], a[88:91], v[152:155], v[104:119]
    ds_read_b64_tr_b16 v[142:143], v195 offset:16896
    ds_read_b128 v[144:147], v201 offset:12288
    ds_read_b64_tr_b16 a[208:209], v195 offset:0
    ds_read_b64_tr_b16 a[210:211], v195 offset:512
    s_add_u32 m0, s85, 147456
    s_add_u32 s56, s83, 286720
    buffer_load_dwordx4 v192, s[16:19], s56 offen lds
    v_mfma_f32_32x32x16_bf16 v[120:135], v[148:151], v[156:159], v[120:135]
    s_waitcnt lgkmcnt(10)
    s_nop 0
    v_mfma_f32_32x32x16_bf16 v[88:103], v[160:163], a[92:95], v[88:103]
    ds_read_b128 a[100:103], v198 offset:49152
    ds_read_b64_tr_b16 v[148:149], v195 offset:10240
    ds_read_b64_tr_b16 v[150:151], v195 offset:10752
    ds_read_b64_tr_b16 v[152:153], v195 offset:18432
    s_add_u32 m0, s85, 151552
    s_add_u32 s56, s83, 315392
    buffer_load_dwordx4 v192, s[16:19], s56 offen lds
    v_mfma_f32_32x32x16_bf16 v[104:119], a[92:95], v[164:167], v[104:119]
    ds_read_b64_tr_b16 v[154:155], v195 offset:18944
    ds_read_b128 v[156:159], v202 offset:12288
    ds_read_b64_tr_b16 a[212:213], v195 offset:2048
    ds_read_b64_tr_b16 a[214:215], v195 offset:2560
    v_mfma_f32_32x32x16_bf16 v[120:135], v[160:163], v[168:171], v[120:135]
    s_waitcnt lgkmcnt(10)
    s_nop 0
    v_mfma_f32_32x32x16_bf16 v[88:103], v[136:139], a[96:99], v[88:103]
    ds_read_b128 a[104:107], v199 offset:49152
    ds_read_b64_tr_b16 v[160:161], v195 offset:12288
    ds_read_b64_tr_b16 v[162:163], v195 offset:12800
    ds_read_b64_tr_b16 v[164:165], v195 offset:20480
    v_mfma_f32_32x32x16_bf16 v[104:119], a[96:99], v[140:143], v[104:119]
    ds_read_b64_tr_b16 v[166:167], v195 offset:20992
    ds_read_b128 v[168:171], v203 offset:12288
    ds_read_b64_tr_b16 a[216:217], v195 offset:4096
    ds_read_b64_tr_b16 a[218:219], v195 offset:4608
    v_mfma_f32_32x32x16_bf16 v[120:135], v[136:139], v[144:147], v[120:135]
    s_waitcnt lgkmcnt(10)
    s_nop 0
    v_mfma_f32_32x32x16_bf16 v[88:103], v[148:151], a[100:103], v[88:103]
    ds_read_b128 a[108:111], v200 offset:49152
    ds_read_b64_tr_b16 v[136:137], v195 offset:14336
    ds_read_b64_tr_b16 v[138:139], v195 offset:14848
    ds_read_b64_tr_b16 v[140:141], v195 offset:22528
    v_mfma_f32_32x32x16_bf16 v[104:119], a[100:103], v[152:155], v[104:119]
    ds_read_b64_tr_b16 v[142:143], v195 offset:23040
    ds_read_b128 v[144:147], v212 offset:12288
    ds_read_b64_tr_b16 a[220:221], v195 offset:6144
    ds_read_b64_tr_b16 a[222:223], v195 offset:6656
    v_mfma_f32_32x32x16_bf16 v[120:135], v[148:151], v[156:159], v[120:135]
    s_waitcnt vmcnt(12)
    s_mov_b32 s50, 0
Lt_9:
    v_and_b32 v14, 0x80808080, v194
    v_cmp_ne_u32 vcc, 0x80808080, v14
    s_cbranch_vccz Lt_10
    s_add_u32 s50, s50, 1
    s_cmp_ge_u32 s50, 0x40000
    s_cbranch_scc1 Lt_10
    s_sleep 16
    buffer_load_dword v194, v193, s[36:39], s49 offen sc1
    s_waitcnt vmcnt(0)
    s_branch Lt_9
Lt_10:
    s_mul_i32 s51, s48, 0x01010101
    v_and_b32 v14, 0x07070707, v194
    v_cmp_ne_u32 vcc, s51, v14
    s_nop 0
    v_readlane_b32 s52, v194, 0
    v_readlane_b32 s53, v194, 1
    s_cmp_eq_u64 vcc, 0
    s_cselect_b32 s45, 1, 0
    s_cselect_b32 s51, 0, 4194304
    s_add_u32 s32, s32, s51
    s_addc_u32 s33, s33, 0
    s_and_b32 s52, s52, 0x78787878
    s_lshr_b32 s52, s52, 3
    s_and_b32 s53, s53, 0x78787878
    s_lshl_b32 s53, s53, 1
    s_or_b32 s46, s52, s53
    s_lshl_b32 s49, s42, 12
    s_add_u32 s71, s82, 65536
    s_add_u32 s72, s82, 323584
    s_add_u32 s73, s82, 585728
    s_add_u32 s74, s82, 600064
    s_add_u32 s75, s82, 294912
    s_add_u32 s76, s82, 528384
    s_add_u32 s77, s82, 542720
    s_waitcnt vmcnt(4)
    s_waitcnt lgkmcnt(0)
    s_barrier
    s_waitcnt lgkmcnt(10)
    v_mfma_f32_32x32x16_bf16 v[88:103], v[160:163], a[104:107], v[88:103]
    s_add_u32 m0, s85, 155648
    s_add_u32 s56, s83, 344064
    buffer_load_dwordx4 v192, s[16:19], s56 offen lds
    v_mfma_f32_32x32x16_bf16 v[104:119], a[104:107], v[164:167], v[104:119]
    s_add_u32 m0, s85, 159744
    s_add_u32 s56, s83, 372736
    buffer_load_dwordx4 v192, s[16:19], s56 offen lds
    v_mfma_f32_32x32x16_bf16 v[120:135], v[160:163], v[168:171], v[120:135]
    s_waitcnt lgkmcnt(2)
    s_nop 0
    v_mfma_f32_32x32x16_bf16 v[88:103], v[136:139], a[108:111], v[88:103]
    v_mfma_f32_32x32x16_bf16 v[104:119], a[108:111], v[140:143], v[104:119]
    v_mfma_f32_32x32x16_bf16 v[120:135], v[136:139], v[144:147], v[120:135]
    v_mfma_f32_32x32x16_bf16 v[72:87], a[112:115], a[0:3], 0
    ds_read_b64_tr_b16 a[224:225], v184 offset:0
    ds_read_b64_tr_b16 a[226:227], v188 offset:0
    ds_read_b64_tr_b16 a[228:229], v185 offset:0
    ds_read_b64_tr_b16 a[230:231], v189 offset:0
    v_mfma_f32_32x32x16_bf16 v[72:87], a[116:119], a[4:7], v[72:87]
    ds_read_b64_tr_b16 a[232:233], v186 offset:0
    ds_read_b64_tr_b16 a[234:235], v190 offset:0
    ds_read_b64_tr_b16 a[236:237], v187 offset:0
    ds_read_b64_tr_b16 a[238:239], v191 offset:0
    v_mfma_f32_32x32x16_bf16 v[72:87], a[120:123], a[8:11], v[72:87]
    v_cvt_pk_bf16_f32 v24, v88, v89
    v_cvt_pk_bf16_f32 v25, v90, v91
    v_cvt_pk_bf16_f32 v26, v92, v93
    v_cvt_pk_bf16_f32 v27, v94, v95
    buffer_store_dwordx4 v[24:27], v254, s[32:35], s72 offen offset:0 sc1
    v_mfma_f32_32x32x16_bf16 v[72:87], a[124:127], a[12:15], v[72:87]
    v_cvt_pk_bf16_f32 v28, v96, v97
    v_cvt_pk_bf16_f32 v29, v98, v99
    v_cvt_pk_bf16_f32 v30, v100, v101
    v_cvt_pk_bf16_f32 v31, v102, v103
    buffer_store_dwordx4 v[28:31], v254, s[32:35], s72 offen offset:512 sc1
    v_mfma_f32_32x32x16_bf16 v[72:87], a[128:131], a[16:19], v[72:87]
    v_cvt_pk_bf16_f32 v32, v104, v105
    v_cvt_pk_bf16_f32 v33, v106, v107
    v_cvt_pk_bf16_f32 v34, v108, v109
    v_cvt_pk_bf16_f32 v35, v110, v111
    buffer_store_dwordx4 v[32:35], v175, s[32:35], s73 offen sc1
    v_mfma_f32_32x32x16_bf16 v[72:87], a[132:135], a[20:23], v[72:87]
    v_cvt_pk_bf16_f32 v36, v112, v113
    v_cvt_pk_bf16_f32 v37, v114, v115
    v_cvt_pk_bf16_f32 v38, v116, v117
    v_cvt_pk_bf16_f32 v39, v118, v119
    buffer_store_dwordx4 v[36:39], v175, s[32:35], s74 offen sc1
    v_mfma_f32_32x32x16_bf16 v[72:87], a[136:139], a[24:27], v[72:87]
    v_cvt_pk_bf16_f32 v40, v120, v121
    v_cvt_pk_bf16_f32 v41, v122, v123
    v_cvt_pk_bf16_f32 v42, v124, v125
    v_cvt_pk_bf16_f32 v43, v126, v127
    buffer_store_dwordx4 v[40:43], v254, s[32:35], s75 offen offset:0 sc1
    v_mfma_f32_32x32x16_bf16 v[72:87], a[140:143], a[28:31], v[72:87]
    v_cvt_pk_bf16_f32 v44, v128, v129
    v_cvt_pk_bf16_f32 v45, v130, v131
    v_cvt_pk_bf16_f32 v46, v132, v133
    v_cvt_pk_bf16_f32 v47, v134, v135
    buffer_store_dwordx4 v[44:47], v254, s[32:35], s75 offen offset:512 sc1
    v_mfma_f32_32x32x16_bf16 v[72:87], a[144:147], a[32:35], v[72:87]
    ds_read_b64_tr_b16 a[240:241], v186 offset:3584
    ds_read_b64_tr_b16 a[242:243], v190 offset:3584
    ds_read_b64_tr_b16 a[244:245], v187 offset:3584
    ds_read_b64_tr_b16 a[246:247], v191 offset:3584
    v_mfma_f32_32x32x16_bf16 v[72:87], a[148:151], a[36:39], v[72:87]
    ds_read_b64_tr_b16 a[248:249], v184 offset:3584
    ds_read_b64_tr_b16 a[250:251], v188 offset:3584
    ds_read_b64_tr_b16 a[252:253], v185 offset:3584
    ds_read_b64_tr_b16 a[254:255], v189 offset:3584
    v_mfma_f32_32x32x16_bf16 v[72:87], a[152:155], a[40:43], v[72:87]
    ds_read_b64_tr_b16 a[0:1], v184 offset:7168
    ds_read_b64_tr_b16 a[2:3], v188 offset:7168
    ds_read_b64_tr_b16 a[112:113], v185 offset:7168
    ds_read_b64_tr_b16 a[114:115], v189 offset:7168
    v_mfma_f32_32x32x16_bf16 v[72:87], a[156:159], a[44:47], v[72:87]
    ds_read_b64_tr_b16 a[4:5], v186 offset:7168
    ds_read_b64_tr_b16 a[6:7], v190 offset:7168
    ds_read_b64_tr_b16 a[116:117], v187 offset:7168
    ds_read_b64_tr_b16 a[118:119], v191 offset:7168
    v_mfma_f32_32x32x16_bf16 v[72:87], a[160:163], a[48:51], v[72:87]
    ds_read_b64_tr_b16 a[8:9], v186 offset:10752
    ds_read_b64_tr_b16 a[10:11], v190 offset:10752
    ds_read_b64_tr_b16 a[120:121], v187 offset:10752
    ds_read_b64_tr_b16 a[122:123], v191 offset:10752
    v_mfma_f32_32x32x16_bf16 v[72:87], a[164:167], a[52:55], v[72:87]
    ds_read_b64_tr_b16 a[12:13], v184 offset:10752
    ds_read_b64_tr_b16 a[14:15], v188 offset:10752
    ds_read_b64_tr_b16 a[124:125], v185 offset:10752
    ds_read_b64_tr_b16 a[126:127], v189 offset:10752
    v_mfma_f32_32x32x16_bf16 v[72:87], a[168:171], a[56:59], v[72:87]
    ds_read_b64_tr_b16 a[16:17], v184 offset:14336
    ds_read_b64_tr_b16 a[18:19], v188 offset:14336
    ds_read_b64_tr_b16 a[128:129], v185 offset:14336
    ds_read_b64_tr_b16 a[130:131], v189 offset:14336
    v_mfma_f32_32x32x16_bf16 v[72:87], a[172:175], a[60:63], v[72:87]
    ds_read_b64_tr_b16 a[20:21], v186 offset:14336
    ds_read_b64_tr_b16 a[22:23], v190 offset:14336
    ds_read_b64_tr_b16 a[132:133], v187 offset:14336
    ds_read_b64_tr_b16 a[134:135], v191 offset:14336
    v_mfma_f32_32x32x16_bf16 v[72:87], a[176:179], a[64:67], v[72:87]
    ds_read_b64_tr_b16 a[24:25], v186 offset:17920
    ds_read_b64_tr_b16 a[26:27], v190 offset:17920
    ds_read_b64_tr_b16 a[136:137], v187 offset:17920
    ds_read_b64_tr_b16 a[138:139], v191 offset:17920
    v_mfma_f32_32x32x16_bf16 v[72:87], a[180:183], a[68:71], v[72:87]
    ds_read_b64_tr_b16 a[28:29], v184 offset:17920
    ds_read_b64_tr_b16 a[30:31], v188 offset:17920
    ds_read_b64_tr_b16 a[140:141], v185 offset:17920
    ds_read_b64_tr_b16 a[142:143], v189 offset:17920
    v_mfma_f32_32x32x16_bf16 v[72:87], a[184:187], a[72:75], v[72:87]
    ds_read_b64_tr_b16 a[32:33], v184 offset:21504
    ds_read_b64_tr_b16 a[34:35], v188 offset:21504
    ds_read_b64_tr_b16 a[144:145], v185 offset:21504
    ds_read_b64_tr_b16 a[146:147], v189 offset:21504
    v_mfma_f32_32x32x16_bf16 v[72:87], a[188:191], a[76:79], v[72:87]
    ds_read_b64_tr_b16 a[36:37], v186 offset:21504
    ds_read_b64_tr_b16 a[38:39], v190 offset:21504
    ds_read_b64_tr_b16 a[148:149], v187 offset:21504
    ds_read_b64_tr_b16 a[150:151], v191 offset:21504
    v_mfma_f32_32x32x16_bf16 v[72:87], a[192:195], a[80:83], v[72:87]
    ds_read_b64_tr_b16 a[40:41], v186 offset:25088
    ds_read_b64_tr_b16 a[42:43], v190 offset:25088
    ds_read_b64_tr_b16 a[152:153], v187 offset:25088
    ds_read_b64_tr_b16 a[154:155], v191 offset:25088
    v_mfma_f32_32x32x16_bf16 v[72:87], a[196:199], a[84:87], v[72:87]
    ds_read_b64_tr_b16 a[44:45], v184 offset:25088
    ds_read_b64_tr_b16 a[46:47], v188 offset:25088
    ds_read_b64_tr_b16 a[156:157], v185 offset:25088
    ds_read_b64_tr_b16 a[158:159], v189 offset:25088
    v_mfma_f32_32x32x16_bf16 v[72:87], a[200:203], a[88:91], v[72:87]
    ds_read_b64_tr_b16 a[48:49], v184 offset:28672
    ds_read_b64_tr_b16 a[50:51], v188 offset:28672
    ds_read_b64_tr_b16 a[160:161], v185 offset:28672
    ds_read_b64_tr_b16 a[162:163], v189 offset:28672
    v_mfma_f32_32x32x16_bf16 v[72:87], a[204:207], a[92:95], v[72:87]
    ds_read_b64_tr_b16 a[52:53], v186 offset:28672
    ds_read_b64_tr_b16 a[54:55], v190 offset:28672
    ds_read_b64_tr_b16 a[164:165], v187 offset:28672
    ds_read_b64_tr_b16 a[166:167], v191 offset:28672
    v_mfma_f32_32x32x16_bf16 v[72:87], a[208:211], a[96:99], v[72:87]
    v_mfma_f32_32x32x16_bf16 v[72:87], a[212:215], a[100:103], v[72:87]
    v_mfma_f32_32x32x16_bf16 v[72:87], a[216:219], a[104:107], v[72:87]
    v_mfma_f32_32x32x16_bf16 v[72:87], a[220:223], a[108:111], v[72:87]
    s_cmp_eq_u32 s45, 0
    s_cbranch_scc1 Ls_11
    s_nop 9
    s_nop 0
    v_cvt_pk_bf16_f32 v16, v72, v73
    v_cvt_pk_bf16_f32 v17, v74, v75
    v_cvt_pk_bf16_f32 v18, v76, v77
    v_cvt_pk_bf16_f32 v19, v78, v79
    buffer_store_dwordx4 v[16:19], v254, s[32:35], s71 offen offset:0
    v_cvt_pk_bf16_f32 v20, v80, v81
    v_cvt_pk_bf16_f32 v21, v82, v83
    v_cvt_pk_bf16_f32 v22, v84, v85
    v_cvt_pk_bf16_f32 v23, v86, v87
    buffer_store_dwordx4 v[20:23], v254, s[32:35], s71 offen offset:512
    s_branch Ls_12
Ls_11:
    s_nop 7
    s_nop 3
    s_nop 0
    v_cvt_pk_bf16_f32 v16, v72, v73
    v_cvt_pk_bf16_f32 v17, v74, v75
    v_cvt_pk_bf16_f32 v18, v76, v77
    v_cvt_pk_bf16_f32 v19, v78, v79
    buffer_store_dwordx4 v[16:19], v254, s[32:35], s71 offen offset:0 sc1
    v_cvt_pk_bf16_f32 v20, v80, v81
    v_cvt_pk_bf16_f32 v21, v82, v83
    v_cvt_pk_bf16_f32 v22, v84, v85
    v_cvt_pk_bf16_f32 v23, v86, v87
    buffer_store_dwordx4 v[20:23], v254, s[32:35], s71 offen offset:512 sc1
Ls_12:
    s_branch L_att
L_Av:
    s_nop 0
    ds_read_b128 a[0:3], v197 offset:0
    ds_read_b64_tr_b16 v[136:137], v195 offset:8192
    ds_read_b64_tr_b16 v[138:139], v195 offset:8704
    ds_read_b64_tr_b16 v[140:141], v195 offset:16384
    ds_read_b64_tr_b16 v[142:143], v195 offset:16896
    ds_read_b128 v[144:147], v201 offset:0
    ds_read_b64_tr_b16 a[112:113], v195 offset:0
    ds_read_b64_tr_b16 a[114:115], v195 offset:512
    ds_read_b128 a[4:7], v198 offset:0
    ds_read_b64_tr_b16 v[148:149], v195 offset:10240
    ds_read_b64_tr_b16 v[150:151], v195 offset:10752
    ds_read_b64_tr_b16 v[152:153], v195 offset:18432
    ds_read_b64_tr_b16 v[154:155], v195 offset:18944
    ds_read_b128 v[156:159], v202 offset:0
    ds_read_b64_tr_b16 a[116:117], v195 offset:2048
    ds_read_b64_tr_b16 a[118:119], v195 offset:2560
    s_waitcnt lgkmcnt(10)
    s_nop 0
    v_mfma_f32_32x32x16_bf16 v[88:103], v[136:139], a[0:3], 0
    ds_read_b128 a[8:11], v199 offset:0
    ds_read_b64_tr_b16 v[160:161], v195 offset:12288
    ds_read_b64_tr_b16 v[162:163], v195 offset:12800
    ds_read_b64_tr_b16 v[164:165], v195 offset:20480
    v_mfma_f32_32x32x16_bf16 v[104:119], a[0:3], v[140:143], 0
    ds_read_b64_tr_b16 v[166:167], v195 offset:20992
    ds_read_b128 v[168:171], v203 offset:0
    ds_read_b64_tr_b16 a[120:121], v195 offset:4096
    ds_read_b64_tr_b16 a[122:123], v195 offset:4608
    v_mfma_f32_32x32x16_bf16 v[120:135], v[144:147], v[140:143], 0
    s_waitcnt lgkmcnt(10)
    s_nop 0
    v_mfma_f32_32x32x16_bf16 v[88:103], v[148:151], a[4:7], v[88:103]
    ds_read_b128 a[12:15], v200 offset:0
    ds_read_b64_tr_b16 v[136:137], v195 offset:14336
    ds_read_b64_tr_b16 v[138:139], v195 offset:14848
    ds_read_b64_tr_b16 v[140:141], v195 offset:22528
    v_mfma_f32_32x32x16_bf16 v[104:119], a[4:7], v[152:155], v[104:119]
    ds_read_b64_tr_b16 v[142:143], v195 offset:23040
    ds_read_b128 v[144:147], v212 offset:0
    ds_read_b64_tr_b16 a[124:125], v195 offset:6144
    ds_read_b64_tr_b16 a[126:127], v195 offset:6656
    v_and_b32_e64 v64, 15, v0
    v_lshrrev_b32 v65, 5, v0
    v_bfe_u32 v67, v0, 4, 1
    s_lshl_b32 s62, s57, 7
    s_add_u32 s62, s62, 4096
    s_mul_i32 s68, s57, 28672
    s_add_u32 s68, s68, 323584
    v_mfma_f32_32x32x16_bf16 v[120:135], v[156:159], v[152:155], v[120:135]
    s_waitcnt vmcnt(7)
    s_waitcnt lgkmcnt(0)
    s_barrier
    s_waitcnt lgkmcnt(10)
    v_mfma_f32_32x32x16_bf16 v[88:103], v[160:163], a[8:11], v[88:103]
    ds_read_b128 a[16:19], v197 offset:8192
    ds_read_b64_tr_b16 v[148:149], v195 offset:32768
    ds_read_b64_tr_b16 v[150:151], v195 offset:33280
    ds_read_b64_tr_b16 v[152:153], v195 offset:40960
    s_add_u32 m0, s79, 7296
    s_nop 0
    s_nop 0
    buffer_load_dwordx4 v173, s[12:15], s74 offen offset:896 lds
    v_mfma_f32_32x32x16_bf16 v[104:119], a[8:11], v[164:167], v[104:119]
    ds_read_b64_tr_b16 v[154:155], v195 offset:41472
    ds_read_b128 v[156:159], v201 offset:2048
    ds_read_b64_tr_b16 a[128:129], v195 offset:24576
    ds_read_b64_tr_b16 a[130:131], v195 offset:25088
    buffer_load_dwordx4 v174, s[12:15], s74 offen offset:1920 lds
    s_mul_i32 s69, s57, 7
    s_add_u32 s69, s69, s58
    s_cmp_ge_u32 s58, 7
    s_cselect_b32 s50, 49, 0
    s_add_u32 s69, s69, s50
    s_lshl_b32 s69, s69, 12
    s_add_u32 s69, s69, 1048576
    s_lshr_b32 s59, s57, 1
    s_lshl_b32 s59, s59, 4
    s_add_u32 s59, s59, s58
    s_lshl_b32 s59, s59, 1
    s_and_b32 s50, s42, 1
    s_add_u32 s59, s59, s50
    s_lshl_b32 s59, s59, 2
    s_add_u32 s59, s59, 6144
    v_mfma_f32_32x32x16_bf16 v[120:135], v[168:171], v[164:167], v[120:135]
    s_waitcnt lgkmcnt(10)
    v_mfma_f32_32x32x16_bf16 v[88:103], v[136:139], a[12:15], v[88:103]
    ds_read_b128 a[20:23], v198 offset:8192
    ds_read_b64_tr_b16 v[160:161], v195 offset:34816
    ds_read_b64_tr_b16 v[162:163], v195 offset:35328
    ds_read_b64_tr_b16 v[164:165], v195 offset:43008
    s_add_u32 m0, s79, 14592
    s_nop 0
    s_nop 0
    buffer_load_dwordx4 v173, s[12:15], s74 offen offset:1792 lds
    v_mfma_f32_32x32x16_bf16 v[104:119], a[12:15], v[140:143], v[104:119]
    ds_read_b64_tr_b16 v[166:167], v195 offset:43520
    ds_read_b128 v[168:171], v202 offset:2048
    ds_read_b64_tr_b16 a[132:133], v195 offset:26624
    ds_read_b64_tr_b16 a[134:135], v195 offset:27136
    buffer_load_dwordx4 v174, s[12:15], s74 offen offset:2816 lds
    v_subrev_u32 v4, 106496, v184
    v_xor_b32 v5, 32, v4
    v_mfma_f32_32x32x16_bf16 v[120:135], v[144:147], v[140:143], v[120:135]
    s_waitcnt lgkmcnt(10)
    v_mfma_f32_32x32x16_bf16 v[88:103], v[148:151], a[16:19], v[88:103]
    ds_read_b128 a[24:27], v199 offset:8192
    ds_read_b64_tr_b16 v[136:137], v195 offset:36864
    ds_read_b64_tr_b16 v[138:139], v195 offset:37376
    ds_read_b64_tr_b16 v[140:141], v195 offset:45056
    s_add_u32 m0, s79, 0
    s_nop 0
    buffer_load_dwordx4 v173, s[12:15], s74 offen offset:0 lds
    v_mfma_f32_32x32x16_bf16 v[104:119], a[16:19], v[152:155], v[104:119]
    ds_read_b64_tr_b16 v[142:143], v195 offset:45568
    ds_read_b128 v[144:147], v203 offset:2048
    ds_read_b64_tr_b16 a[136:137], v195 offset:28672
    ds_read_b64_tr_b16 a[138:139], v195 offset:29184
    buffer_load_dwordx4 v174, s[12:15], s74 offen offset:1024 lds
    v_xor_b32 v6, 64, v4
    v_xor_b32 v7, 96, v4
    v_mfma_f32_32x32x16_bf16 v[120:135], v[156:159], v[152:155], v[120:135]
    s_waitcnt lgkmcnt(10)
    v_mfma_f32_32x32x16_bf16 v[88:103], v[160:163], a[20:23], v[88:103]
    ds_read_b128 a[28:31], v200 offset:8192
    ds_read_b64_tr_b16 v[148:149], v195 offset:38912
    ds_read_b64_tr_b16 v[150:151], v195 offset:39424
    ds_read_b64_tr_b16 v[152:153], v195 offset:47104
    v_mfma_f32_32x32x16_bf16 v[104:119], a[20:23], v[164:167], v[104:119]
    ds_read_b64_tr_b16 v[154:155], v195 offset:47616
    ds_read_b128 v[156:159], v212 offset:2048
    ds_read_b64_tr_b16 a[140:141], v195 offset:30720
    ds_read_b64_tr_b16 a[142:143], v195 offset:31232
    v_add_u32 v8, 65536, v4
    v_add_u32 v9, 65536, v5
    v_mfma_f32_32x32x16_bf16 v[120:135], v[168:171], v[164:167], v[120:135]
    s_waitcnt vmcnt(7)
    s_waitcnt lgkmcnt(0)
    s_barrier
    s_waitcnt lgkmcnt(10)
    v_mfma_f32_32x32x16_bf16 v[88:103], v[136:139], a[24:27], v[88:103]
    ds_read_b128 a[32:35], v197 offset:16384
    ds_read_b64_tr_b16 v[160:161], v196 offset:8192
    ds_read_b64_tr_b16 v[162:163], v196 offset:8704
    ds_read_b64_tr_b16 v[164:165], v196 offset:16384
    s_add_u32 m0, s79, 31872
    s_nop 0
    s_nop 0
    buffer_load_dwordx4 v173, s[12:15], s75 offen offset:896 lds
    v_mfma_f32_32x32x16_bf16 v[104:119], a[24:27], v[140:143], v[104:119]
    ds_read_b64_tr_b16 v[166:167], v196 offset:16896
    ds_read_b128 v[168:171], v201 offset:4096
    ds_read_b64_tr_b16 a[144:145], v196 offset:0
    ds_read_b64_tr_b16 a[146:147], v196 offset:512
    buffer_load_dwordx4 v174, s[12:15], s75 offen offset:1920 lds
    v_add_u32 v10, 65536, v6
    v_add_u32 v11, 65536, v7
    v_mfma_f32_32x32x16_bf16 v[120:135], v[144:147], v[140:143], v[120:135]
    s_waitcnt lgkmcnt(10)
    v_mfma_f32_32x32x16_bf16 v[88:103], v[148:151], a[28:31], v[88:103]
    ds_read_b128 a[36:39], v198 offset:16384
    ds_read_b64_tr_b16 v[136:137], v196 offset:10240
    ds_read_b64_tr_b16 v[138:139], v196 offset:10752
    ds_read_b64_tr_b16 v[140:141], v196 offset:18432
    s_add_u32 m0, s79, 39168
    s_nop 0
    buffer_load_dwordx4 v173, s[12:15], s75 offen offset:1792 lds
    v_mfma_f32_32x32x16_bf16 v[104:119], a[28:31], v[152:155], v[104:119]
    ds_read_b64_tr_b16 v[142:143], v196 offset:18944
    ds_read_b128 v[144:147], v202 offset:4096
    ds_read_b64_tr_b16 a[148:149], v196 offset:2048
    ds_read_b64_tr_b16 a[150:151], v196 offset:2560
    buffer_load_dwordx4 v174, s[12:15], s75 offen offset:2816 lds
    v_and_b32 v14, 7, v0
    v_min_u32 v14, 6, v14
    v_and_b32 v15, 8, v0
    v_or_b32 v14, v14, v15
    v_lshlrev_b32 v234, 2, v14
    v_lshrrev_b32 v14, 3, v0
    v_and_b32 v15, 6, v14
    v_xor_b32 v15, v0, v15
    v_and_b32 v15, 7, v15
    v_mul_u32_u24 v14, 896, v14
    v_lshl_add_u32 v244, v15, 4, v14
    v_mfma_f32_32x32x16_bf16 v[120:135], v[156:159], v[152:155], v[120:135]
    s_waitcnt lgkmcnt(10)
    v_mfma_f32_32x32x16_bf16 v[88:103], v[160:163], a[32:35], v[88:103]
    ds_read_b128 a[40:43], v199 offset:16384
    ds_read_b64_tr_b16 v[148:149], v196 offset:12288
    ds_read_b64_tr_b16 v[150:151], v196 offset:12800
    ds_read_b64_tr_b16 v[152:153], v196 offset:20480
    s_add_u32 m0, s79, 24576
    s_nop 0
    s_nop 0
    buffer_load_dwordx4 v173, s[12:15], s75 offen offset:0 lds
    v_mfma_f32_32x32x16_bf16 v[104:119], a[32:35], v[164:167], v[104:119]
    ds_read_b64_tr_b16 v[154:155], v196 offset:20992
    ds_read_b128 v[156:159], v203 offset:4096
    ds_read_b64_tr_b16 a[152:153], v196 offset:4096
    ds_read_b64_tr_b16 a[154:155], v196 offset:4608
    buffer_load_dwordx4 v174, s[12:15], s75 offen offset:1024 lds
    v_add_u32 v245, 6144, v244
    v_add_u32 v246, 12288, v244
    v_mfma_f32_32x32x16_bf16 v[120:135], v[168:171], v[164:167], v[120:135]
    s_waitcnt lgkmcnt(10)
    s_nop 0
    v_mfma_f32_32x32x16_bf16 v[88:103], v[136:139], a[36:39], v[88:103]
    ds_read_b128 a[44:47], v200 offset:16384
    ds_read_b64_tr_b16 v[160:161], v196 offset:14336
    ds_read_b64_tr_b16 v[162:163], v196 offset:14848
    ds_read_b64_tr_b16 v[164:165], v196 offset:22528
    v_mfma_f32_32x32x16_bf16 v[104:119], a[36:39], v[140:143], v[104:119]
    ds_read_b64_tr_b16 v[166:167], v196 offset:23040
    ds_read_b128 v[168:171], v212 offset:4096
    ds_read_b64_tr_b16 a[156:157], v196 offset:6144
    ds_read_b64_tr_b16 a[158:159], v196 offset:6656
    v_add_u32 v247, 18432, v244
    s_mul_i32 s70, s42, 401408
    s_lshl_b32 s50, s44, 7
    s_add_u32 s70, s70, s50
    s_add_u32 s50, s89, 131072
    v_add_u32 v12, 14336, v253
    v_add_u32 v248, s50, v4
    v_add_u32 v249, s50, v5
    v_add_u32 v250, s50, v6
    v_add_u32 v251, s50, v7
    v_mfma_f32_32x32x16_bf16 v[120:135], v[144:147], v[140:143], v[120:135]
    s_waitcnt vmcnt(6)
    s_waitcnt lgkmcnt(0)
    s_barrier
    s_waitcnt lgkmcnt(10)
    v_mfma_f32_32x32x16_bf16 v[88:103], v[148:151], a[40:43], v[88:103]
    ds_read_b128 a[48:51], v197 offset:24576
    ds_read_b64_tr_b16 v[136:137], v195 offset:8192
    ds_read_b64_tr_b16 v[138:139], v195 offset:8704
    ds_read_b64_tr_b16 v[140:141], v195 offset:16384
    s_add_u32 m0, s79, 56448
    s_nop 0
    s_nop 0
    buffer_load_dwordx4 v173, s[12:15], s76 offen offset:896 lds
    v_mfma_f32_32x32x16_bf16 v[104:119], a[40:43], v[152:155], v[104:119]
    ds_read_b64_tr_b16 v[142:143], v195 offset:16896
    ds_read_b128 v[144:147], v201 offset:6144
    ds_read_b64_tr_b16 a[160:161], v195 offset:0
    ds_read_b64_tr_b16 a[162:163], v195 offset:512
    buffer_load_dwordx4 v174, s[12:15], s76 offen offset:1920 lds
    s_add_u32 s50, s89, 131072
    v_mul_u32_u24 v213, 144, v2
    v_lshl_add_u32 v213, v3, 4, v213
    v_add_u32_e64 v213, s50, v213
    v_mul_u32_u24 v214, 144, v64
    v_lshrrev_b32_e64 v14, 4, v0
    v_lshl_add_u32 v214, v14, 3, v214
    v_add_u32 v214, s50, v214
    v_mfma_f32_32x32x16_bf16 v[120:135], v[156:159], v[152:155], v[120:135]
    s_waitcnt lgkmcnt(10)
    v_mfma_f32_32x32x16_bf16 v[88:103], v[160:163], a[44:47], v[88:103]
    ds_read_b128 a[52:55], v198 offset:24576
    ds_read_b64_tr_b16 v[148:149], v195 offset:10240
    ds_read_b64_tr_b16 v[150:151], v195 offset:10752
    ds_read_b64_tr_b16 v[152:153], v195 offset:18432
    s_add_u32 m0, s79, 63744
    s_nop 0
    s_nop 0
    buffer_load_dwordx4 v173, s[12:15], s76 offen offset:1792 lds
    v_mfma_f32_32x32x16_bf16 v[104:119], a[44:47], v[164:167], v[104:119]
    ds_read_b64_tr_b16 v[154:155], v195 offset:18944
    ds_read_b128 v[156:159], v202 offset:6144
    ds_read_b64_tr_b16 a[164:165], v195 offset:2048
    ds_read_b64_tr_b16 a[166:167], v195 offset:2560
    buffer_load_dwordx4 v174, s[12:15], s76 offen offset:2816 lds
    v_lshrrev_b32_e64 v14, 3, v0
    v_mul_u32_u24 v215, 144, v14
    v_and_b32_e64 v14, 7, v0
    v_lshl_add_u32 v215, v14, 4, v215
    v_add_u32 v215, s50, v215
    v_lshlrev_b32 v232, 4, v64
    s_lshl_b32 s52, s43, 2
    s_add_u32 s52, s52, s42
    s_mul_i32 s64, s52, 14336
    s_lshl_b32 s50, s44, 11
    s_add_u32 s65, s64, s50
    s_add_u32 s65, s65, 323584
    s_add_u32 s64, s64, 65536
    v_mfma_f32_32x32x16_bf16 v[120:135], v[168:171], v[164:167], v[120:135]
    s_waitcnt lgkmcnt(10)
    v_mfma_f32_32x32x16_bf16 v[88:103], v[136:139], a[48:51], v[88:103]
    ds_read_b128 a[56:59], v199 offset:24576
    ds_read_b64_tr_b16 v[160:161], v195 offset:12288
    ds_read_b64_tr_b16 v[162:163], v195 offset:12800
    ds_read_b64_tr_b16 v[164:165], v195 offset:20480
    s_add_u32 m0, s79, 49152
    s_nop 0
    buffer_load_dwordx4 v173, s[12:15], s76 offen offset:0 lds
    v_mfma_f32_32x32x16_bf16 v[104:119], a[48:51], v[140:143], v[104:119]
    ds_read_b64_tr_b16 v[166:167], v195 offset:20992
    ds_read_b128 v[168:171], v203 offset:6144
    ds_read_b64_tr_b16 a[168:169], v195 offset:4096
    ds_read_b64_tr_b16 a[170:171], v195 offset:4608
    buffer_load_dwordx4 v174, s[12:15], s76 offen offset:1024 lds
    s_mul_i32 s67, s52, 1792
    s_add_u32 s67, s67, 16384
    s_lshl_b32 s50, s44, 8
    s_add_u32 s66, s67, s50
    s_lshr_b32 s53, s52, 1
    s_and_b32 s51, s42, 1
    s_lshl_b32 s47, s53, 2
    s_add_u32 s47, s47, s51
    s_lshl_b32 s47, s47, 3
    s_add_u32 s47, s47, s44
    s_lshl_b32 s47, s47, 2
    s_add_u32 s47, s47, 4096
    v_mfma_f32_32x32x16_bf16 v[120:135], v[144:147], v[140:143], v[120:135]
    s_waitcnt lgkmcnt(10)
    v_mfma_f32_32x32x16_bf16 v[88:103], v[148:151], a[52:55], v[88:103]
    ds_read_b128 a[60:63], v200 offset:24576
    ds_read_b64_tr_b16 v[136:137], v195 offset:14336
    ds_read_b64_tr_b16 v[138:139], v195 offset:14848
    ds_read_b64_tr_b16 v[140:141], v195 offset:22528
    s_lshl_b32 s55, s44, 7
    s_add_u32 s55, s55, s86
    buffer_load_dwordx4 v[204:207], v172, s[8:11], s55 offen offset:0
    v_mfma_f32_32x32x16_bf16 v[104:119], a[52:55], v[152:155], v[104:119]
    ds_read_b64_tr_b16 v[142:143], v195 offset:23040
    ds_read_b128 v[144:147], v212 offset:6144
    ds_read_b64_tr_b16 a[172:173], v195 offset:6144
    ds_read_b64_tr_b16 a[174:175], v195 offset:6656
    buffer_load_dwordx4 v[208:211], v172, s[8:11], s55 offen offset:64
    s_lshl_b32 s60, s43, 1
    s_add_u32 s60, s60, s51
    s_lshl_b32 s60, s60, 7
    s_add_u32 s60, s60, 2048
    s_cmp_lt_u32 s43, 3
    s_cselect_b32 s50, 16, 0
    v_and_b32 v14, s50, v0
    v_lshlrev_b32_e64 v233, 2, v64
    v_lshl_add_u32 v233, v14, 4, v233
    v_mfma_f32_32x32x16_bf16 v[120:135], v[156:159], v[152:155], v[120:135]
    s_waitcnt vmcnt(8)
    s_waitcnt lgkmcnt(0)
    s_barrier
    s_waitcnt lgkmcnt(10)
    v_mfma_f32_32x32x16_bf16 v[88:103], v[160:163], a[56:59], v[88:103]
    ds_read_b128 a[64:67], v197 offset:32768
    ds_read_b64_tr_b16 v[148:149], v195 offset:32768
    ds_read_b64_tr_b16 v[150:151], v195 offset:33280
    ds_read_b64_tr_b16 v[152:153], v195 offset:40960
    s_add_u32 m0, s79, 7296
    s_nop 0
    s_nop 0
    buffer_load_dwordx4 v173, s[12:15], s77 offen offset:896 lds
    v_mfma_f32_32x32x16_bf16 v[104:119], a[56:59], v[164:167], v[104:119]
    ds_read_b64_tr_b16 v[154:155], v195 offset:41472
    ds_read_b128 v[156:159], v201 offset:8192
    ds_read_b64_tr_b16 a[176:177], v195 offset:24576
    ds_read_b64_tr_b16 a[178:179], v195 offset:25088
    buffer_load_dwordx4 v174, s[12:15], s77 offen offset:1920 lds
    v_mfma_f32_32x32x16_bf16 v[120:135], v[168:171], v[164:167], v[120:135]
    s_waitcnt lgkmcnt(10)
    v_mfma_f32_32x32x16_bf16 v[88:103], v[136:139], a[60:63], v[88:103]
    ds_read_b128 a[68:71], v198 offset:32768
    ds_read_b64_tr_b16 v[160:161], v195 offset:34816
    ds_read_b64_tr_b16 v[162:163], v195 offset:35328
    ds_read_b64_tr_b16 v[164:165], v195 offset:43008
    s_add_u32 m0, s79, 14592
    s_nop 0
    buffer_load_dwordx4 v173, s[12:15], s77 offen offset:1792 lds
    v_mfma_f32_32x32x16_bf16 v[104:119], a[60:63], v[140:143], v[104:119]
    ds_read_b64_tr_b16 v[166:167], v195 offset:43520
    ds_read_b128 v[168:171], v202 offset:8192
    ds_read_b64_tr_b16 a[180:181], v195 offset:26624
    ds_read_b64_tr_b16 a[182:183], v195 offset:27136
    buffer_load_dwordx4 v174, s[12:15], s77 offen offset:2816 lds
    v_mfma_f32_32x32x16_bf16 v[120:135], v[144:147], v[140:143], v[120:135]
    s_waitcnt lgkmcnt(10)
    s_nop 0
    v_mfma_f32_32x32x16_bf16 v[88:103], v[148:151], a[64:67], v[88:103]
    ds_read_b128 a[72:75], v199 offset:32768
    ds_read_b64_tr_b16 v[136:137], v195 offset:36864
    ds_read_b64_tr_b16 v[138:139], v195 offset:37376
    ds_read_b64_tr_b16 v[140:141], v195 offset:45056
    s_add_u32 m0, s79, 0
    s_nop 0
    buffer_load_dwordx4 v173, s[12:15], s77 offen offset:0 lds
    v_mfma_f32_32x32x16_bf16 v[104:119], a[64:67], v[152:155], v[104:119]
    ds_read_b64_tr_b16 v[142:143], v195 offset:45568
    ds_read_b128 v[144:147], v203 offset:8192
    ds_read_b64_tr_b16 a[184:185], v195 offset:28672
    ds_read_b64_tr_b16 a[186:187], v195 offset:29184
    buffer_load_dwordx4 v174, s[12:15], s77 offen offset:1024 lds
    v_mfma_f32_32x32x16_bf16 v[120:135], v[156:159], v[152:155], v[120:135]
    s_waitcnt lgkmcnt(10)
    s_nop 0
    v_mfma_f32_32x32x16_bf16 v[88:103], v[160:163], a[68:71], v[88:103]
    ds_read_b128 a[76:79], v200 offset:32768
    ds_read_b64_tr_b16 v[148:149], v195 offset:38912
    ds_read_b64_tr_b16 v[150:151], v195 offset:39424
    ds_read_b64_tr_b16 v[152:153], v195 offset:47104
    buffer_load_dword v194, v193, s[36:39], s49 offen sc1
    v_mfma_f32_32x32x16_bf16 v[104:119], a[68:71], v[164:167], v[104:119]
    ds_read_b64_tr_b16 v[154:155], v195 offset:47616
    ds_read_b128 v[156:159], v212 offset:8192
    ds_read_b64_tr_b16 a[188:189], v195 offset:30720
    ds_read_b64_tr_b16 a[190:191], v195 offset:31232
    s_add_u32 m0, s85, 106496
    s_add_u32 s56, s83, 0
    s_nop 0
    buffer_load_dwordx4 v192, s[16:19], s56 offen lds
    v_mfma_f32_32x32x16_bf16 v[120:135], v[168:171], v[164:167], v[120:135]
    s_waitcnt vmcnt(10)
    s_waitcnt lgkmcnt(0)
    s_barrier
    s_waitcnt lgkmcnt(10)
    v_mfma_f32_32x32x16_bf16 v[88:103], v[136:139], a[72:75], v[88:103]
    ds_read_b128 a[80:83], v197 offset:40960
    ds_read_b64_tr_b16 v[160:161], v196 offset:8192
    ds_read_b64_tr_b16 v[162:163], v196 offset:8704
    ds_read_b64_tr_b16 v[164:165], v196 offset:16384
    s_add_u32 m0, s85, 110592
    s_add_u32 s56, s83, 28672
    buffer_load_dwordx4 v192, s[16:19], s56 offen lds
    v_mfma_f32_32x32x16_bf16 v[104:119], a[72:75], v[140:143], v[104:119]
    ds_read_b64_tr_b16 v[166:167], v196 offset:16896
    ds_read_b128 v[168:171], v201 offset:10240
    ds_read_b64_tr_b16 a[192:193], v196 offset:0
    ds_read_b64_tr_b16 a[194:195], v196 offset:512
    s_add_u32 m0, s85, 114688
    s_add_u32 s56, s83, 57344
    buffer_load_dwordx4 v192, s[16:19], s56 offen lds
    v_mfma_f32_32x32x16_bf16 v[120:135], v[144:147], v[140:143], v[120:135]
    s_waitcnt lgkmcnt(10)
    s_nop 0
    v_mfma_f32_32x32x16_bf16 v[88:103], v[148:151], a[76:79], v[88:103]
    ds_read_b128 a[84:87], v198 offset:40960
    ds_read_b64_tr_b16 v[136:137], v196 offset:10240
    ds_read_b64_tr_b16 v[138:139], v196 offset:10752
    ds_read_b64_tr_b16 v[140:141], v196 offset:18432
    s_add_u32 m0, s85, 118784
    s_add_u32 s56, s83, 86016
    buffer_load_dwordx4 v192, s[16:19], s56 offen lds
    v_mfma_f32_32x32x16_bf16 v[104:119], a[76:79], v[152:155], v[104:119]
    ds_read_b64_tr_b16 v[142:143], v196 offset:18944
    ds_read_b128 v[144:147], v202 offset:10240
    ds_read_b64_tr_b16 a[196:197], v196 offset:2048
    ds_read_b64_tr_b16 a[198:199], v196 offset:2560
    s_add_u32 m0, s85, 122880
    s_add_u32 s56, s83, 114688
    buffer_load_dwordx4 v192, s[16:19], s56 offen lds
    v_mfma_f32_32x32x16_bf16 v[120:135], v[156:159], v[152:155], v[120:135]
    s_waitcnt lgkmcnt(10)
    s_nop 0
    v_mfma_f32_32x32x16_bf16 v[88:103], v[160:163], a[80:83], v[88:103]
    ds_read_b128 a[88:91], v199 offset:40960
    ds_read_b64_tr_b16 v[148:149], v196 offset:12288
    ds_read_b64_tr_b16 v[150:151], v196 offset:12800
    ds_read_b64_tr_b16 v[152:153], v196 offset:20480
    s_add_u32 m0, s85, 126976
    s_add_u32 s56, s83, 143360
    buffer_load_dwordx4 v192, s[16:19], s56 offen lds
    v_mfma_f32_32x32x16_bf16 v[104:119], a[80:83], v[164:167], v[104:119]
    ds_read_b64_tr_b16 v[154:155], v196 offset:20992
    ds_read_b128 v[156:159], v203 offset:10240
    ds_read_b64_tr_b16 a[200:201], v196 offset:4096
    ds_read_b64_tr_b16 a[202:203], v196 offset:4608
    s_add_u32 m0, s85, 131072
    s_add_u32 s56, s83, 172032
    buffer_load_dwordx4 v192, s[16:19], s56 offen lds
    v_mfma_f32_32x32x16_bf16 v[120:135], v[168:171], v[164:167], v[120:135]
    s_waitcnt lgkmcnt(10)
    s_nop 0
    v_mfma_f32_32x32x16_bf16 v[88:103], v[136:139], a[84:87], v[88:103]
    ds_read_b128 a[92:95], v200 offset:40960
    ds_read_b64_tr_b16 v[160:161], v196 offset:14336
    ds_read_b64_tr_b16 v[162:163], v196 offset:14848
    ds_read_b64_tr_b16 v[164:165], v196 offset:22528
    s_add_u32 m0, s85, 135168
    s_add_u32 s56, s83, 200704
    buffer_load_dwordx4 v192, s[16:19], s56 offen lds
    v_mfma_f32_32x32x16_bf16 v[104:119], a[84:87], v[140:143], v[104:119]
    ds_read_b64_tr_b16 v[166:167], v196 offset:23040
    ds_read_b128 v[168:171], v212 offset:10240
    ds_read_b64_tr_b16 a[204:205], v196 offset:6144
    ds_read_b64_tr_b16 a[206:207], v196 offset:6656
    s_add_u32 m0, s85, 139264
    s_add_u32 s56, s83, 229376
    buffer_load_dwordx4 v192, s[16:19], s56 offen lds
    v_mfma_f32_32x32x16_bf16 v[120:135], v[144:147], v[140:143], v[120:135]
    s_waitcnt vmcnt(10)
    s_waitcnt lgkmcnt(0)
    s_barrier
    s_waitcnt lgkmcnt(10)
    v_mfma_f32_32x32x16_bf16 v[88:103], v[148:151], a[88:91], v[88:103]
    ds_read_b128 a[96:99], v197 offset:49152
    ds_read_b64_tr_b16 v[136:137], v195 offset:8192
    ds_read_b64_tr_b16 v[138:139], v195 offset:8704
    ds_read_b64_tr_b16 v[140:141], v195 offset:16384
    s_add_u32 m0, s85, 143360
    s_add_u32 s56, s83, 258048
    buffer_load_dwordx4 v192, s[16:19], s56 offen lds
    v_mfma_f32_32x32x16_bf16 v[104:119], a[88:91], v[152:155], v[104:119]
    ds_read_b64_tr_b16 v[142:143], v195 offset:16896
    ds_read_b128 v[144:147], v201 offset:12288
    ds_read_b64_tr_b16 a[208:209], v195 offset:0
    ds_read_b64_tr_b16 a[210:211], v195 offset:512
    s_add_u32 m0, s85, 147456
    s_add_u32 s56, s83, 286720
    buffer_load_dwordx4 v192, s[16:19], s56 offen lds
    v_mfma_f32_32x32x16_bf16 v[120:135], v[156:159], v[152:155], v[120:135]
    s_waitcnt lgkmcnt(10)
    s_nop 0
    v_mfma_f32_32x32x16_bf16 v[88:103], v[160:163], a[92:95], v[88:103]
    ds_read_b128 a[100:103], v198 offset:49152
    ds_read_b64_tr_b16 v[148:149], v195 offset:10240
    ds_read_b64_tr_b16 v[150:151], v195 offset:10752
    ds_read_b64_tr_b16 v[152:153], v195 offset:18432
    s_add_u32 m0, s85, 151552
    s_add_u32 s56, s83, 315392
    buffer_load_dwordx4 v192, s[16:19], s56 offen lds
    v_mfma_f32_32x32x16_bf16 v[104:119], a[92:95], v[164:167], v[104:119]
    ds_read_b64_tr_b16 v[154:155], v195 offset:18944
    ds_read_b128 v[156:159], v202 offset:12288
    ds_read_b64_tr_b16 a[212:213], v195 offset:2048
    ds_read_b64_tr_b16 a[214:215], v195 offset:2560
    v_mfma_f32_32x32x16_bf16 v[120:135], v[168:171], v[164:167], v[120:135]
    s_waitcnt lgkmcnt(10)
    s_nop 0
    v_mfma_f32_32x32x16_bf16 v[88:103], v[136:139], a[96:99], v[88:103]
    ds_read_b128 a[104:107], v199 offset:49152
    ds_read_b64_tr_b16 v[160:161], v195 offset:12288
    ds_read_b64_tr_b16 v[162:163], v195 offset:12800
    ds_read_b64_tr_b16 v[164:165], v195 offset:20480
    v_mfma_f32_32x32x16_bf16 v[104:119], a[96:99], v[140:143], v[104:119]
    ds_read_b64_tr_b16 v[166:167], v195 offset:20992
    ds_read_b128 v[168:171], v203 offset:12288
    ds_read_b64_tr_b16 a[216:217], v195 offset:4096
    ds_read_b64_tr_b16 a[218:219], v195 offset:4608
    v_mfma_f32_32x32x16_bf16 v[120:135], v[144:147], v[140:143], v[120:135]
    s_waitcnt lgkmcnt(10)
    s_nop 0
    v_mfma_f32_32x32x16_bf16 v[88:103], v[148:151], a[100:103], v[88:103]
    ds_read_b128 a[108:111], v200 offset:49152
    ds_read_b64_tr_b16 v[136:137], v195 offset:14336
    ds_read_b64_tr_b16 v[138:139], v195 offset:14848
    ds_read_b64_tr_b16 v[140:141], v195 offset:22528
    v_mfma_f32_32x32x16_bf16 v[104:119], a[100:103], v[152:155], v[104:119]
    ds_read_b64_tr_b16 v[142:143], v195 offset:23040
    ds_read_b128 v[144:147], v212 offset:12288
    ds_read_b64_tr_b16 a[220:221], v195 offset:6144
    ds_read_b64_tr_b16 a[222:223], v195 offset:6656
    v_mfma_f32_32x32x16_bf16 v[120:135], v[156:159], v[152:155], v[120:135]
    s_waitcnt vmcnt(12)
    s_mov_b32 s50, 0
Lt_13:
    v_and_b32 v14, 0x80808080, v194
    v_cmp_ne_u32 vcc, 0x80808080, v14
    s_cbranch_vccz Lt_14
    s_add_u32 s50, s50, 1
    s_cmp_ge_u32 s50, 0x40000
    s_cbranch_scc1 Lt_14
    s_sleep 16
    buffer_load_dword v194, v193, s[36:39], s49 offen sc1
    s_waitcnt vmcnt(0)
    s_branch Lt_13
Lt_14:
    s_mul_i32 s51, s48, 0x01010101
    v_and_b32 v14, 0x07070707, v194
    v_cmp_ne_u32 vcc, s51, v14
    s_nop 0
    v_readlane_b32 s52, v194, 0
    v_readlane_b32 s53, v194, 1
    s_cmp_eq_u64 vcc, 0
    s_cselect_b32 s45, 1, 0
    s_cselect_b32 s51, 0, 4194304
    s_add_u32 s32, s32, s51
    s_addc_u32 s33, s33, 0
    s_and_b32 s52, s52, 0x78787878
    s_lshr_b32 s52, s52, 3
    s_and_b32 s53, s53, 0x78787878
    s_lshl_b32 s53, s53, 1
    s_or_b32 s46, s52, s53
    s_lshl_b32 s49, s42, 12
    s_add_u32 s71, s82, 65536
    s_add_u32 s72, s82, 323584
    s_add_u32 s73, s82, 585728
    s_add_u32 s74, s82, 600064
    s_add_u32 s75, s82, 294912
    s_add_u32 s76, s82, 528384
    s_add_u32 s77, s82, 542720
    s_waitcnt vmcnt(4)
    s_waitcnt lgkmcnt(0)
    s_barrier
    s_waitcnt lgkmcnt(10)
    v_mfma_f32_32x32x16_bf16 v[88:103], v[160:163], a[104:107], v[88:103]
    s_add_u32 m0, s85, 155648
    s_add_u32 s56, s83, 344064
    buffer_load_dwordx4 v192, s[16:19], s56 offen lds
    v_mfma_f32_32x32x16_bf16 v[104:119], a[104:107], v[164:167], v[104:119]
    s_add_u32 m0, s85, 159744
    s_add_u32 s56, s83, 372736
    buffer_load_dwordx4 v192, s[16:19], s56 offen lds
    v_mfma_f32_32x32x16_bf16 v[120:135], v[168:171], v[164:167], v[120:135]
    s_waitcnt lgkmcnt(2)
    s_nop 0
    v_mfma_f32_32x32x16_bf16 v[88:103], v[136:139], a[108:111], v[88:103]
    v_mfma_f32_32x32x16_bf16 v[104:119], a[108:111], v[140:143], v[104:119]
    v_mfma_f32_32x32x16_bf16 v[120:135], v[144:147], v[140:143], v[120:135]
    v_mfma_f32_32x32x16_bf16 v[72:87], a[112:115], a[0:3], 0
    ds_read_b64_tr_b16 a[224:225], v184 offset:0
    ds_read_b64_tr_b16 a[226:227], v188 offset:0
    ds_read_b64_tr_b16 a[228:229], v185 offset:0
    ds_read_b64_tr_b16 a[230:231], v189 offset:0
    v_mfma_f32_32x32x16_bf16 v[72:87], a[116:119], a[4:7], v[72:87]
    ds_read_b64_tr_b16 a[232:233], v186 offset:0
    ds_read_b64_tr_b16 a[234:235], v190 offset:0
    ds_read_b64_tr_b16 a[236:237], v187 offset:0
    ds_read_b64_tr_b16 a[238:239], v191 offset:0
    v_mfma_f32_32x32x16_bf16 v[72:87], a[120:123], a[8:11], v[72:87]
    v_cvt_pk_bf16_f32 v24, v88, v89
    v_cvt_pk_bf16_f32 v25, v90, v91
    v_cvt_pk_bf16_f32 v26, v92, v93
    v_cvt_pk_bf16_f32 v27, v94, v95
    buffer_store_dwordx4 v[24:27], v254, s[32:35], s72 offen offset:0 sc1
    v_mfma_f32_32x32x16_bf16 v[72:87], a[124:127], a[12:15], v[72:87]
    v_cvt_pk_bf16_f32 v28, v96, v97
    v_cvt_pk_bf16_f32 v29, v98, v99
    v_cvt_pk_bf16_f32 v30, v100, v101
    v_cvt_pk_bf16_f32 v31, v102, v103
    buffer_store_dwordx4 v[28:31], v254, s[32:35], s72 offen offset:512 sc1
    v_mfma_f32_32x32x16_bf16 v[72:87], a[128:131], a[16:19], v[72:87]
    v_cvt_pk_bf16_f32 v32, v104, v105
    v_cvt_pk_bf16_f32 v33, v106, v107
    v_cvt_pk_bf16_f32 v34, v108, v109
    v_cvt_pk_bf16_f32 v35, v110, v111
    buffer_store_dwordx4 v[32:35], v175, s[32:35], s73 offen sc1
    v_mfma_f32_32x32x16_bf16 v[72:87], a[132:135], a[20:23], v[72:87]
    v_cvt_pk_bf16_f32 v36, v112, v113
    v_cvt_pk_bf16_f32 v37, v114, v115
    v_cvt_pk_bf16_f32 v38, v116, v117
    v_cvt_pk_bf16_f32 v39, v118, v119
    buffer_store_dwordx4 v[36:39], v175, s[32:35], s74 offen sc1
    v_mfma_f32_32x32x16_bf16 v[72:87], a[136:139], a[24:27], v[72:87]
    v_cvt_pk_bf16_f32 v40, v120, v121
    v_cvt_pk_bf16_f32 v41, v122, v123
    v_cvt_pk_bf16_f32 v42, v124, v125
    v_cvt_pk_bf16_f32 v43, v126, v127
    buffer_store_dwordx4 v[40:43], v175, s[32:35], s76 offen sc1
    v_mfma_f32_32x32x16_bf16 v[72:87], a[140:143], a[28:31], v[72:87]
    v_cvt_pk_bf16_f32 v44, v128, v129
    v_cvt_pk_bf16_f32 v45, v130, v131
    v_cvt_pk_bf16_f32 v46, v132, v133
    v_cvt_pk_bf16_f32 v47, v134, v135
    buffer_store_dwordx4 v[44:47], v175, s[32:35], s77 offen sc1
    v_mfma_f32_32x32x16_bf16 v[72:87], a[144:147], a[32:35], v[72:87]
    ds_read_b64_tr_b16 a[240:241], v186 offset:3584
    ds_read_b64_tr_b16 a[242:243], v190 offset:3584
    ds_read_b64_tr_b16 a[244:245], v187 offset:3584
    ds_read_b64_tr_b16 a[246:247], v191 offset:3584
    v_mfma_f32_32x32x16_bf16 v[72:87], a[148:151], a[36:39], v[72:87]
    ds_read_b64_tr_b16 a[248:249], v184 offset:3584
    ds_read_b64_tr_b16 a[250:251], v188 offset:3584
    ds_read_b64_tr_b16 a[252:253], v185 offset:3584
    ds_read_b64_tr_b16 a[254:255], v189 offset:3584
    v_mfma_f32_32x32x16_bf16 v[72:87], a[152:155], a[40:43], v[72:87]
    ds_read_b64_tr_b16 a[0:1], v184 offset:7168
    ds_read_b64_tr_b16 a[2:3], v188 offset:7168
    ds_read_b64_tr_b16 a[112:113], v185 offset:7168
    ds_read_b64_tr_b16 a[114:115], v189 offset:7168
    v_mfma_f32_32x32x16_bf16 v[72:87], a[156:159], a[44:47], v[72:87]
    ds_read_b64_tr_b16 a[4:5], v186 offset:7168
    ds_read_b64_tr_b16 a[6:7], v190 offset:7168
    ds_read_b64_tr_b16 a[116:117], v187 offset:7168
    ds_read_b64_tr_b16 a[118:119], v191 offset:7168
    v_mfma_f32_32x32x16_bf16 v[72:87], a[160:163], a[48:51], v[72:87]
    ds_read_b64_tr_b16 a[8:9], v186 offset:10752
    ds_read_b64_tr_b16 a[10:11], v190 offset:10752
    ds_read_b64_tr_b16 a[120:121], v187 offset:10752
    ds_read_b64_tr_b16 a[122:123], v191 offset:10752
    v_mfma_f32_32x32x16_bf16 v[72:87], a[164:167], a[52:55], v[72:87]
    ds_read_b64_tr_b16 a[12:13], v184 offset:10752
    ds_read_b64_tr_b16 a[14:15], v188 offset:10752
    ds_read_b64_tr_b16 a[124:125], v185 offset:10752
    ds_read_b64_tr_b16 a[126:127], v189 offset:10752
    v_mfma_f32_32x32x16_bf16 v[72:87], a[168:171], a[56:59], v[72:87]
    ds_read_b64_tr_b16 a[16:17], v184 offset:14336
    ds_read_b64_tr_b16 a[18:19], v188 offset:14336
    ds_read_b64_tr_b16 a[128:129], v185 offset:14336
    ds_read_b64_tr_b16 a[130:131], v189 offset:14336
    v_mfma_f32_32x32x16_bf16 v[72:87], a[172:175], a[60:63], v[72:87]
    ds_read_b64_tr_b16 a[20:21], v186 offset:14336
    ds_read_b64_tr_b16 a[22:23], v190 offset:14336
    ds_read_b64_tr_b16 a[132:133], v187 offset:14336
    ds_read_b64_tr_b16 a[134:135], v191 offset:14336
    v_mfma_f32_32x32x16_bf16 v[72:87], a[176:179], a[64:67], v[72:87]
    ds_read_b64_tr_b16 a[24:25], v186 offset:17920
    ds_read_b64_tr_b16 a[26:27], v190 offset:17920
    ds_read_b64_tr_b16 a[136:137], v187 offset:17920
    ds_read_b64_tr_b16 a[138:139], v191 offset:17920
    v_mfma_f32_32x32x16_bf16 v[72:87], a[180:183], a[68:71], v[72:87]
    ds_read_b64_tr_b16 a[28:29], v184 offset:17920
    ds_read_b64_tr_b16 a[30:31], v188 offset:17920
    ds_read_b64_tr_b16 a[140:141], v185 offset:17920
    ds_read_b64_tr_b16 a[142:143], v189 offset:17920
    v_mfma_f32_32x32x16_bf16 v[72:87], a[184:187], a[72:75], v[72:87]
    ds_read_b64_tr_b16 a[32:33], v184 offset:21504
    ds_read_b64_tr_b16 a[34:35], v188 offset:21504
    ds_read_b64_tr_b16 a[144:145], v185 offset:21504
    ds_read_b64_tr_b16 a[146:147], v189 offset:21504
    v_mfma_f32_32x32x16_bf16 v[72:87], a[188:191], a[76:79], v[72:87]
    ds_read_b64_tr_b16 a[36:37], v186 offset:21504
    ds_read_b64_tr_b16 a[38:39], v190 offset:21504
    ds_read_b64_tr_b16 a[148:149], v187 offset:21504
    ds_read_b64_tr_b16 a[150:151], v191 offset:21504
    v_mfma_f32_32x32x16_bf16 v[72:87], a[192:195], a[80:83], v[72:87]
    ds_read_b64_tr_b16 a[40:41], v186 offset:25088
    ds_read_b64_tr_b16 a[42:43], v190 offset:25088
    ds_read_b64_tr_b16 a[152:153], v187 offset:25088
    ds_read_b64_tr_b16 a[154:155], v191 offset:25088
    v_mfma_f32_32x32x16_bf16 v[72:87], a[196:199], a[84:87], v[72:87]
    ds_read_b64_tr_b16 a[44:45], v184 offset:25088
    ds_read_b64_tr_b16 a[46:47], v188 offset:25088
    ds_read_b64_tr_b16 a[156:157], v185 offset:25088
    ds_read_b64_tr_b16 a[158:159], v189 offset:25088
    v_mfma_f32_32x32x16_bf16 v[72:87], a[200:203], a[88:91], v[72:87]
    ds_read_b64_tr_b16 a[48:49], v184 offset:28672
    ds_read_b64_tr_b16 a[50:51], v188 offset:28672
    ds_read_b64_tr_b16 a[160:161], v185 offset:28672
    ds_read_b64_tr_b16 a[162:163], v189 offset:28672
    v_mfma_f32_32x32x16_bf16 v[72:87], a[204:207], a[92:95], v[72:87]
    ds_read_b64_tr_b16 a[52:53], v186 offset:28672
    ds_read_b64_tr_b16 a[54:55], v190 offset:28672
    ds_read_b64_tr_b16 a[164:165], v187 offset:28672
    ds_read_b64_tr_b16 a[166:167], v191 offset:28672
    v_mfma_f32_32x32x16_bf16 v[72:87], a[208:211], a[96:99], v[72:87]
    v_mfma_f32_32x32x16_bf16 v[72:87], a[212:215], a[100:103], v[72:87]
    v_mfma_f32_32x32x16_bf16 v[72:87], a[216:219], a[104:107], v[72:87]
    v_mfma_f32_32x32x16_bf16 v[72:87], a[220:223], a[108:111], v[72:87]
    s_cmp_eq_u32 s45, 0
    s_cbranch_scc1 Ls_15
    s_nop 9
    s_nop 0
    v_cvt_pk_bf16_f32 v16, v72, v73
    v_cvt_pk_bf16_f32 v17, v74, v75
    v_cvt_pk_bf16_f32 v18, v76, v77
    v_cvt_pk_bf16_f32 v19, v78, v79
    buffer_store_dwordx4 v[16:19], v254, s[32:35], s71 offen offset:0
    v_cvt_pk_bf16_f32 v20, v80, v81
    v_cvt_pk_bf16_f32 v21, v82, v83
    v_cvt_pk_bf16_f32 v22, v84, v85
    v_cvt_pk_bf16_f32 v23, v86, v87
    buffer_store_dwordx4 v[20:23], v254, s[32:35], s71 offen offset:512
    s_branch Ls_16
Ls_15:
    s_nop 7
    s_nop 3
    s_nop 0
    v_cvt_pk_bf16_f32 v16, v72, v73
    v_cvt_pk_bf16_f32 v17, v74, v75
    v_cvt_pk_bf16_f32 v18, v76, v77
    v_cvt_pk_bf16_f32 v19, v78, v79
    buffer_store_dwordx4 v[16:19], v254, s[32:35], s71 offen offset:0 sc1
    v_cvt_pk_bf16_f32 v20, v80, v81
    v_cvt_pk_bf16_f32 v21, v82, v83
    v_cvt_pk_bf16_f32 v22, v84, v85
    v_cvt_pk_bf16_f32 v23, v86, v87
    buffer_store_dwordx4 v[20:23], v254, s[32:35], s71 offen offset:512 sc1
Ls_16:
    s_branch L_att
L_serv:
    s_nop 0
    s_mov_b32 s14, 1204224
    s_mov_b32 s15, 0x20000
    s_mov_b32 s18, 401408
    s_mov_b32 s19, 0x20000
    s_mov_b32 s22, 1605632
    s_mov_b32 s23, 0x20000
    s_mov_b32 s26, 1605632
    s_mov_b32 s27, 0x20000
    s_mov_b32 s30, 1835008
    s_mov_b32 s31, 0x20000
    s_mov_b32 s34, 4194304
    s_mov_b32 s35, 0x20000
    s_mov_b32 s38, 256
    s_mov_b32 s39, 0x20000
    s_mov_b32 s12, s66
    s_mov_b32 s13, s67
    s_mov_b32 s16, s68
    s_mov_b32 s17, s69
    s_mov_b32 s24, s76
    s_mov_b32 s25, s77
    s_mov_b32 s28, s78
    s_mov_b32 s29, s79
    s_mov_b32 s36, s80
    s_mov_b32 s37, s81
    s_cmp_lt_u32 s42, 2
    s_cselect_b32 s20, s72, s74
    s_cselect_b32 s21, s73, s75
    s_lshl_b32 s50, s40, 23
    s_add_u32 s32, s82, s50
    s_addc_u32 s33, s83, 0
    s_getreg_b32 s48, hwreg(HW_REG_XCC_ID, 0, 3)
    v_lshlrev_b32 v253, 4, v0
    s_mov_b32 s61, 0xffff0000
    s_lshl_b32 s89, s42, 13
    s_lshl_b32 s49, s40, 5
    v_lshlrev_b32_e64 v168, 7, v0
    s_sub_u32 s64, s41, 28
    s_lshl_b32 s80, s64, 2
    s_add_u32 s80, s80, s42
    s_lshl_b32 s78, s64, 1
    s_and_b32 s50, s42, 1
    s_add_u32 s78, s78, s50
    s_lshl_b32 s66, s40, 4
    s_add_u32 s66, s66, s80
    s_mul_i32 s66, s66, 9472
    buffer_load_dword a255, v168, s[12:15], s66 offen sc1
    s_add_u32 s66, s66, 8192
    v_min_u32 v169, 1152, v168
    buffer_load_dword a255, v169, s[12:15], s66 offen
    v_and_b32 v193, 7, v0
    v_lshlrev_b32 v193, 2, v193
    s_lshr_b32 s54, s41, 3
    s_bfe_u32 s50, s41, 0x10002
    s_and_b32 s55, s41, 3
    s_lshl_b32 s55, s55, 2
    s_add_u32 s55, s55, s42
    s_lshl_b32 s51, s54, 2
    s_add_u32 s51, s51, s50
    s_mul_i32 s51, s51, 14336
    s_mul_i32 s50, s55, 896
    s_add_u32 s50, s50, s51
    s_and_b32 s56, s42, 1
    s_lshl_b32 s56, s56, 7
    s_add_u32 s97, s50, 65536
    s_add_u32 s98, s50, 94208
    s_sub_u32 s50, s50, s56
    s_add_u32 s91, s50, 65536
    s_add_u32 s93, s50, 294912
    s_add_u32 s95, s51, 557056
    s_add_u32 s92, s50, 94208
    s_add_u32 s94, s50, 323584
    s_add_u32 s96, s51, 585728
    s_mul_i32 s52, s55, 28
    s_add_u32 s51, s52, 27
    s_lshr_b32 s50, s52, 5
    s_lshr_b32 s51, s51, 5
    s_sub_u32 s51, s51, s50
    s_lshl_b32 s53, s54, 1
    s_sub_u32 s53, s53, 1
    v_min_u32 v176, 2, v3
    v_add_u32 v176, s53, v176
    v_max_i32 v176, 0, v176
    v_lshlrev_b32 v176, 7, v176
    v_and_b32 v160, 1, v2
    v_mul_u32_u24 v160, s51, v160
    v_add_u32 v160, s50, v160
    v_lshl_add_u32 v176, v160, 2, v176
    v_and_b32_e64 v160, 15, v0
    v_bfe_u32 v163, v0, 4, 1
    v_lshrrev_b32_e64 v161, 5, v0
    v_bfe_u32 v162, v0, 3, 1
    v_mul_u32_u24 v162, 28672, v162
    v_and_b32_e64 v177, 0x37, v0
    v_lshl_add_u32 v177, v177, 4, v162
    v_mul_u32_u24 v162, 28672, v161
    v_lshl_add_u32 v162, v163, 9, v162
    v_add_u32 v164, 0, v160
    v_min_u32 v164, 27, v164
    v_add_u32 v164, s52, v164
    v_lshrrev_b32 v165, 5, v164
    v_and_b32_e64 v164, 31, v164
    v_lshl_add_u32 v164, v164, 4, v162
    v_lshl_add_u32 v178, v165, 10, v164
    v_add_u32 v164, 16, v160
    v_min_u32 v164, 27, v164
    v_add_u32 v164, s52, v164
    v_lshrrev_b32 v165, 5, v164
    v_and_b32_e64 v164, 31, v164
    v_lshl_add_u32 v164, v164, 4, v162
    v_lshl_add_u32 v179, v165, 10, v164
    s_mov_b32 s0, -1
    s_mov_b32 s1, 0xffff
    s_cmp_eq_u32 s56, 0
    s_cselect_b32 s2, -1, 0xffff0000
    s_cselect_b32 s5, 0xffff, -1
    s_mov_b32 s3, -1
    s_mov_b32 s4, -1
    v_add_u32 v164, 752896, v253
    v_add_u32 v165, 128, v253
    v_cndmask_b32 v181, v164, v253, s[0:1]
    v_cndmask_b32 v182, v164, v165, s[0:1]
    v_add_u32_e64 v165, s56, v253
    v_cndmask_b32 v180, v164, v165, s[0:1]
    v_subrev_u32 v165, 256, v253
    v_cndmask_b32 v183, v165, v253, s[0:1]
    s_lshr_b32 s7, s41, 2
    s_lshl_b32 s7, s7, 7
    s_lshl_b32 s50, s55, 2
    s_add_u32 s7, s7, s50
    s_add_u32 s7, s7, 2048
    v_lshlrev_b32 v164, 2, v163
    v_sub_u32 v164, v160, v164
    v_xor_b32 v165, 1, v161
    v_lshl_add_u32 v164, v165, 4, v164
    s_or_b32 s50, s40, s54
    s_cmp_eq_u32 s50, 0
    s_cselect_b32 s50, 64, 0
    v_mad_u32_u24 v165, v165, s50, v164
    v_mov_b32 v162, 0xf149f2ca
    v_subrev_u32_e64 v166, 0, v164
    v_subrev_u32 v167, 0, v165
    v_cmp_lt_u32 vcc, 7, v166
    v_cmp_lt_u32 s[52:53], 7, v167
    s_nop 0
    v_cndmask_b32 v216, 0, v162, vcc
    v_cndmask_b32 v224, 0, v162, s[52:53]
    v_subrev_u32_e64 v166, 1, v164
    v_subrev_u32 v167, 1, v165
    v_cmp_lt_u32 vcc, 7, v166
    v_cmp_lt_u32 s[52:53], 7, v167
    s_nop 0
    v_cndmask_b32 v217, 0, v162, vcc
    v_cndmask_b32 v225, 0, v162, s[52:53]
    v_subrev_u32_e64 v166, 2, v164
    v_subrev_u32 v167, 2, v165
    v_cmp_lt_u32 vcc, 7, v166
    v_cmp_lt_u32 s[52:53], 7, v167
    s_nop 0
    v_cndmask_b32 v218, 0, v162, vcc
    v_cndmask_b32 v226, 0, v162, s[52:53]
    v_subrev_u32_e64 v166, 3, v164
    v_subrev_u32 v167, 3, v165
    v_cmp_lt_u32 vcc, 7, v166
    v_cmp_lt_u32 s[52:53], 7, v167
    s_nop 0
    v_cndmask_b32 v219, 0, v162, vcc
    v_cndmask_b32 v227, 0, v162, s[52:53]
    v_subrev_u32_e64 v166, 8, v164
    v_subrev_u32 v167, 8, v165
    v_cmp_lt_u32 vcc, 7, v166
    v_cmp_lt_u32 s[52:53], 7, v167
    s_nop 0
    v_cndmask_b32 v220, 0, v162, vcc
    v_cndmask_b32 v228, 0, v162, s[52:53]
    v_subrev_u32_e64 v166, 9, v164
    v_subrev_u32 v167, 9, v165
    v_cmp_lt_u32 vcc, 7, v166
    v_cmp_lt_u32 s[52:53], 7, v167
    s_nop 0
    v_cndmask_b32 v221, 0, v162, vcc
    v_cndmask_b32 v229, 0, v162, s[52:53]
    v_subrev_u32_e64 v166, 10, v164
    v_subrev_u32 v167, 10, v165
    v_cmp_lt_u32 vcc, 7, v166
    v_cmp_lt_u32 s[52:53], 7, v167
    s_nop 0
    v_cndmask_b32 v222, 0, v162, vcc
    v_cndmask_b32 v230, 0, v162, s[52:53]
    v_subrev_u32_e64 v166, 11, v164
    v_subrev_u32 v167, 11, v165
    v_cmp_lt_u32 vcc, 7, v166
    v_cmp_lt_u32 s[52:53], 7, v167
    s_nop 0
    v_cndmask_b32 v223, 0, v162, vcc
    v_cndmask_b32 v231, 0, v162, s[52:53]
    v_lshrrev_b32 v164, 1, v2
    v_and_b32 v164, 3, v164
    v_lshlrev_b32_e64 v164, 5, v164
    v_lshl_add_u32 v164, v2, 7, v164
    v_lshl_add_u32 v184, v3, 3, v164
    v_add_u32 v184, 106496, v184
    v_add_u32 v164, 2048, v184
    v_add_u32 v165, 1536, v184
    v_xor_b32_e64 v165, 64, v165
    v_cndmask_b32 v188, v165, v164, s[0:1]
    v_xor_b32 v185, 32, v184
    v_xor_b32 v189, 32, v188
    v_xor_b32 v186, 64, v184
    v_xor_b32 v190, 64, v188
    v_xor_b32 v187, 96, v184
    v_xor_b32 v191, 96, v188
    v_lshrrev_b32 v14, 3, v0
    v_and_b32 v15, 6, v14
    v_xor_b32 v15, v0, v15
    v_and_b32 v15, 7, v15
    v_mul_u32_u24 v14, 3584, v14
    v_lshl_add_u32 v240, v15, 4, v14
    v_add_u32 v241, 27648, v240
    v_add_u32 v242, 55296, v240
    v_add_u32 v243, 82944, v240
    s_min_u32 s50, s41, 27
    s_cmp_ge_u32 s50, 14
    s_cselect_b32 s57, 4, 0
    s_cselect_b32 s51, 14, 0
    s_sub_u32 s58, s50, s51
    s_add_u32 s57, s57, s42
    s_lshl_b32 s88, s58, 8
    s_and_b32 s50, s42, 1
    s_mul_i32 s51, s50, 114688
    s_add_u32 s88, s88, s51
    v_mul_u32_u24 v164, 14336, v163
    v_lshl_add_u32 v164, v161, 8, v164
    v_lshl_add_u32 v254, v160, 4, v164
    s_cmp_lg_u32 s42, 0
    s_cbranch_scc1 L_17
    s_lshl_b32 s50, s41, 2
    s_lshr_b32 s50, s84, s50
    s_and_b32 s50, s50, 15
    s_cmp_lt_u32 s41, 8
    s_cselect_b32 s50, s50, 0
    s_lshl_b32 s50, s50, 3
    s_or_b32 s54, s50, s48
    s_or_b32 s54, s54, 0x80
    s_add_u32 s51, s49, s41
    s_and_b32 s51, s51, 0xfc
    s_and_b32 s50, s41, 3
    s_lshl_b32 s50, s50, 3
    s_lshl_b32 s50, s54, s50
    v_mov_b32 v252, s50
    s_mov_b64 exec, 1
    buffer_atomic_or v252, off, s[36:39], s51 sc1
    s_mov_b64 exec, -1
L_17:
    v_and_b32 v64, 15, v0
    v_lshrrev_b32 v65, 5, v0
    v_bfe_u32 v67, v0, 4, 1
    s_lshl_b32 s62, s57, 7
    s_add_u32 s62, s62, 4096
    s_mul_i32 s68, s57, 28672
    s_add_u32 s68, s68, 323584
    s_mul_i32 s69, s57, 7
    s_add_u32 s69, s69, s58
    s_cmp_ge_u32 s58, 7
    s_cselect_b32 s50, 49, 0
    s_add_u32 s69, s69, s50
    s_lshl_b32 s69, s69, 12
    s_add_u32 s69, s69, 1048576
    s_lshr_b32 s59, s57, 1
    s_lshl_b32 s59, s59, 4
    s_add_u32 s59, s59, s58
    s_lshl_b32 s59, s59, 1
    s_and_b32 s50, s42, 1
    s_add_u32 s59, s59, s50
    s_lshl_b32 s59, s59, 2
    s_add_u32 s59, s59, 6144
    v_subrev_u32 v4, 106496, v184
    v_xor_b32 v5, 32, v4
    v_xor_b32_e64 v6, 64, v4
    v_xor_b32 v7, 96, v4
    v_add_u32 v8, 65536, v4
    v_add_u32 v9, 65536, v5
    v_add_u32 v10, 65536, v6
    v_add_u32 v11, 65536, v7
    v_and_b32 v14, 7, v0
    v_min_u32 v14, 6, v14
    v_and_b32 v15, 8, v0
    v_or_b32 v14, v14, v15
    v_lshlrev_b32 v234, 2, v14
    v_lshrrev_b32 v14, 3, v0
    v_and_b32 v15, 6, v14
    v_xor_b32 v15, v0, v15
    v_and_b32_e64 v15, 7, v15
    v_mul_u32_u24 v14, 896, v14
    v_lshl_add_u32 v244, v15, 4, v14
    v_add_u32 v245, 6144, v244
    v_add_u32 v246, 12288, v244
    v_add_u32 v247, 18432, v244
    s_mul_i32 s70, s42, 401408
    s_lshl_b32 s50, s44, 7
    s_add_u32 s70, s70, s50
    s_add_u32 s50, s89, 131072
    v_add_u32 v12, 14336, v253
    v_add_u32 v248, s50, v4
    v_add_u32 v249, s50, v5
    v_add_u32 v250, s50, v6
    v_add_u32 v251, s50, v7
    s_add_u32 s50, s89, 131072
    v_mul_u32_u24 v213, 144, v2
    v_lshl_add_u32 v213, v3, 4, v213
    v_add_u32_e64 v213, s50, v213
    v_mul_u32_u24 v214, 144, v64
    v_lshrrev_b32_e64 v14, 4, v0
    v_lshl_add_u32 v214, v14, 3, v214
    v_add_u32 v214, s50, v214
    v_lshrrev_b32 v14, 3, v0
    v_mul_u32_u24 v215, 144, v14
    v_and_b32_e64 v14, 7, v0
    v_lshl_add_u32 v215, v14, 4, v215
    v_add_u32 v215, s50, v215
    v_lshlrev_b32 v232, 4, v64
    s_lshl_b32 s52, s43, 2
    s_add_u32 s52, s52, s42
    s_mul_i32 s64, s52, 14336
    s_lshl_b32 s50, s44, 11
    s_add_u32 s65, s64, s50
    s_add_u32 s65, s65, 323584
    s_add_u32 s64, s64, 65536
    s_mul_i32 s67, s52, 1792
    s_add_u32 s67, s67, 16384
    s_lshl_b32 s50, s44, 8
    s_add_u32 s66, s67, s50
    s_lshr_b32 s53, s52, 1
    s_and_b32 s51, s42, 1
    s_lshl_b32 s47, s53, 2
    s_add_u32 s47, s47, s51
    s_lshl_b32 s47, s47, 3
    s_add_u32 s47, s47, s44
    s_lshl_b32 s47, s47, 2
    s_add_u32 s47, s47, 4096
    s_lshl_b32 s60, s43, 1
    s_add_u32 s60, s60, s51
    s_lshl_b32 s60, s60, 7
    s_add_u32 s60, s60, 2048
    s_cmp_lt_u32 s43, 3
    s_cselect_b32 s50, 16, 0
    v_and_b32_e64 v14, s50, v0
    v_lshlrev_b32 v233, 2, v64
    v_lshl_add_u32 v233, v14, 4, v233
    s_waitcnt vmcnt(0)
    s_lshl_b32 s66, s40, 4
    s_add_u32 s66, s66, s80
    s_mul_i32 s66, s66, 3200
    v_min_u32 v169, 3072, v168
    buffer_load_dword a255, v169, s[16:19], s66 offen
    s_mul_i32 s66, s80, 2816
    v_min_u32 v169, 2688, v168
    buffer_load_dword a255, v169, s[32:35], s66 offen
    s_mul_i32 s66, s80, 14336
    s_add_u32 s66, s66, 65536
    buffer_load_dword a255, v168, s[32:35], s66 offen sc1
    s_add_u32 s66, s66, 6144
    buffer_load_dword a255, v168, s[32:35], s66 offen sc1
    s_mul_i32 s66, s80, 14336
    s_add_u32 s66, s66, 819200
    v_bfe_u32 v169, v0, 1, 4
    v_mul_u32_u24 v169, 896, v169
    v_and_b32 v170, 128, v168
    v_add_u32 v169, v169, v170
    buffer_load_dword a255, v169, s[32:35], s66 offen
    s_waitcnt vmcnt(0)
    buffer_load_dword v194, v193, s[36:39], s49 offen sc1
    s_waitcnt vmcnt(0)
    s_mov_b32 s50, 0
Lt_18:
    v_and_b32 v14, 0x80808080, v194
    v_cmp_ne_u32 vcc, 0x80808080, v14
    s_cbranch_vccz Lt_19
    s_add_u32 s50, s50, 1
    s_cmp_ge_u32 s50, 0x40000
    s_cbranch_scc1 Lt_19
    s_sleep 16
    buffer_load_dword v194, v193, s[36:39], s49 offen sc1
    s_waitcnt vmcnt(0)
    s_branch Lt_18
Lt_19:
    s_mul_i32 s51, s48, 0x01010101
    v_and_b32 v14, 0x07070707, v194
    v_cmp_ne_u32 vcc, s51, v14
    v_readlane_b32 s52, v194, 0
    v_readlane_b32 s53, v194, 1
    s_cmp_eq_u64 vcc, 0
    s_cselect_b32 s45, 1, 0
    s_cselect_b32 s51, 0, 4194304
    s_add_u32 s32, s32, s51
    s_addc_u32 s33, s33, 0
    s_and_b32 s52, s52, 0x78787878
    s_lshr_b32 s52, s52, 3
    s_and_b32 s53, s53, 0x78787878
    s_lshl_b32 s53, s53, 1
    s_or_b32 s46, s52, s53
    s_lshl_b32 s49, s42, 12
    s_mov_b32 s6, 1792
L_att:
    s_cmp_eq_u32 s45, 0
    s_cselect_b32 s50, 1773568, 0
    s_add_u32 s65, s65, s50
    s_add_u32 s68, s68, s50
    v_mov_b32 v14, s46
    s_cmp_eq_u32 s45, 0
    s_mov_b64 exec, 1
    s_waitcnt vmcnt(0)
    s_cbranch_scc1 Lf_20
    buffer_store_dword v14, off, s[32:35], s6
    s_branch Lf_21
Lf_20:
    buffer_store_dword v14, off, s[32:35], s6 sc1
Lf_21:
    s_mov_b64 exec, -1
    s_add_u32 m0, s49, 32768
    s_add_u32 s90, s88, 0
    buffer_load_dwordx4 v240, s[20:23], s90 offen offset:0 lds
    buffer_load_dwordx4 v241, s[20:23], s90 offen offset:1024 lds
    buffer_load_dwordx4 v242, s[20:23], s90 offen offset:2048 lds
    buffer_load_dwordx4 v243, s[20:23], s90 offen offset:3072 lds
    s_add_u32 m0, s49, 49152
    s_add_u32 s90, s88, 229376
    buffer_load_dwordx4 v240, s[20:23], s90 offen offset:0 lds
    buffer_load_dwordx4 v241, s[20:23], s90 offen offset:1024 lds
    buffer_load_dwordx4 v242, s[20:23], s90 offen offset:2048 lds
    buffer_load_dwordx4 v243, s[20:23], s90 offen offset:3072 lds
    s_barrier
    s_nop 0
    ds_read_b64_tr_b16 a[56:57], v186 offset:32256
    ds_read_b64_tr_b16 a[58:59], v190 offset:32256
    ds_read_b64_tr_b16 a[168:169], v187 offset:32256
    ds_read_b64_tr_b16 a[170:171], v191 offset:32256
    ds_read_b64_tr_b16 a[60:61], v184 offset:32256
    ds_read_b64_tr_b16 a[62:63], v188 offset:32256
    ds_read_b64_tr_b16 a[172:173], v185 offset:32256
    ds_read_b64_tr_b16 a[174:175], v189 offset:32256
    s_mov_b32 s50, 0x40000
Lp_22:
    buffer_load_dword v15, v176, s[32:35], 0 offen sc1
    s_waitcnt vmcnt(0)
    v_cmp_ne_u32 vcc, s46, v15
    s_cbranch_vccz Lp_23
    s_sub_u32 s50, s50, 1
    s_cmp_lg_u32 s50, 0
    s_cbranch_scc1 Lp_22
Lp_23:
    buffer_load_dwordx4 v[72:75], v177, s[32:35], s93 offen offset:0 sc1
    buffer_load_dwordx4 v[76:79], v177, s[32:35], s93 offen offset:128 sc1
    buffer_load_dwordx4 v[64:67], v253, s[32:35], s91 offen offset:0 sc1
    buffer_load_dwordx4 v[80:83], v177, s[32:35], s94 offen offset:0 sc1
    buffer_load_dwordx4 v[84:87], v177, s[32:35], s94 offen offset:128 sc1
    buffer_load_dwordx4 v[68:71], v253, s[32:35], s92 offen offset:0 sc1
    buffer_load_dwordx4 v[88:91], v178, s[32:35], s95 offen offset:0 sc1
    buffer_load_dwordx4 v[92:95], v179, s[32:35], s95 offen offset:0 sc1
    buffer_load_dwordx4 v[96:99], v178, s[32:35], s96 offen offset:0 sc1
    buffer_load_dwordx4 v[100:103], v179, s[32:35], s96 offen offset:0 sc1
    ds_read_b64_tr_b16 a[64:65], v184 offset:35840
    ds_read_b64_tr_b16 a[66:67], v188 offset:35840
    ds_read_b64_tr_b16 a[176:177], v185 offset:35840
    ds_read_b64_tr_b16 a[178:179], v189 offset:35840
    ds_read_b64_tr_b16 a[68:69], v186 offset:35840
    ds_read_b64_tr_b16 a[70:71], v190 offset:35840
    ds_read_b64_tr_b16 a[180:181], v187 offset:35840
    ds_read_b64_tr_b16 a[182:183], v191 offset:35840
    ds_read_b64_tr_b16 a[72:73], v186 offset:39424
    ds_read_b64_tr_b16 a[74:75], v190 offset:39424
    ds_read_b64_tr_b16 a[184:185], v187 offset:39424
    ds_read_b64_tr_b16 a[186:187], v191 offset:39424
    ds_read_b64_tr_b16 a[76:77], v184 offset:39424
    ds_read_b64_tr_b16 a[78:79], v188 offset:39424
    ds_read_b64_tr_b16 a[188:189], v185 offset:39424
    ds_read_b64_tr_b16 a[190:191], v189 offset:39424
    ds_read_b64_tr_b16 a[80:81], v184 offset:43008
    ds_read_b64_tr_b16 a[82:83], v188 offset:43008
    ds_read_b64_tr_b16 a[192:193], v185 offset:43008
    ds_read_b64_tr_b16 a[194:195], v189 offset:43008
    s_mov_b32 s57, 0x3e8b97f6
    s_waitcnt vmcnt(7)
    s_nop 0
    v_cndmask_b32 v64, 0, v64, s[2:3]
    v_cndmask_b32 v65, 0, v65, s[2:3]
    v_cndmask_b32 v66, 0, v66, s[4:5]
    v_cndmask_b32 v67, 0, v67, s[4:5]
    s_nop 1
    v_mfma_f32_16x16x32_bf16 v[104:107], v[72:75], v[64:67], v[224:227]
    v_mfma_f32_16x16x32_bf16 v[108:111], v[76:79], v[64:67], v[228:231]
    s_waitcnt vmcnt(4)
    v_cndmask_b32 v68, 0, v68, s[2:3]
    v_cndmask_b32 v69, 0, v69, s[2:3]
    v_cndmask_b32 v70, 0, v70, s[4:5]
    v_cndmask_b32 v71, 0, v71, s[4:5]
    s_nop 1
    v_mfma_f32_16x16x32_bf16 v[112:115], v[80:83], v[68:71], v[216:219]
    v_mfma_f32_16x16x32_bf16 v[116:119], v[84:87], v[68:71], v[220:223]
    s_add_u32 m0, s49, 0
    s_add_u32 s90, s88, 458752
    buffer_load_dwordx4 v240, s[20:23], s90 offen offset:0 lds
    v_max3_f32 v144, v104, v105, v106
    v_max3_f32 v148, v107, v108, v109
    v_max3_f32 v144, v144, v110, v111
    v_max_f32_e64 v144, v144, v148
    v_max3_f32 v145, v112, v113, v114
    v_max3_f32 v148, v115, v116, v117
    v_max3_f32 v145, v145, v118, v119
    v_max_f32 v145, v145, v148
    v_mov_b32 v148, v144
    v_mov_b32 v149, v145
    s_nop 0
    v_permlane16_swap_b32 v148, v144
    v_permlane16_swap_b32 v149, v145
    v_max_f32 v144, v144, v148
    v_max_f32 v145, v145, v149
    v_mov_b32 v148, v144
    v_mov_b32 v149, v145
    s_nop 0
    v_permlane32_swap_b32 v148, v144
    v_permlane32_swap_b32 v149, v145
    v_max_f32 v144, v144, v148
    v_max_f32_e64 v145, v145, v149
    buffer_load_dwordx4 v241, s[20:23], s90 offen offset:1024 lds
    v_mul_f32 v144, s57, v144
    v_mul_f32 v145, s57, v145
    v_fma_f32 v104, v104, s57, -v144
    v_fma_f32 v105, v105, s57, -v144
    v_fma_f32 v106, v106, s57, -v144
    v_fma_f32 v107, v107, s57, -v144
    v_fma_f32 v108, v108, s57, -v144
    v_fma_f32 v109, v109, s57, -v144
    v_fma_f32 v110, v110, s57, -v144
    v_fma_f32 v111, v111, s57, -v144
    buffer_load_dwordx4 v242, s[20:23], s90 offen offset:2048 lds
    v_exp_f32 v104, v104
    v_exp_f32 v105, v105
    v_exp_f32 v106, v106
    v_exp_f32 v107, v107
    v_exp_f32 v108, v108
    v_exp_f32 v109, v109
    v_exp_f32 v110, v110
    v_exp_f32 v111, v111
    buffer_load_dwordx4 v243, s[20:23], s90 offen offset:3072 lds
    v_cvt_pk_bf16_f32 v120, v104, v105
    v_cvt_pk_bf16_f32 v121, v106, v107
    v_cvt_pk_bf16_f32 v122, v108, v109
    v_cvt_pk_bf16_f32 v123, v110, v111
    s_waitcnt vmcnt(6)
    s_nop 0
    v_mfma_f32_16x16x32_bf16 v[128:131], v[88:91], v[120:123], 0
    v_mfma_f32_16x16x32_bf16 v[132:135], v[92:95], v[120:123], 0
    v_fma_f32 v112, v112, s57, -v145
    v_fma_f32 v113, v113, s57, -v145
    v_fma_f32 v114, v114, s57, -v145
    v_fma_f32 v115, v115, s57, -v145
    v_fma_f32 v116, v116, s57, -v145
    v_fma_f32 v117, v117, s57, -v145
    v_fma_f32 v118, v118, s57, -v145
    v_fma_f32 v119, v119, s57, -v145
    s_add_u32 m0, s49, 16384
    s_add_u32 s90, s88, 688128
    buffer_load_dwordx4 v240, s[20:23], s90 offen offset:0 lds
    v_exp_f32 v112, v112
    v_exp_f32 v113, v113
    v_exp_f32 v114, v114
    v_exp_f32 v115, v115
    v_exp_f32 v116, v116
    v_exp_f32 v117, v117
    v_exp_f32 v118, v118
    v_exp_f32 v119, v119
    buffer_load_dwordx4 v241, s[20:23], s90 offen offset:1024 lds
    v_cvt_pk_bf16_f32 v124, v112, v113
    v_cvt_pk_bf16_f32 v125, v114, v115
    v_cvt_pk_bf16_f32 v126, v116, v117
    v_cvt_pk_bf16_f32 v127, v118, v119
    s_waitcnt vmcnt(6)
    s_nop 0
    v_mfma_f32_16x16x32_bf16 v[136:139], v[96:99], v[124:127], 0
    v_mfma_f32_16x16x32_bf16 v[140:143], v[100:103], v[124:127], 0
    v_add_f32 v104, v104, v105
    v_add_f32 v106, v106, v107
    v_add_f32 v108, v108, v109
    v_add_f32 v110, v110, v111
    v_add_f32 v104, v104, v106
    v_add_f32 v108, v108, v110
    v_add_f32 v146, v104, v108
    v_add_f32 v112, v112, v113
    v_add_f32 v114, v114, v115
    v_add_f32 v116, v116, v117
    v_add_f32 v118, v118, v119
    v_add_f32 v112, v112, v114
    v_add_f32 v116, v116, v118
    v_add_f32 v147, v112, v116
    buffer_load_dwordx4 v242, s[20:23], s90 offen offset:2048 lds
    v_mov_b32 v148, v146
    v_mov_b32 v149, v147
    s_nop 0
    v_permlane16_swap_b32 v148, v146
    v_permlane16_swap_b32 v149, v147
    v_add_f32 v146, v146, v148
    v_add_f32 v147, v147, v149
    v_mov_b32 v148, v146
    v_mov_b32 v149, v147
    s_nop 0
    v_permlane32_swap_b32 v148, v146
    v_permlane32_swap_b32 v149, v147
    v_add_f32 v146, v146, v148
    v_add_f32 v147, v147, v149
    buffer_load_dwordx4 v243, s[20:23], s90 offen offset:3072 lds
    v_rcp_f32 v148, v146
    v_rcp_f32 v150, v147
    v_cndmask_b32 v149, 0, v148, s[0:1]
    v_cndmask_b32 v151, 0, v150, s[0:1]
    s_cmp_eq_u32 s45, 0
    s_cbranch_scc1 Ls_24
    v_pk_mul_f32 v[128:129], v[128:129], v[148:149] op_sel:[0,0] op_sel_hi:[1,0]
    v_pk_mul_f32 v[130:131], v[130:131], v[148:149] op_sel:[0,0] op_sel_hi:[1,0]
    v_pk_mul_f32 v[132:133], v[132:133], v[148:149] op_sel:[0,1] op_sel_hi:[1,1]
    v_pk_mul_f32 v[134:135], v[134:135], v[148:149] op_sel:[0,1] op_sel_hi:[1,1]
    v_cvt_pk_bf16_f32 v120, v128, v129
    v_cvt_pk_bf16_f32 v121, v130, v131
    v_cvt_pk_bf16_f32 v122, v132, v133
    v_cvt_pk_bf16_f32 v123, v134, v135
    buffer_store_dwordx4 v[120:123], v180, s[32:35], s97 offen
    v_pk_mul_f32 v[136:137], v[136:137], v[150:151] op_sel:[0,0] op_sel_hi:[1,0]
    v_pk_mul_f32 v[138:139], v[138:139], v[150:151] op_sel:[0,0] op_sel_hi:[1,0]
    v_pk_mul_f32 v[140:141], v[140:141], v[150:151] op_sel:[0,1] op_sel_hi:[1,1]
    v_pk_mul_f32 v[142:143], v[142:143], v[150:151] op_sel:[0,1] op_sel_hi:[1,1]
    v_cvt_pk_bf16_f32 v124, v136, v137
    v_cvt_pk_bf16_f32 v125, v138, v139
    v_cvt_pk_bf16_f32 v126, v140, v141
    v_cvt_pk_bf16_f32 v127, v142, v143
    buffer_store_dwordx4 v[124:127], v180, s[32:35], s98 offen
    s_branch Ls_25
Ls_24:
    s_nop 7
    s_nop 3
    s_nop 0
    v_pk_mul_f32 v[128:129], v[128:129], v[148:149] op_sel:[0,0] op_sel_hi:[1,0]
    v_pk_mul_f32 v[130:131], v[130:131], v[148:149] op_sel:[0,0] op_sel_hi:[1,0]
    v_pk_mul_f32 v[132:133], v[132:133], v[148:149] op_sel:[0,1] op_sel_hi:[1,1]
    v_pk_mul_f32 v[134:135], v[134:135], v[148:149] op_sel:[0,1] op_sel_hi:[1,1]
    v_cvt_pk_bf16_f32 v120, v128, v129
    v_cvt_pk_bf16_f32 v121, v130, v131
    v_cvt_pk_bf16_f32 v122, v132, v133
    v_cvt_pk_bf16_f32 v123, v134, v135
    buffer_store_dwordx4 v[120:123], v180, s[32:35], s97 offen sc1
    v_pk_mul_f32 v[136:137], v[136:137], v[150:151] op_sel:[0,0] op_sel_hi:[1,0]
    v_pk_mul_f32 v[138:139], v[138:139], v[150:151] op_sel:[0,0] op_sel_hi:[1,0]
    v_pk_mul_f32 v[140:141], v[140:141], v[150:151] op_sel:[0,1] op_sel_hi:[1,1]
    v_pk_mul_f32 v[142:143], v[142:143], v[150:151] op_sel:[0,1] op_sel_hi:[1,1]
    v_cvt_pk_bf16_f32 v124, v136, v137
    v_cvt_pk_bf16_f32 v125, v138, v139
    v_cvt_pk_bf16_f32 v126, v140, v141
    v_cvt_pk_bf16_f32 v127, v142, v143
    buffer_store_dwordx4 v[124:127], v180, s[32:35], s98 offen sc1
Ls_25:
    ds_read_b64_tr_b16 a[84:85], v186 offset:43008
    ds_read_b64_tr_b16 a[86:87], v190 offset:43008
    ds_read_b64_tr_b16 a[196:197], v187 offset:43008
    ds_read_b64_tr_b16 a[198:199], v191 offset:43008
    ds_read_b64_tr_b16 a[88:89], v186 offset:46592
    ds_read_b64_tr_b16 a[90:91], v190 offset:46592
    ds_read_b64_tr_b16 a[200:201], v187 offset:46592
    ds_read_b64_tr_b16 a[202:203], v191 offset:46592
    ds_read_b64_tr_b16 a[92:93], v184 offset:46592
    ds_read_b64_tr_b16 a[94:95], v188 offset:46592
    ds_read_b64_tr_b16 a[204:205], v185 offset:46592
    ds_read_b64_tr_b16 a[206:207], v189 offset:46592
    ds_read_b64_tr_b16 a[96:97], v184 offset:50176
    ds_read_b64_tr_b16 a[98:99], v188 offset:50176
    ds_read_b64_tr_b16 a[208:209], v185 offset:50176
    ds_read_b64_tr_b16 a[210:211], v189 offset:50176
    ds_read_b64_tr_b16 a[100:101], v186 offset:50176
    ds_read_b64_tr_b16 a[102:103], v190 offset:50176
    ds_read_b64_tr_b16 a[212:213], v187 offset:50176
    ds_read_b64_tr_b16 a[214:215], v191 offset:50176
    ds_read_b64_tr_b16 a[104:105], v186 offset:53760
    ds_read_b64_tr_b16 a[106:107], v190 offset:53760
    ds_read_b64_tr_b16 a[216:217], v187 offset:53760
    ds_read_b64_tr_b16 a[218:219], v191 offset:53760
    ds_read_b64_tr_b16 a[108:109], v184 offset:53760
    ds_read_b64_tr_b16 a[110:111], v188 offset:53760
    ds_read_b64_tr_b16 a[220:221], v185 offset:53760
    ds_read_b64_tr_b16 a[222:223], v189 offset:53760
    v_mov_b32_e64 v14, s46
    s_cmp_eq_u32 s45, 0
    s_mov_b64 exec, 1
    s_waitcnt vmcnt(0)
    s_cbranch_scc1 Lf_26
    buffer_store_dword v14, off, s[32:35], s7
    s_branch Lf_27
Lf_26:
    buffer_store_dword v14, off, s[32:35], s7 sc1
Lf_27:
    s_mov_b64 exec, -1
    s_cmp_ge_u32 s41, 28
    s_cbranch_scc1 L_bserv
    v_mov_b32 v160, 0x3f803f80
    v_mov_b32 v156, 0
    v_mov_b32 v158, 0
    v_mov_b32 v157, s46
    v_mov_b32 v159, s46
    s_waitcnt lgkmcnt(0)
    s_barrier
    ds_write_b128 v213, v[204:207] offset:0
    ds_write_b128 v213, v[208:211] offset:64
    ds_read_b64 v[96:97], v214 offset:0
    ds_read_b64 v[98:99], v214 offset:32
    ds_read_b64 v[100:101], v214 offset:64
    ds_read_b64 v[102:103], v214 offset:96
    s_mov_b32 s50, 0x40000
Lp_28:
    buffer_load_dword v15, v233, s[32:35], s60 offen sc1
    s_waitcnt vmcnt(0)
    v_cmp_ne_u32 vcc, s46, v15
    s_cbranch_vccz Lp_29
    s_sub_u32 s50, s50, 1
    s_cmp_lg_u32 s50, 0
    s_cbranch_scc1 Lp_28
Lp_29:
    buffer_load_dwordx4 v[16:19], v181, s[32:35], s64 offen offset:0 sc1
    buffer_load_dwordx4 v[20:23], v182, s[32:35], s64 offen offset:896 sc1
    buffer_load_dwordx4 v[24:27], v181, s[32:35], s64 offen offset:1792 sc1
    buffer_load_dwordx4 v[28:31], v182, s[32:35], s64 offen offset:2688 sc1
    s_add_u32 s64, s64, 3584
    buffer_load_dwordx4 v[32:35], v181, s[32:35], s64 offen offset:0 sc1
    s_waitcnt lgkmcnt(0)
    v_lshlrev_b32 v80, 16, v96
    v_and_b32 v81, s61, v96
    v_lshlrev_b32 v82, 16, v97
    v_and_b32 v83, s61, v97
    v_lshlrev_b32 v84, 16, v98
    v_and_b32 v85, s61, v98
    v_lshlrev_b32 v86, 16, v99
    v_and_b32 v87, s61, v99
    v_lshlrev_b32 v88, 16, v100
    v_and_b32 v89, s61, v100
    v_lshlrev_b32 v90, 16, v101
    v_and_b32 v91, s61, v101
    v_lshlrev_b32 v92, 16, v102
    v_and_b32 v93, s61, v102
    v_lshlrev_b32 v94, 16, v103
    v_and_b32 v95, s61, v103
    s_waitcnt vmcnt(4)
    v_mfma_f32_16x16x32_bf16 v[80:83], a[224:227], v[16:19], v[80:83]
    buffer_load_dwordx4 v[36:39], v182, s[32:35], s64 offen offset:896 sc1
    v_mfma_f32_16x16x32_bf16 v[84:87], a[228:231], v[16:19], v[84:87]
    v_mfma_f32_16x16x32_bf16 v[88:91], a[232:235], v[16:19], v[88:91]
    v_mfma_f32_16x16x32_bf16 v[92:95], a[236:239], v[16:19], v[92:95]
    s_waitcnt vmcnt(4)
    s_nop 0
    v_mfma_f32_16x16x32_bf16 v[80:83], a[240:243], v[20:23], v[80:83]
    buffer_load_dwordx4 v[40:43], v181, s[32:35], s64 offen offset:1792 sc1
    v_mfma_f32_16x16x32_bf16 v[84:87], a[244:247], v[20:23], v[84:87]
    v_mfma_f32_16x16x32_bf16 v[88:91], a[248:251], v[20:23], v[88:91]
    v_mfma_f32_16x16x32_bf16 v[92:95], a[252:255], v[20:23], v[92:95]
    s_waitcnt vmcnt(4)
    v_mfma_f32_16x16x32_bf16 v[80:83], a[0:3], v[24:27], v[80:83]
    buffer_load_dwordx4 v[44:47], v182, s[32:35], s64 offen offset:2688 sc1
    v_mfma_f32_16x16x32_bf16 v[84:87], a[112:115], v[24:27], v[84:87]
    v_mfma_f32_16x16x32_bf16 v[88:91], a[4:7], v[24:27], v[88:91]
    v_mfma_f32_16x16x32_bf16 v[92:95], a[116:119], v[24:27], v[92:95]
    s_waitcnt vmcnt(4)
    v_mfma_f32_16x16x32_bf16 v[80:83], a[8:11], v[28:31], v[80:83]
    s_add_u32 s64, s64, 3584
    buffer_load_dwordx4 v[48:51], v181, s[32:35], s64 offen offset:0 sc1
    v_mfma_f32_16x16x32_bf16 v[84:87], a[120:123], v[28:31], v[84:87]
    v_mfma_f32_16x16x32_bf16 v[88:91], a[12:15], v[28:31], v[88:91]
    v_mfma_f32_16x16x32_bf16 v[92:95], a[124:127], v[28:31], v[92:95]
    s_waitcnt vmcnt(4)
    v_mfma_f32_16x16x32_bf16 v[80:83], a[16:19], v[32:35], v[80:83]
    buffer_load_dwordx4 v[52:55], v182, s[32:35], s64 offen offset:896 sc1
    v_mfma_f32_16x16x32_bf16 v[84:87], a[128:131], v[32:35], v[84:87]
    v_mfma_f32_16x16x32_bf16 v[88:91], a[20:23], v[32:35], v[88:91]
    v_mfma_f32_16x16x32_bf16 v[92:95], a[132:135], v[32:35], v[92:95]
    s_waitcnt vmcnt(4)
    v_mfma_f32_16x16x32_bf16 v[80:83], a[24:27], v[36:39], v[80:83]
    buffer_load_dwordx4 v[56:59], v181, s[32:35], s64 offen offset:1792 sc1
    v_mfma_f32_16x16x32_bf16 v[84:87], a[136:139], v[36:39], v[84:87]
    v_mfma_f32_16x16x32_bf16 v[88:91], a[28:31], v[36:39], v[88:91]
    v_mfma_f32_16x16x32_bf16 v[92:95], a[140:143], v[36:39], v[92:95]
    s_waitcnt vmcnt(4)
    v_mfma_f32_16x16x32_bf16 v[80:83], a[32:35], v[40:43], v[80:83]
    buffer_load_dwordx4 v[60:63], v182, s[32:35], s64 offen offset:2688 sc1
    v_mfma_f32_16x16x32_bf16 v[84:87], a[144:147], v[40:43], v[84:87]
    v_mfma_f32_16x16x32_bf16 v[88:91], a[36:39], v[40:43], v[88:91]
    v_mfma_f32_16x16x32_bf16 v[92:95], a[148:151], v[40:43], v[92:95]
    s_waitcnt vmcnt(4)
    v_mfma_f32_16x16x32_bf16 v[80:83], a[40:43], v[44:47], v[80:83]
    s_add_u32 s64, s64, 3584
    buffer_load_dwordx4 v[64:67], v181, s[32:35], s64 offen offset:0 sc1
    v_mfma_f32_16x16x32_bf16 v[84:87], a[152:155], v[44:47], v[84:87]
    v_mfma_f32_16x16x32_bf16 v[88:91], a[44:47], v[44:47], v[88:91]
    v_mfma_f32_16x16x32_bf16 v[92:95], a[156:159], v[44:47], v[92:95]
    s_waitcnt vmcnt(4)
    v_mfma_f32_16x16x32_bf16 v[80:83], a[48:51], v[48:51], v[80:83]
    buffer_load_dwordx4 v[68:71], v182, s[32:35], s64 offen offset:896 sc1
    v_mfma_f32_16x16x32_bf16 v[84:87], a[160:163], v[48:51], v[84:87]
    v_mfma_f32_16x16x32_bf16 v[88:91], a[52:55], v[48:51], v[88:91]
    v_mfma_f32_16x16x32_bf16 v[92:95], a[164:167], v[48:51], v[92:95]
    s_waitcnt vmcnt(4)
    v_mfma_f32_16x16x32_bf16 v[80:83], a[56:59], v[52:55], v[80:83]
    buffer_load_dwordx4 v[72:75], v181, s[32:35], s64 offen offset:1792 sc1
    v_mfma_f32_16x16x32_bf16 v[84:87], a[168:171], v[52:55], v[84:87]
    v_mfma_f32_16x16x32_bf16 v[88:91], a[60:63], v[52:55], v[88:91]
    v_mfma_f32_16x16x32_bf16 v[92:95], a[172:175], v[52:55], v[92:95]
    s_waitcnt vmcnt(4)
    v_mfma_f32_16x16x32_bf16 v[80:83], a[64:67], v[56:59], v[80:83]
    buffer_load_dwordx4 v[76:79], v182, s[32:35], s64 offen offset:2688 sc1
    v_mfma_f32_16x16x32_bf16 v[84:87], a[176:179], v[56:59], v[84:87]
    v_mfma_f32_16x16x32_bf16 v[88:91], a[68:71], v[56:59], v[88:91]
    v_mfma_f32_16x16x32_bf16 v[92:95], a[180:183], v[56:59], v[92:95]
    s_waitcnt vmcnt(4)
    v_mfma_f32_16x16x32_bf16 v[80:83], a[72:75], v[60:63], v[80:83]
    s_add_u32 m0, s49, 65536
    s_add_u32 s90, s88, 917504
    buffer_load_dwordx4 v240, s[20:23], s90 offen offset:0 lds
    v_mfma_f32_16x16x32_bf16 v[84:87], a[184:187], v[60:63], v[84:87]
    v_mfma_f32_16x16x32_bf16 v[88:91], a[76:79], v[60:63], v[88:91]
    v_mfma_f32_16x16x32_bf16 v[92:95], a[188:191], v[60:63], v[92:95]
    s_waitcnt vmcnt(4)
    v_mfma_f32_16x16x32_bf16 v[80:83], a[80:83], v[64:67], v[80:83]
    buffer_load_dwordx4 v241, s[20:23], s90 offen offset:1024 lds
    v_mfma_f32_16x16x32_bf16 v[84:87], a[192:195], v[64:67], v[84:87]
    v_mfma_f32_16x16x32_bf16 v[88:91], a[84:87], v[64:67], v[88:91]
    v_mfma_f32_16x16x32_bf16 v[92:95], a[196:199], v[64:67], v[92:95]
    s_waitcnt vmcnt(4)
    v_mfma_f32_16x16x32_bf16 v[80:83], a[88:91], v[68:71], v[80:83]
    buffer_load_dwordx4 v242, s[20:23], s90 offen offset:2048 lds
    v_mfma_f32_16x16x32_bf16 v[84:87], a[200:203], v[68:71], v[84:87]
    v_mfma_f32_16x16x32_bf16 v[88:91], a[92:95], v[68:71], v[88:91]
    v_mfma_f32_16x16x32_bf16 v[92:95], a[204:207], v[68:71], v[92:95]
    s_waitcnt vmcnt(4)
    v_mfma_f32_16x16x32_bf16 v[80:83], a[96:99], v[72:75], v[80:83]
    buffer_load_dwordx4 v243, s[20:23], s90 offen offset:3072 lds
    v_mfma_f32_16x16x32_bf16 v[84:87], a[208:211], v[72:75], v[84:87]
    v_mfma_f32_16x16x32_bf16 v[88:91], a[100:103], v[72:75], v[88:91]
    v_mfma_f32_16x16x32_bf16 v[92:95], a[212:215], v[72:75], v[92:95]
    s_waitcnt vmcnt(4)
    v_mfma_f32_16x16x32_bf16 v[80:83], a[104:107], v[76:79], v[80:83]
    s_add_u32 m0, s49, 81920
    s_add_u32 s90, s88, 1146880
    buffer_load_dwordx4 v240, s[20:23], s90 offen offset:0 lds
    v_mfma_f32_16x16x32_bf16 v[84:87], a[216:219], v[76:79], v[84:87]
    v_mfma_f32_16x16x32_bf16 v[88:91], a[108:111], v[76:79], v[88:91]
    v_mfma_f32_16x16x32_bf16 v[92:95], a[220:223], v[76:79], v[92:95]
    buffer_load_dwordx4 v241, s[20:23], s90 offen offset:1024 lds
    s_nop 0
    v_cvt_pk_bf16_f32 v104, v80, v81
    v_cvt_pk_bf16_f32 v105, v82, v83
    s_nop 1
    v_cvt_pk_bf16_f32 v106, v84, v85
    v_cvt_pk_bf16_f32 v107, v86, v87
    v_cvt_pk_bf16_f32 v108, v88, v89
    v_cvt_pk_bf16_f32 v109, v90, v91
    v_cvt_pk_bf16_f32 v110, v92, v93
    v_cvt_pk_bf16_f32 v111, v94, v95
    v_dot2c_f32_bf16 v156, v104, v160
    v_dot2c_f32_bf16 v158, v104, v104
    v_dot2c_f32_bf16 v156, v105, v160
    v_dot2c_f32_bf16 v158, v105, v105
    v_dot2c_f32_bf16 v156, v106, v160
    v_dot2c_f32_bf16 v158, v106, v106
    v_dot2c_f32_bf16 v156, v107, v160
    v_dot2c_f32_bf16 v158, v107, v107
    v_dot2c_f32_bf16 v156, v108, v160
    v_dot2c_f32_bf16 v158, v108, v108
    v_dot2c_f32_bf16 v156, v109, v160
    v_dot2c_f32_bf16 v158, v109, v109
    v_dot2c_f32_bf16 v156, v110, v160
    v_dot2c_f32_bf16 v158, v110, v110
    v_dot2c_f32_bf16 v156, v111, v160
    v_dot2c_f32_bf16 v158, v111, v111
    buffer_load_dwordx4 v242, s[20:23], s90 offen offset:2048 lds
    buffer_load_dwordx4 v243, s[20:23], s90 offen offset:3072 lds
    v_mov_b32 v162, v156
    v_mov_b32 v163, v158
    s_nop 0
    v_permlane16_swap_b32 v162, v156
    v_permlane16_swap_b32 v163, v158
    v_add_f32 v156, v156, v162
    v_add_f32 v158, v158, v163
    v_mov_b32 v162, v156
    v_mov_b32 v163, v158
    s_nop 0
    v_permlane32_swap_b32 v162, v156
    v_permlane32_swap_b32 v163, v158
    v_add_f32 v156, v156, v162
    v_add_f32 v158, v158, v163
    s_mov_b64 exec, 0xffff
    s_cmp_eq_u32 s45, 0
    s_cbranch_scc1 Ls_30
    buffer_store_dwordx4 v[156:159], v232, s[32:35], s66 offen
    s_branch Ls_31
Ls_30:
    s_nop 7
    s_nop 3
    buffer_store_dwordx4 v[156:159], v232, s[32:35], s66 offen sc1
Ls_31:
    s_mov_b64 exec, -1
    ds_write_b64 v214, v[104:105] offset:0
    ds_write_b64 v214, v[106:107] offset:32
    ds_write_b64 v214, v[108:109] offset:64
    ds_write_b64 v214, v[110:111] offset:96
    ds_read_b128 a[240:243], v215 offset:0
    ds_read_b128 a[244:247], v215 offset:1152
    v_lshlrev_b32 v80, 16, v104
    v_and_b32 v81, s61, v104
    v_lshlrev_b32 v82, 16, v105
    v_and_b32 v83, s61, v105
    v_lshlrev_b32 v84, 16, v106
    v_and_b32 v85, s61, v106
    v_lshlrev_b32 v86, 16, v107
    v_and_b32 v87, s61, v107
    v_lshlrev_b32 v88, 16, v108
    v_and_b32 v89, s61, v108
    v_lshlrev_b32 v90, 16, v109
    v_and_b32 v91, s61, v109
    v_lshlrev_b32 v92, 16, v110
    v_and_b32 v93, s61, v110
    v_lshlrev_b32 v94, 16, v111
    v_and_b32 v95, s61, v111
    s_mov_b32 s50, 0x40000
Lp_32:
    buffer_load_dwordx4 v[120:123], v253, s[32:35], s67 offen sc1
    buffer_load_dwordx4 v[124:127], v183, s[32:35], s67 offen offset:1024 sc1
    s_waitcnt vmcnt(0)
    v_xor_b32 v121, s46, v121
    v_xor_b32 v123, s46, v123
    v_xor_b32 v125, s46, v125
    v_xor_b32_e64 v127, s46, v127
    v_or3_b32 v121, v121, v123, v125
    v_or_b32 v121, v121, v127
    v_cmp_ne_u32 vcc, 0, v121
    s_cbranch_vccz Lp_33
    s_sub_u32 s50, s50, 1
    s_cmp_lg_u32 s50, 0
    s_cbranch_scc1 Lp_32
Lp_33:
    v_cndmask_b32 v124, 0, v124, s[0:1]
    v_cndmask_b32 v126, 0, v126, s[0:1]
    v_add_f32 v120, v120, v124
    v_add_f32 v122, v122, v126
    v_mov_b32 v162, v120
    v_mov_b32 v163, v122
    s_nop 0
    v_permlane16_swap_b32 v162, v120
    v_permlane16_swap_b32 v163, v122
    v_add_f32 v120, v120, v162
    v_add_f32 v122, v122, v163
    v_mov_b32 v162, v120
    v_mov_b32 v163, v122
    s_nop 0
    v_permlane32_swap_b32 v162, v120
    v_permlane32_swap_b32 v163, v122
    v_add_f32 v120, v120, v162
    v_add_f32 v122, v122, v163
    v_mul_f32 v120, 0x3b124925, v120
    v_mul_f32 v122, 0x3b124925, v122
    v_fma_f32 v122, -v120, v120, v122
    v_max_f32_e64 v122, 0, v122
    v_cvt_pk_bf16_f32 v122, v122, v122
    v_and_b32_e64 v122, s61, v122
    v_add_f32 v122, 0x3727c5ac, v122
    v_cvt_pk_bf16_f32 v122, v122, v122
    v_and_b32 v122, s61, v122
    v_sqrt_f32 v122, v122
    v_cvt_pk_bf16_f32 v120, v120, v120
    v_and_b32_e64 v120, s61, v120
    v_cvt_pk_bf16_f32 v122, v122, v122
    v_and_b32 v122, s61, v122
    v_rcp_f32 v164, v122
    s_nop 0
    v_mul_f32_e64 v165, -v120, v164
    s_waitcnt lgkmcnt(0)
    s_cmp_eq_u32 s45, 0
    s_cbranch_scc1 Ls_34
    v_pk_fma_f32 v[80:81], v[80:81], v[164:165], v[164:165] op_sel:[0,0,1] op_sel_hi:[1,0,1]
    v_pk_fma_f32 v[82:83], v[82:83], v[164:165], v[164:165] op_sel:[0,0,1] op_sel_hi:[1,0,1]
    v_pk_fma_f32 v[84:85], v[84:85], v[164:165], v[164:165] op_sel:[0,0,1] op_sel_hi:[1,0,1]
    v_pk_fma_f32 v[86:87], v[86:87], v[164:165], v[164:165] op_sel:[0,0,1] op_sel_hi:[1,0,1]
    v_cvt_pk_bf16_f32 v104, v80, v81
    v_cvt_pk_bf16_f32 v105, v82, v83
    v_cvt_pk_bf16_f32 v106, v84, v85
    v_cvt_pk_bf16_f32 v107, v86, v87
    buffer_store_dwordx4 v[104:107], v253, s[32:35], s65 offen offset:0
    v_pk_fma_f32 v[88:89], v[88:89], v[164:165], v[164:165] op_sel:[0,0,1] op_sel_hi:[1,0,1]
    v_pk_fma_f32 v[90:91], v[90:91], v[164:165], v[164:165] op_sel:[0,0,1] op_sel_hi:[1,0,1]
    v_pk_fma_f32 v[92:93], v[92:93], v[164:165], v[164:165] op_sel:[0,0,1] op_sel_hi:[1,0,1]
    v_pk_fma_f32 v[94:95], v[94:95], v[164:165], v[164:165] op_sel:[0,0,1] op_sel_hi:[1,0,1]
    v_cvt_pk_bf16_f32 v108, v88, v89
    v_cvt_pk_bf16_f32 v109, v90, v91
    v_cvt_pk_bf16_f32 v110, v92, v93
    v_cvt_pk_bf16_f32 v111, v94, v95
    buffer_store_dwordx4 v[108:111], v253, s[32:35], s65 offen offset:1024
    s_branch Ls_35
Ls_34:
    s_nop 7
    s_nop 3
    s_nop 0
    v_pk_fma_f32 v[80:81], v[80:81], v[164:165], v[164:165] op_sel:[0,0,1] op_sel_hi:[1,0,1]
    v_pk_fma_f32 v[82:83], v[82:83], v[164:165], v[164:165] op_sel:[0,0,1] op_sel_hi:[1,0,1]
    v_pk_fma_f32 v[84:85], v[84:85], v[164:165], v[164:165] op_sel:[0,0,1] op_sel_hi:[1,0,1]
    v_pk_fma_f32 v[86:87], v[86:87], v[164:165], v[164:165] op_sel:[0,0,1] op_sel_hi:[1,0,1]
    v_cvt_pk_bf16_f32 v104, v80, v81
    v_cvt_pk_bf16_f32 v105, v82, v83
    v_cvt_pk_bf16_f32 v106, v84, v85
    v_cvt_pk_bf16_f32 v107, v86, v87
    buffer_store_dwordx4 v[104:107], v253, s[32:35], s65 offen offset:0 sc1
    v_pk_fma_f32 v[88:89], v[88:89], v[164:165], v[164:165] op_sel:[0,0,1] op_sel_hi:[1,0,1]
    v_pk_fma_f32 v[90:91], v[90:91], v[164:165], v[164:165] op_sel:[0,0,1] op_sel_hi:[1,0,1]
    v_pk_fma_f32 v[92:93], v[92:93], v[164:165], v[164:165] op_sel:[0,0,1] op_sel_hi:[1,0,1]
    v_pk_fma_f32 v[94:95], v[94:95], v[164:165], v[164:165] op_sel:[0,0,1] op_sel_hi:[1,0,1]
    v_cvt_pk_bf16_f32 v108, v88, v89
    v_cvt_pk_bf16_f32 v109, v90, v91
    v_cvt_pk_bf16_f32 v110, v92, v93
    v_cvt_pk_bf16_f32 v111, v94, v95
    buffer_store_dwordx4 v[108:111], v253, s[32:35], s65 offen offset:1024 sc1
Ls_35:
    s_and_b32 s51, s42, 1
    s_mul_i32 s50, s44, 43
    s_lshr_b32 s50, s50, 7
    s_mul_i32 s50, s50, 3
    s_sub_u32 s50, s44, s50
    s_lshl_b32 s50, s50, 2
    s_lshr_b32 s50, 0x20420, s50
    s_bfe_u32 s91, s50, 0x40000
    s_add_u32 s91, s91, s51
    s_bfe_u32 s92, s50, 0x40004
    s_add_u32 s92, s92, s51
    s_bfe_u32 s93, s50, 0x40008
    s_add_u32 s93, s93, s51
    s_cmp_eq_u32 s51, 0
    s_mov_b32 s50, 0x04206420
    s_cselect_b32 s50, 0x03165316, s50
    s_and_b32 s51, s44, 3
    s_lshl_b32 s51, s51, 2
    s_lshr_b32 s50, s50, s51
    s_bfe_u32 s94, s50, 0x40000
    s_bfe_u32 s95, s50, 0x40004
    s_bfe_u32 s96, s50, 0x40008
    s_bfe_u32 s97, s50, 0x4000c
    s_mov_b32 s80, 458752
    s_cmp_eq_u32 s45, 0
    s_cselect_b32 s81, s80, 4293754880
    s_cselect_b32 s80, s80, 4294242304
    s_cmp_ge_u32 s69, 1277952
    s_cselect_b32 s82, s81, s80
    s_add_u32 s82, s82, s69
    s_and_b32 s83, s59, 0xffffff84
    v_min_u32 v1, 13, v0
    v_lshlrev_b32 v1, 3, v1
    v_mov_b32_e64 v14, s46
    s_cmp_eq_u32 s45, 0
    s_mov_b64 exec, 1
    s_waitcnt vmcnt(0)
    s_cbranch_scc1 Lf_36
    buffer_store_dword v14, off, s[32:35], s47
    s_branch Lf_37
Lf_36:
    buffer_store_dword v14, off, s[32:35], s47 sc1
Lf_37:
    s_mov_b64 exec, -1
    s_add_u32 m0, s49, 98304
    s_add_u32 s90, s88, 1376256
    buffer_load_dwordx4 v240, s[20:23], s90 offen offset:0 lds
    buffer_load_dwordx4 v241, s[20:23], s90 offen offset:1024 lds
    buffer_load_dwordx4 v242, s[20:23], s90 offen offset:2048 lds
    buffer_load_dwordx4 v243, s[20:23], s90 offen offset:3072 lds
    s_add_u32 m0, s49, 114688
    s_add_u32 s90, s88, 128
    buffer_load_dwordx4 v240, s[20:23], s90 offen offset:0 lds
    buffer_load_dwordx4 v241, s[20:23], s90 offen offset:1024 lds
    buffer_load_dwordx4 v242, s[20:23], s90 offen offset:2048 lds
    buffer_load_dwordx4 v243, s[20:23], s90 offen offset:3072 lds
    ds_read_b64_tr_b16 a[112:113], v4 offset:32768
    ds_read_b64_tr_b16 a[114:115], v4 offset:34816
    ds_read_b64_tr_b16 a[116:117], v4 offset:40960
    ds_read_b64_tr_b16 a[118:119], v4 offset:43008
    ds_read_b64_tr_b16 a[120:121], v5 offset:32768
    ds_read_b64_tr_b16 a[122:123], v5 offset:34816
    ds_read_b64_tr_b16 a[124:125], v5 offset:40960
    ds_read_b64_tr_b16 a[126:127], v5 offset:43008
    ds_read_b64_tr_b16 a[128:129], v6 offset:32768
    ds_read_b64_tr_b16 a[130:131], v6 offset:34816
    ds_read_b64_tr_b16 a[132:133], v6 offset:40960
    ds_read_b64_tr_b16 a[134:135], v6 offset:43008
    ds_read_b64_tr_b16 a[136:137], v7 offset:32768
    ds_read_b64_tr_b16 a[138:139], v7 offset:34816
    ds_read_b64_tr_b16 a[140:141], v7 offset:40960
    ds_read_b64_tr_b16 a[142:143], v7 offset:43008
    ds_read_b64_tr_b16 a[144:145], v4 offset:36864
    ds_read_b64_tr_b16 a[146:147], v4 offset:38912
    ds_read_b64_tr_b16 a[148:149], v4 offset:45056
    ds_read_b64_tr_b16 a[150:151], v4 offset:47104
    ds_read_b64_tr_b16 a[152:153], v5 offset:36864
    ds_read_b64_tr_b16 a[154:155], v5 offset:38912
    ds_read_b64_tr_b16 a[156:157], v5 offset:45056
    ds_read_b64_tr_b16 a[158:159], v5 offset:47104
    s_mul_i32 s50, s42, 7
    s_lshr_b32 s50, s50, 1
    s_lshl_b32 s50, s50, 3
    s_lshl_b32 s71, s43, 7
    s_add_u32 s71, s71, s50
    s_add_u32 s71, s71, 6144
    s_add_u32 s79, s71, 512
    s_mul_i32 s64, s43, 57344
    s_add_u32 s64, s64, 1048576
    s_mul_i32 s65, s42, 7
    s_cmp_ge_u32 s42, 2
    s_cselect_b32 s80, s81, s80
    s_cselect_b32 s50, 200704, 0
    s_add_u32 s64, s64, s50
    s_add_u32 s50, s65, s91
    s_bitcmp1_b32 s50, 0
    s_cselect_b32 s51, s80, 0
    s_lshr_b32 s50, s50, 1
    s_lshl_b32 s50, s50, 12
    s_add_u32 s72, s50, s64
    s_add_u32 s72, s72, s51
    s_add_u32 s50, s65, s92
    s_bitcmp1_b32 s50, 0
    s_cselect_b32 s51, s80, 0
    s_lshr_b32 s50, s50, 1
    s_lshl_b32 s50, s50, 12
    s_add_u32 s73, s50, s64
    s_add_u32 s73, s73, s51
    s_add_u32 s50, s65, s93
    s_bitcmp1_b32 s50, 0
    s_cselect_b32 s51, s80, 0
    s_lshr_b32 s50, s50, 1
    s_lshl_b32 s50, s50, 12
    s_add_u32 s74, s50, s64
    s_add_u32 s74, s74, s51
    s_add_u32 s50, s65, s94
    s_bitcmp1_b32 s50, 0
    s_cselect_b32 s51, s80, 0
    s_lshr_b32 s50, s50, 1
    s_lshl_b32 s50, s50, 12
    s_add_u32 s75, s50, s64
    s_add_u32 s75, s75, s51
    s_add_u32 s50, s65, s95
    s_bitcmp1_b32 s50, 0
    s_cselect_b32 s51, s80, 0
    s_lshr_b32 s50, s50, 1
    s_lshl_b32 s50, s50, 12
    s_add_u32 s76, s50, s64
    s_add_u32 s76, s76, s51
    s_add_u32 s50, s65, s96
    s_bitcmp1_b32 s50, 0
    s_cselect_b32 s51, s80, 0
    s_lshr_b32 s50, s50, 1
    s_lshl_b32 s50, s50, 12
    s_add_u32 s77, s50, s64
    s_add_u32 s77, s77, s51
    s_add_u32 s50, s65, s97
    s_bitcmp1_b32 s50, 0
    s_cselect_b32 s51, s80, 0
    s_lshr_b32 s50, s50, 1
    s_lshl_b32 s50, s50, 12
    s_add_u32 s78, s50, s64
    s_add_u32 s78, s78, s51
    v_and_b32 v2, 7, v0
    v_lshlrev_b32 v2, 2, v2
    v_add_u32 v3, 28672, v253
    v_mov_b32_e64 v252, s46
    s_mov_b32 s50, 0x40000
Lp_38:
    buffer_load_dword v15, v234, s[32:35], s62 offen sc1
    s_waitcnt vmcnt(0)
    v_cmp_ne_u32 vcc, s46, v15
    s_cbranch_vccz Lp_39
    s_sub_u32 s50, s50, 1
    s_cmp_lg_u32 s50, 0
    s_cbranch_scc1 Lp_38
Lp_39:
    buffer_load_dwordx4 a[0:3], v253, s[32:35], s68 offen offset:0 sc1
    buffer_load_dwordx4 a[4:7], v12, s[32:35], s68 offen offset:0 sc1
    buffer_load_dwordx4 a[8:11], v253, s[32:35], s68 offen offset:1024 sc1
    buffer_load_dwordx4 a[12:15], v12, s[32:35], s68 offen offset:1024 sc1
    s_waitcnt vmcnt(2) lgkmcnt(15)
    s_nop 0
    v_mfma_f32_16x16x32_bf16 v[112:115], a[112:115], a[0:3], 0
    ds_read_b64_tr_b16 a[160:161], v6 offset:36864
    v_mfma_f32_16x16x32_bf16 v[128:131], a[112:115], a[4:7], 0
    ds_read_b64_tr_b16 a[162:163], v6 offset:38912
    v_mfma_f32_16x16x32_bf16 v[120:123], a[116:119], a[0:3], 0
    ds_read_b64_tr_b16 a[164:165], v6 offset:45056
    ds_read_b64_tr_b16 a[166:167], v6 offset:47104
    v_mfma_f32_16x16x32_bf16 v[136:139], a[116:119], a[4:7], 0
    buffer_load_dwordx4 a[16:19], v253, s[32:35], s68 offen offset:2048 sc1
    v_mfma_f32_16x16x32_bf16 v[116:119], a[120:123], a[0:3], 0
    ds_read_b64_tr_b16 a[168:169], v7 offset:36864
    v_mfma_f32_16x16x32_bf16 v[132:135], a[120:123], a[4:7], 0
    ds_read_b64_tr_b16 a[170:171], v7 offset:38912
    ds_read_b64_tr_b16 a[172:173], v7 offset:45056
    v_mfma_f32_16x16x32_bf16 v[124:127], a[124:127], a[0:3], 0
    ds_read_b64_tr_b16 a[174:175], v7 offset:47104
    v_mfma_f32_16x16x32_bf16 v[140:143], a[124:127], a[4:7], 0
    buffer_load_dwordx4 a[20:23], v12, s[32:35], s68 offen offset:2048 sc1
    s_waitcnt lgkmcnt(15)
    s_nop 0
    v_mfma_f32_16x16x32_bf16 v[144:147], a[128:131], a[0:3], 0
    ds_read_b64_tr_b16 a[176:177], v4 offset:49152
    v_mfma_f32_16x16x32_bf16 v[160:163], a[128:131], a[4:7], 0
    ds_read_b64_tr_b16 a[178:179], v4 offset:51200
    v_mfma_f32_16x16x32_bf16 v[152:155], a[132:135], a[0:3], 0
    ds_read_b64_tr_b16 a[180:181], v4 offset:57344
    ds_read_b64_tr_b16 a[182:183], v4 offset:59392
    v_mfma_f32_16x16x32_bf16 v[168:171], a[132:135], a[4:7], 0
    buffer_load_dwordx4 a[24:27], v253, s[32:35], s68 offen offset:3072 sc1
    v_mfma_f32_16x16x32_bf16 v[148:151], a[136:139], a[0:3], 0
    ds_read_b64_tr_b16 a[184:185], v5 offset:49152
    v_mfma_f32_16x16x32_bf16 v[164:167], a[136:139], a[4:7], 0
    ds_read_b64_tr_b16 a[186:187], v5 offset:51200
    ds_read_b64_tr_b16 a[188:189], v5 offset:57344
    v_mfma_f32_16x16x32_bf16 v[156:159], a[140:143], a[0:3], 0
    ds_read_b64_tr_b16 a[190:191], v5 offset:59392
    v_mfma_f32_16x16x32_bf16 v[172:175], a[140:143], a[4:7], 0
    buffer_load_dwordx4 a[28:31], v12, s[32:35], s68 offen offset:3072 sc1
    s_waitcnt vmcnt(4) lgkmcnt(15)
    s_nop 0
    v_mfma_f32_16x16x32_bf16 v[112:115], a[144:147], a[8:11], v[112:115]
    ds_read_b64_tr_b16 a[192:193], v6 offset:49152
    v_mfma_f32_16x16x32_bf16 v[128:131], a[144:147], a[12:15], v[128:131]
    ds_read_b64_tr_b16 a[194:195], v6 offset:51200
    ds_read_b64_tr_b16 a[196:197], v6 offset:57344
    v_mfma_f32_16x16x32_bf16 v[120:123], a[148:151], a[8:11], v[120:123]
    ds_read_b64_tr_b16 a[198:199], v6 offset:59392
    s_add_u32 s68, s68, 4096
    v_mfma_f32_16x16x32_bf16 v[136:139], a[148:151], a[12:15], v[136:139]
    buffer_load_dwordx4 a[32:35], v253, s[32:35], s68 offen offset:0 sc1
    ds_read_b64_tr_b16 a[200:201], v7 offset:49152
    v_mfma_f32_16x16x32_bf16 v[116:119], a[152:155], a[8:11], v[116:119]
    ds_read_b64_tr_b16 a[202:203], v7 offset:51200
    ds_read_b64_tr_b16 a[204:205], v7 offset:57344
    v_mfma_f32_16x16x32_bf16 v[132:135], a[152:155], a[12:15], v[132:135]
    ds_read_b64_tr_b16 a[206:207], v7 offset:59392
    s_mul_i32 s90, s91, 57344
    v_mfma_f32_16x16x32_bf16 v[124:127], a[156:159], a[8:11], v[124:127]
    s_add_u32 m0, s89, 131072
    s_add_u32 s90, s90, s70
    v_mfma_f32_16x16x32_bf16 v[140:143], a[156:159], a[12:15], v[140:143]
    buffer_load_dwordx4 v244, s[24:27], s90 offen offset:0 lds
    s_waitcnt lgkmcnt(15)
    v_mfma_f32_16x16x32_bf16 v[144:147], a[160:163], a[8:11], v[144:147]
    ds_read_b64_tr_b16 a[208:209], v4 offset:53248
    v_mfma_f32_16x16x32_bf16 v[160:163], a[160:163], a[12:15], v[160:163]
    ds_read_b64_tr_b16 a[210:211], v4 offset:55296
    v_mfma_f32_16x16x32_bf16 v[152:155], a[164:167], a[8:11], v[152:155]
    ds_read_b64_tr_b16 a[212:213], v4 offset:61440
    ds_read_b64_tr_b16 a[214:215], v4 offset:63488
    v_mfma_f32_16x16x32_bf16 v[168:171], a[164:167], a[12:15], v[168:171]
    buffer_load_dwordx4 a[36:39], v12, s[32:35], s68 offen offset:0 sc1
    v_mfma_f32_16x16x32_bf16 v[148:151], a[168:171], a[8:11], v[148:151]
    ds_read_b64_tr_b16 a[216:217], v5 offset:53248
    v_mfma_f32_16x16x32_bf16 v[164:167], a[168:171], a[12:15], v[164:167]
    ds_read_b64_tr_b16 a[218:219], v5 offset:55296
    ds_read_b64_tr_b16 a[220:221], v5 offset:61440
    v_mfma_f32_16x16x32_bf16 v[156:159], a[172:175], a[8:11], v[156:159]
    ds_read_b64_tr_b16 a[222:223], v5 offset:63488
    v_mfma_f32_16x16x32_bf16 v[172:175], a[172:175], a[12:15], v[172:175]
    buffer_load_dwordx4 v245, s[24:27], s90 offen offset:1024 lds
    s_waitcnt vmcnt(6) lgkmcnt(15)
    s_nop 0
    v_mfma_f32_16x16x32_bf16 v[112:115], a[176:179], a[16:19], v[112:115]
    ds_read_b64_tr_b16 a[224:225], v6 offset:53248
    v_mfma_f32_16x16x32_bf16 v[128:131], a[176:179], a[20:23], v[128:131]
    ds_read_b64_tr_b16 a[226:227], v6 offset:55296
    v_mfma_f32_16x16x32_bf16 v[120:123], a[180:183], a[16:19], v[120:123]
    ds_read_b64_tr_b16 a[228:229], v6 offset:61440
    ds_read_b64_tr_b16 a[230:231], v6 offset:63488
    v_mfma_f32_16x16x32_bf16 v[136:139], a[180:183], a[20:23], v[136:139]
    buffer_load_dwordx4 a[40:43], v253, s[32:35], s68 offen offset:1024 sc1
    v_mfma_f32_16x16x32_bf16 v[116:119], a[184:187], a[16:19], v[116:119]
    ds_read_b64_tr_b16 a[232:233], v7 offset:53248
    v_mfma_f32_16x16x32_bf16 v[132:135], a[184:187], a[20:23], v[132:135]
    ds_read_b64_tr_b16 a[234:235], v7 offset:55296
    ds_read_b64_tr_b16 a[236:237], v7 offset:61440
    v_mfma_f32_16x16x32_bf16 v[124:127], a[188:191], a[16:19], v[124:127]
    ds_read_b64_tr_b16 a[238:239], v7 offset:63488
    v_mfma_f32_16x16x32_bf16 v[140:143], a[188:191], a[20:23], v[140:143]
    buffer_load_dwordx4 v246, s[24:27], s90 offen offset:2048 lds
    s_waitcnt lgkmcnt(15)
    s_nop 0
    v_mfma_f32_16x16x32_bf16 v[144:147], a[192:195], a[16:19], v[144:147]
    ds_read_b64_tr_b16 a[112:113], v4 offset:0
    v_mfma_f32_16x16x32_bf16 v[160:163], a[192:195], a[20:23], v[160:163]
    ds_read_b64_tr_b16 a[114:115], v4 offset:2048
    v_mfma_f32_16x16x32_bf16 v[152:155], a[196:199], a[16:19], v[152:155]
    ds_read_b64_tr_b16 a[116:117], v4 offset:8192
    ds_read_b64_tr_b16 a[118:119], v4 offset:10240
    v_mfma_f32_16x16x32_bf16 v[168:171], a[196:199], a[20:23], v[168:171]
    buffer_load_dwordx4 a[44:47], v12, s[32:35], s68 offen offset:1024 sc1
    v_mfma_f32_16x16x32_bf16 v[148:151], a[200:203], a[16:19], v[148:151]
    ds_read_b64_tr_b16 a[120:121], v5 offset:0
    v_mfma_f32_16x16x32_bf16 v[164:167], a[200:203], a[20:23], v[164:167]
    ds_read_b64_tr_b16 a[122:123], v5 offset:2048
    ds_read_b64_tr_b16 a[124:125], v5 offset:8192
    v_mfma_f32_16x16x32_bf16 v[156:159], a[204:207], a[16:19], v[156:159]
    ds_read_b64_tr_b16 a[126:127], v5 offset:10240
    v_mfma_f32_16x16x32_bf16 v[172:175], a[204:207], a[20:23], v[172:175]
    buffer_load_dwordx4 v247, s[24:27], s90 offen offset:3072 lds
    s_waitcnt vmcnt(8) lgkmcnt(15)
    s_nop 0
    v_mfma_f32_16x16x32_bf16 v[112:115], a[208:211], a[24:27], v[112:115]
    ds_read_b64_tr_b16 a[128:129], v6 offset:0
    v_mfma_f32_16x16x32_bf16 v[128:131], a[208:211], a[28:31], v[128:131]
    ds_read_b64_tr_b16 a[130:131], v6 offset:2048
    ds_read_b64_tr_b16 a[132:133], v6 offset:8192
    v_mfma_f32_16x16x32_bf16 v[120:123], a[212:215], a[24:27], v[120:123]
    ds_read_b64_tr_b16 a[134:135], v6 offset:10240
    v_mfma_f32_16x16x32_bf16 v[136:139], a[212:215], a[28:31], v[136:139]
    buffer_load_dwordx4 a[48:51], v253, s[32:35], s68 offen offset:2048 sc1
    ds_read_b64_tr_b16 a[136:137], v7 offset:0
    v_mfma_f32_16x16x32_bf16 v[116:119], a[216:219], a[24:27], v[116:119]
    ds_read_b64_tr_b16 a[138:139], v7 offset:2048
    ds_read_b64_tr_b16 a[140:141], v7 offset:8192
    v_mfma_f32_16x16x32_bf16 v[132:135], a[216:219], a[28:31], v[132:135]
    ds_read_b64_tr_b16 a[142:143], v7 offset:10240
    v_mfma_f32_16x16x32_bf16 v[124:127], a[220:223], a[24:27], v[124:127]
    s_add_u32 m0, s89, 135168
    s_add_u32 s90, s90, 28672
    v_mfma_f32_16x16x32_bf16 v[140:143], a[220:223], a[28:31], v[140:143]
    buffer_load_dwordx4 v244, s[24:27], s90 offen offset:0 lds
    s_waitcnt lgkmcnt(15)
    v_mfma_f32_16x16x32_bf16 v[144:147], a[224:227], a[24:27], v[144:147]
    ds_read_b64_tr_b16 a[144:145], v4 offset:4096
    v_mfma_f32_16x16x32_bf16 v[160:163], a[224:227], a[28:31], v[160:163]
    ds_read_b64_tr_b16 a[146:147], v4 offset:6144
    s_barrier
    v_mfma_f32_16x16x32_bf16 v[152:155], a[228:231], a[24:27], v[152:155]
    ds_read_b64_tr_b16 a[148:149], v4 offset:12288
    v_mfma_f32_16x16x32_bf16 v[168:171], a[228:231], a[28:31], v[168:171]
    ds_read_b64_tr_b16 a[150:151], v4 offset:14336
    buffer_load_dwordx4 a[52:55], v12, s[32:35], s68 offen offset:2048 sc1
    v_mfma_f32_16x16x32_bf16 v[148:151], a[232:235], a[24:27], v[148:151]
    ds_read_b64_tr_b16 a[152:153], v5 offset:4096
    v_mfma_f32_16x16x32_bf16 v[164:167], a[232:235], a[28:31], v[164:167]
    ds_read_b64_tr_b16 a[154:155], v5 offset:6144
    ds_read_b64_tr_b16 a[156:157], v5 offset:12288
    v_mfma_f32_16x16x32_bf16 v[156:159], a[236:239], a[24:27], v[156:159]
    ds_read_b64_tr_b16 a[158:159], v5 offset:14336
    v_mfma_f32_16x16x32_bf16 v[172:175], a[236:239], a[28:31], v[172:175]
    buffer_load_dwordx4 v245, s[24:27], s90 offen offset:1024 lds
    s_waitcnt vmcnt(9) lgkmcnt(15)
    s_nop 0
    v_mfma_f32_16x16x32_bf16 v[112:115], a[112:115], a[32:35], v[112:115]
    ds_read_b64_tr_b16 a[160:161], v6 offset:4096
    v_mfma_f32_16x16x32_bf16 v[128:131], a[112:115], a[36:39], v[128:131]
    ds_read_b64_tr_b16 a[162:163], v6 offset:6144
    v_mfma_f32_16x16x32_bf16 v[120:123], a[116:119], a[32:35], v[120:123]
    ds_read_b64_tr_b16 a[164:165], v6 offset:12288
    ds_read_b64_tr_b16 a[166:167], v6 offset:14336
    v_mfma_f32_16x16x32_bf16 v[136:139], a[116:119], a[36:39], v[136:139]
    buffer_load_dwordx4 a[56:59], v253, s[32:35], s68 offen offset:3072 sc1
    v_mfma_f32_16x16x32_bf16 v[116:119], a[120:123], a[32:35], v[116:119]
    ds_read_b64_tr_b16 a[168:169], v7 offset:4096
    v_mfma_f32_16x16x32_bf16 v[132:135], a[120:123], a[36:39], v[132:135]
    ds_read_b64_tr_b16 a[170:171], v7 offset:6144
    ds_read_b64_tr_b16 a[172:173], v7 offset:12288
    v_mfma_f32_16x16x32_bf16 v[124:127], a[124:127], a[32:35], v[124:127]
    ds_read_b64_tr_b16 a[174:175], v7 offset:14336
    v_mfma_f32_16x16x32_bf16 v[140:143], a[124:127], a[36:39], v[140:143]
    buffer_load_dwordx4 v246, s[24:27], s90 offen offset:2048 lds
    s_waitcnt lgkmcnt(15)
    s_nop 0
    v_mfma_f32_16x16x32_bf16 v[144:147], a[128:131], a[32:35], v[144:147]
    ds_read_b64_tr_b16 a[176:177], v4 offset:16384
    v_mfma_f32_16x16x32_bf16 v[160:163], a[128:131], a[36:39], v[160:163]
    ds_read_b64_tr_b16 a[178:179], v4 offset:18432
    v_mfma_f32_16x16x32_bf16 v[152:155], a[132:135], a[32:35], v[152:155]
    ds_read_b64_tr_b16 a[180:181], v4 offset:24576
    ds_read_b64_tr_b16 a[182:183], v4 offset:26624
    v_mfma_f32_16x16x32_bf16 v[168:171], a[132:135], a[36:39], v[168:171]
    buffer_load_dwordx4 a[60:63], v12, s[32:35], s68 offen offset:3072 sc1
    v_mfma_f32_16x16x32_bf16 v[148:151], a[136:139], a[32:35], v[148:151]
    ds_read_b64_tr_b16 a[184:185], v5 offset:16384
    v_mfma_f32_16x16x32_bf16 v[164:167], a[136:139], a[36:39], v[164:167]
    ds_read_b64_tr_b16 a[186:187], v5 offset:18432
    ds_read_b64_tr_b16 a[188:189], v5 offset:24576
    v_mfma_f32_16x16x32_bf16 v[156:159], a[140:143], a[32:35], v[156:159]
    ds_read_b64_tr_b16 a[190:191], v5 offset:26624
    v_mfma_f32_16x16x32_bf16 v[172:175], a[140:143], a[36:39], v[172:175]
    buffer_load_dwordx4 v247, s[24:27], s90 offen offset:3072 lds
    s_waitcnt vmcnt(9) lgkmcnt(15)
    s_nop 0
    v_mfma_f32_16x16x32_bf16 v[112:115], a[144:147], a[40:43], v[112:115]
    ds_read_b64_tr_b16 a[192:193], v6 offset:16384
    v_mfma_f32_16x16x32_bf16 v[128:131], a[144:147], a[44:47], v[128:131]
    ds_read_b64_tr_b16 a[194:195], v6 offset:18432
    ds_read_b64_tr_b16 a[196:197], v6 offset:24576
    v_mfma_f32_16x16x32_bf16 v[120:123], a[148:151], a[40:43], v[120:123]
    ds_read_b64_tr_b16 a[198:199], v6 offset:26624
    s_add_u32 s68, s68, 4096
    v_mfma_f32_16x16x32_bf16 v[136:139], a[148:151], a[44:47], v[136:139]
    buffer_load_dwordx4 a[64:67], v253, s[32:35], s68 offen offset:0 sc1
    ds_read_b64_tr_b16 a[200:201], v7 offset:16384
    v_mfma_f32_16x16x32_bf16 v[116:119], a[152:155], a[40:43], v[116:119]
    ds_read_b64_tr_b16 a[202:203], v7 offset:18432
    v_mfma_f32_16x16x32_bf16 v[132:135], a[152:155], a[44:47], v[132:135]
    ds_read_b64_tr_b16 a[204:205], v7 offset:24576
    ds_read_b64_tr_b16 a[206:207], v7 offset:26624
    v_mfma_f32_16x16x32_bf16 v[124:127], a[156:159], a[40:43], v[124:127]
    s_add_u32 m0, s49, 32768
    s_add_u32 s90, s88, 229504
    v_mfma_f32_16x16x32_bf16 v[140:143], a[156:159], a[44:47], v[140:143]
    buffer_load_dwordx4 v240, s[20:23], s90 offen offset:0 lds
    s_waitcnt lgkmcnt(15)
    s_nop 0
    v_mfma_f32_16x16x32_bf16 v[144:147], a[160:163], a[40:43], v[144:147]
    ds_read_b64_tr_b16 a[208:209], v4 offset:20480
    v_mfma_f32_16x16x32_bf16 v[160:163], a[160:163], a[44:47], v[160:163]
    ds_read_b64_tr_b16 a[210:211], v4 offset:22528
    v_mfma_f32_16x16x32_bf16 v[152:155], a[164:167], a[40:43], v[152:155]
    ds_read_b64_tr_b16 a[212:213], v4 offset:28672
    ds_read_b64_tr_b16 a[214:215], v4 offset:30720
    v_mfma_f32_16x16x32_bf16 v[168:171], a[164:167], a[44:47], v[168:171]
    buffer_load_dwordx4 a[68:71], v12, s[32:35], s68 offen offset:0 sc1
    v_mfma_f32_16x16x32_bf16 v[148:151], a[168:171], a[40:43], v[148:151]
    ds_read_b64_tr_b16 a[216:217], v5 offset:20480
    v_mfma_f32_16x16x32_bf16 v[164:167], a[168:171], a[44:47], v[164:167]
    ds_read_b64_tr_b16 a[218:219], v5 offset:22528
    ds_read_b64_tr_b16 a[220:221], v5 offset:28672
    v_mfma_f32_16x16x32_bf16 v[156:159], a[172:175], a[40:43], v[156:159]
    ds_read_b64_tr_b16 a[222:223], v5 offset:30720
    v_mfma_f32_16x16x32_bf16 v[172:175], a[172:175], a[44:47], v[172:175]
    buffer_load_dwordx4 v241, s[20:23], s90 offen offset:1024 lds
    s_waitcnt vmcnt(9) lgkmcnt(15)
    s_nop 0
    v_mfma_f32_16x16x32_bf16 v[112:115], a[176:179], a[48:51], v[112:115]
    ds_read_b64_tr_b16 a[224:225], v6 offset:20480
    v_mfma_f32_16x16x32_bf16 v[128:131], a[176:179], a[52:55], v[128:131]
    ds_read_b64_tr_b16 a[226:227], v6 offset:22528
    v_mfma_f32_16x16x32_bf16 v[120:123], a[180:183], a[48:51], v[120:123]
    ds_read_b64_tr_b16 a[228:229], v6 offset:28672
    ds_read_b64_tr_b16 a[230:231], v6 offset:30720
    v_mfma_f32_16x16x32_bf16 v[136:139], a[180:183], a[52:55], v[136:139]
    buffer_load_dwordx4 a[72:75], v253, s[32:35], s68 offen offset:1024 sc1
    v_mfma_f32_16x16x32_bf16 v[116:119], a[184:187], a[48:51], v[116:119]
    ds_read_b64_tr_b16 a[232:233], v7 offset:20480
    v_mfma_f32_16x16x32_bf16 v[132:135], a[184:187], a[52:55], v[132:135]
    ds_read_b64_tr_b16 a[234:235], v7 offset:22528
    ds_read_b64_tr_b16 a[236:237], v7 offset:28672
    v_mfma_f32_16x16x32_bf16 v[124:127], a[188:191], a[48:51], v[124:127]
    ds_read_b64_tr_b16 a[238:239], v7 offset:30720
    v_mfma_f32_16x16x32_bf16 v[140:143], a[188:191], a[52:55], v[140:143]
    buffer_load_dwordx4 v242, s[20:23], s90 offen offset:2048 lds
    s_waitcnt lgkmcnt(15)
    s_nop 0
    v_mfma_f32_16x16x32_bf16 v[144:147], a[192:195], a[48:51], v[144:147]
    ds_read_b64_tr_b16 a[112:113], v8 offset:0
    v_mfma_f32_16x16x32_bf16 v[160:163], a[192:195], a[52:55], v[160:163]
    ds_read_b64_tr_b16 a[114:115], v8 offset:2048
    v_mfma_f32_16x16x32_bf16 v[152:155], a[196:199], a[48:51], v[152:155]
    ds_read_b64_tr_b16 a[116:117], v8 offset:8192
    ds_read_b64_tr_b16 a[118:119], v8 offset:10240
    v_mfma_f32_16x16x32_bf16 v[168:171], a[196:199], a[52:55], v[168:171]
    buffer_load_dwordx4 a[76:79], v12, s[32:35], s68 offen offset:1024 sc1
    v_mfma_f32_16x16x32_bf16 v[148:151], a[200:203], a[48:51], v[148:151]
    ds_read_b64_tr_b16 a[120:121], v9 offset:0
    v_mfma_f32_16x16x32_bf16 v[164:167], a[200:203], a[52:55], v[164:167]
    ds_read_b64_tr_b16 a[122:123], v9 offset:2048
    ds_read_b64_tr_b16 a[124:125], v9 offset:8192
    v_mfma_f32_16x16x32_bf16 v[156:159], a[204:207], a[48:51], v[156:159]
    ds_read_b64_tr_b16 a[126:127], v9 offset:10240
    v_mfma_f32_16x16x32_bf16 v[172:175], a[204:207], a[52:55], v[172:175]
    buffer_load_dwordx4 v243, s[20:23], s90 offen offset:3072 lds
    s_waitcnt vmcnt(9) lgkmcnt(15)
    v_mfma_f32_16x16x32_bf16 v[112:115], a[208:211], a[56:59], v[112:115]
    ds_read_b64_tr_b16 a[128:129], v10 offset:0
    ds_read_b64_tr_b16 a[130:131], v10 offset:2048
    v_mfma_f32_16x16x32_bf16 v[128:131], a[208:211], a[60:63], v[128:131]
    s_waitcnt vmcnt(8)
    ds_read_b64_tr_b16 a[132:133], v10 offset:8192
    v_mfma_f32_16x16x32_bf16 v[120:123], a[212:215], a[56:59], v[120:123]
    ds_read_b64_tr_b16 a[134:135], v10 offset:10240
    ds_read_b64_tr_b16 v[16:17], v248 offset:0
    v_mfma_f32_16x16x32_bf16 v[136:139], a[212:215], a[60:63], v[136:139]
    buffer_load_dwordx4 a[80:83], v253, s[32:35], s68 offen offset:2048 sc1
    ds_read_b64_tr_b16 a[136:137], v11 offset:0
    v_mfma_f32_16x16x32_bf16 v[116:119], a[216:219], a[56:59], v[116:119]
    ds_read_b64_tr_b16 a[138:139], v11 offset:2048
    ds_read_b64_tr_b16 v[18:19], v248 offset:2048
    v_mfma_f32_16x16x32_bf16 v[132:135], a[216:219], a[60:63], v[132:135]
    ds_read_b64_tr_b16 a[140:141], v11 offset:8192
    ds_read_b64_tr_b16 a[142:143], v11 offset:10240
    v_mfma_f32_16x16x32_bf16 v[124:127], a[220:223], a[56:59], v[124:127]
    ds_read_b64_tr_b16 v[20:21], v249 offset:0
    s_add_u32 m0, s49, 49152
    v_mfma_f32_16x16x32_bf16 v[140:143], a[220:223], a[60:63], v[140:143]
    s_add_u32 s90, s88, 458880
    buffer_load_dwordx4 v240, s[20:23], s90 offen offset:0 lds
    s_waitcnt lgkmcnt(15)
    v_mfma_f32_16x16x32_bf16 v[144:147], a[224:227], a[56:59], v[144:147]
    ds_read_b64_tr_b16 a[144:145], v8 offset:4096
    ds_read_b64_tr_b16 a[146:147], v8 offset:6144
    v_mfma_f32_16x16x32_bf16 v[160:163], a[224:227], a[60:63], v[160:163]
    s_barrier
    ds_read_b64_tr_b16 v[22:23], v249 offset:2048
    v_mfma_f32_16x16x32_bf16 v[152:155], a[228:231], a[56:59], v[152:155]
    ds_read_b64_tr_b16 a[148:149], v8 offset:12288
    ds_read_b64_tr_b16 a[150:151], v8 offset:14336
    v_mfma_f32_16x16x32_bf16 v[168:171], a[228:231], a[60:63], v[168:171]
    ds_read_b64_tr_b16 v[24:25], v250 offset:0
    buffer_load_dwordx4 a[84:87], v12, s[32:35], s68 offen offset:2048 sc1
    v_mfma_f32_16x16x32_bf16 v[148:151], a[232:235], a[56:59], v[148:151]
    ds_read_b64_tr_b16 a[152:153], v9 offset:4096
    ds_read_b64_tr_b16 a[154:155], v9 offset:6144
    v_mfma_f32_16x16x32_bf16 v[164:167], a[232:235], a[60:63], v[164:167]
    ds_read_b64_tr_b16 v[26:27], v250 offset:2048
    ds_read_b64_tr_b16 a[156:157], v9 offset:12288
    v_mfma_f32_16x16x32_bf16 v[156:159], a[236:239], a[56:59], v[156:159]
    ds_read_b64_tr_b16 a[158:159], v9 offset:14336
    ds_read_b64_tr_b16 v[28:29], v251 offset:0
    v_mfma_f32_16x16x32_bf16 v[172:175], a[236:239], a[60:63], v[172:175]
    buffer_load_dwordx4 v241, s[20:23], s90 offen offset:1024 lds
    s_waitcnt vmcnt(9) lgkmcnt(15)
    s_nop 0
    v_mfma_f32_16x16x32_bf16 v[112:115], a[112:115], a[64:67], v[112:115]
    ds_read_b64_tr_b16 a[160:161], v10 offset:4096
    v_mfma_f32_16x16x32_bf16 v[128:131], a[112:115], a[68:71], v[128:131]
    ds_read_b64_tr_b16 a[162:163], v10 offset:6144
    ds_read_b64_tr_b16 v[30:31], v251 offset:2048
    v_mfma_f32_16x16x32_bf16 v[120:123], a[116:119], a[64:67], v[120:123]
    ds_read_b64_tr_b16 a[164:165], v10 offset:12288
    ds_read_b64_tr_b16 a[166:167], v10 offset:14336
    v_mfma_f32_16x16x32_bf16 v[136:139], a[116:119], a[68:71], v[136:139]
    ds_read_b64_tr_b16 v[32:33], v248 offset:4096
    buffer_load_dwordx4 a[88:91], v253, s[32:35], s68 offen offset:3072 sc1
    v_mfma_f32_16x16x32_bf16 v[116:119], a[120:123], a[64:67], v[116:119]
    ds_read_b64_tr_b16 a[168:169], v11 offset:4096
    ds_read_b64_tr_b16 a[170:171], v11 offset:6144
    v_mfma_f32_16x16x32_bf16 v[132:135], a[120:123], a[68:71], v[132:135]
    ds_read_b64_tr_b16 v[34:35], v248 offset:6144
    ds_read_b64_tr_b16 a[172:173], v11 offset:12288
    v_mfma_f32_16x16x32_bf16 v[124:127], a[124:127], a[64:67], v[124:127]
    ds_read_b64_tr_b16 a[174:175], v11 offset:14336
    ds_read_b64_tr_b16 v[36:37], v249 offset:4096
    v_mfma_f32_16x16x32_bf16 v[140:143], a[124:127], a[68:71], v[140:143]
    buffer_load_dwordx4 v242, s[20:23], s90 offen offset:2048 lds
    s_waitcnt lgkmcnt(15)
    s_nop 0
    v_mfma_f32_16x16x32_bf16 v[144:147], a[128:131], a[64:67], v[144:147]
    ds_read_b64_tr_b16 a[176:177], v8 offset:16384
    v_mfma_f32_16x16x32_bf16 v[160:163], a[128:131], a[68:71], v[160:163]
    ds_read_b64_tr_b16 a[178:179], v8 offset:18432
    ds_read_b64_tr_b16 v[38:39], v249 offset:6144
    v_mfma_f32_16x16x32_bf16 v[152:155], a[132:135], a[64:67], v[152:155]
    ds_read_b64_tr_b16 a[180:181], v8 offset:24576
    ds_read_b64_tr_b16 a[182:183], v8 offset:26624
    v_mfma_f32_16x16x32_bf16 v[168:171], a[132:135], a[68:71], v[168:171]
    ds_read_b64_tr_b16 v[40:41], v250 offset:4096
    buffer_load_dwordx4 a[92:95], v12, s[32:35], s68 offen offset:3072 sc1
    v_mfma_f32_16x16x32_bf16 v[148:151], a[136:139], a[64:67], v[148:151]
    ds_read_b64_tr_b16 a[184:185], v9 offset:16384
    ds_read_b64_tr_b16 a[186:187], v9 offset:18432
    v_mfma_f32_16x16x32_bf16 v[164:167], a[136:139], a[68:71], v[164:167]
    ds_read_b64_tr_b16 v[42:43], v250 offset:6144
    ds_read_b64_tr_b16 a[188:189], v9 offset:24576
    v_mfma_f32_16x16x32_bf16 v[156:159], a[140:143], a[64:67], v[156:159]
    ds_read_b64_tr_b16 a[190:191], v9 offset:26624
    ds_read_b64_tr_b16 v[44:45], v251 offset:4096
    v_mfma_f32_16x16x32_bf16 v[172:175], a[140:143], a[68:71], v[172:175]
    buffer_load_dwordx4 v243, s[20:23], s90 offen offset:3072 lds
    s_waitcnt vmcnt(9) lgkmcnt(15)
    s_nop 0
    v_mfma_f32_16x16x32_bf16 v[112:115], a[144:147], a[72:75], v[112:115]
    ds_read_b64_tr_b16 a[192:193], v10 offset:16384
    ds_read_b64_tr_b16 a[194:195], v10 offset:18432
    v_mfma_f32_16x16x32_bf16 v[128:131], a[144:147], a[76:79], v[128:131]
    ds_read_b64_tr_b16 v[46:47], v251 offset:6144
    ds_read_b64_tr_b16 a[196:197], v10 offset:24576
    v_mfma_f32_16x16x32_bf16 v[120:123], a[148:151], a[72:75], v[120:123]
    ds_read_b64_tr_b16 a[198:199], v10 offset:26624
    s_waitcnt lgkmcnt(2)
    s_nop 0
    v_mfma_f32_16x16x32_bf16 v[136:139], a[148:151], a[76:79], v[136:139]
    s_add_u32 s68, s68, 4096
    buffer_load_dwordx4 a[96:99], v253, s[32:35], s68 offen offset:0 sc1
    v_mfma_f32_16x16x32_bf16 v[116:119], a[152:155], a[72:75], v[116:119]
    ds_read_b64_tr_b16 a[200:201], v11 offset:16384
    ds_read_b64_tr_b16 a[202:203], v11 offset:18432
    v_mfma_f32_16x16x32_bf16 v[132:135], a[152:155], a[76:79], v[132:135]
    ds_read_b64_tr_b16 a[204:205], v11 offset:24576
    ds_read_b64_tr_b16 a[206:207], v11 offset:26624
    v_mfma_f32_16x16x32_bf16 v[124:127], a[156:159], a[72:75], v[124:127]
    s_add_u32 m0, s49, 0
    s_add_u32 s90, s88, 688256
    v_mfma_f32_16x16x32_bf16 v[140:143], a[156:159], a[76:79], v[140:143]
    buffer_load_dwordx4 v240, s[20:23], s90 offen offset:0 lds
    s_waitcnt lgkmcnt(15)
    v_mfma_f32_16x16x32_bf16 v[144:147], a[160:163], a[72:75], v[144:147]
    ds_read_b64_tr_b16 a[208:209], v8 offset:20480
    v_mfma_f32_16x16x32_bf16 v[160:163], a[160:163], a[76:79], v[160:163]
    ds_read_b64_tr_b16 a[210:211], v8 offset:22528
    v_mfma_f32_16x16x32_bf16 v[152:155], a[164:167], a[72:75], v[152:155]
    ds_read_b64_tr_b16 a[212:213], v8 offset:28672
    ds_read_b64_tr_b16 a[214:215], v8 offset:30720
    v_mfma_f32_16x16x32_bf16 v[168:171], a[164:167], a[76:79], v[168:171]
    buffer_load_dwordx4 a[100:103], v12, s[32:35], s68 offen offset:0 sc1
    v_mfma_f32_16x16x32_bf16 v[148:151], a[168:171], a[72:75], v[148:151]
    ds_read_b64_tr_b16 a[216:217], v9 offset:20480
    v_mfma_f32_16x16x32_bf16 v[164:167], a[168:171], a[76:79], v[164:167]
    ds_read_b64_tr_b16 a[218:219], v9 offset:22528
    ds_read_b64_tr_b16 a[220:221], v9 offset:28672
    v_mfma_f32_16x16x32_bf16 v[156:159], a[172:175], a[72:75], v[156:159]
    ds_read_b64_tr_b16 a[222:223], v9 offset:30720
    v_mfma_f32_16x16x32_bf16 v[172:175], a[172:175], a[76:79], v[172:175]
    buffer_load_dwordx4 v241, s[20:23], s90 offen offset:1024 lds
    s_waitcnt vmcnt(9) lgkmcnt(15)
    s_nop 0
    v_mfma_f32_16x16x32_bf16 v[112:115], a[176:179], a[80:83], v[112:115]
    ds_read_b64_tr_b16 a[224:225], v10 offset:20480
    v_mfma_f32_16x16x32_bf16 v[128:131], a[176:179], a[84:87], v[128:131]
    ds_read_b64_tr_b16 a[226:227], v10 offset:22528
    v_mfma_f32_16x16x32_bf16 v[120:123], a[180:183], a[80:83], v[120:123]
    ds_read_b64_tr_b16 a[228:229], v10 offset:28672
    ds_read_b64_tr_b16 a[230:231], v10 offset:30720
    v_mfma_f32_16x16x32_bf16 v[136:139], a[180:183], a[84:87], v[136:139]
    buffer_load_dwordx4 a[104:107], v253, s[32:35], s68 offen offset:1024 sc1
    v_mfma_f32_16x16x32_bf16 v[116:119], a[184:187], a[80:83], v[116:119]
    ds_read_b64_tr_b16 a[232:233], v11 offset:20480
    v_mfma_f32_16x16x32_bf16 v[132:135], a[184:187], a[84:87], v[132:135]
    ds_read_b64_tr_b16 a[234:235], v11 offset:22528
    ds_read_b64_tr_b16 a[236:237], v11 offset:28672
    v_mfma_f32_16x16x32_bf16 v[124:127], a[188:191], a[80:83], v[124:127]
    ds_read_b64_tr_b16 a[238:239], v11 offset:30720
    v_mfma_f32_16x16x32_bf16 v[140:143], a[188:191], a[84:87], v[140:143]
    buffer_load_dwordx4 v242, s[20:23], s90 offen offset:2048 lds
    s_waitcnt lgkmcnt(15)
    s_nop 0
    v_mfma_f32_16x16x32_bf16 v[144:147], a[192:195], a[80:83], v[144:147]
    ds_read_b64_tr_b16 a[112:113], v8 offset:32768
    v_mfma_f32_16x16x32_bf16 v[160:163], a[192:195], a[84:87], v[160:163]
    ds_read_b64_tr_b16 a[114:115], v8 offset:34816
    v_mfma_f32_16x16x32_bf16 v[152:155], a[196:199], a[80:83], v[152:155]
    ds_read_b64_tr_b16 a[116:117], v8 offset:40960
    ds_read_b64_tr_b16 a[118:119], v8 offset:43008
    v_mfma_f32_16x16x32_bf16 v[168:171], a[196:199], a[84:87], v[168:171]
    buffer_load_dwordx4 a[108:111], v12, s[32:35], s68 offen offset:1024 sc1
    v_mfma_f32_16x16x32_bf16 v[148:151], a[200:203], a[80:83], v[148:151]
    ds_read_b64_tr_b16 a[120:121], v9 offset:32768
    v_mfma_f32_16x16x32_bf16 v[164:167], a[200:203], a[84:87], v[164:167]
    ds_read_b64_tr_b16 a[122:123], v9 offset:34816
    ds_read_b64_tr_b16 a[124:125], v9 offset:40960
    v_mfma_f32_16x16x32_bf16 v[156:159], a[204:207], a[80:83], v[156:159]
    ds_read_b64_tr_b16 a[126:127], v9 offset:43008
    v_mfma_f32_16x16x32_bf16 v[172:175], a[204:207], a[84:87], v[172:175]
    buffer_load_dwordx4 v243, s[20:23], s90 offen offset:3072 lds
    s_waitcnt vmcnt(9) lgkmcnt(15)
    s_nop 0
    v_mfma_f32_16x16x32_bf16 v[112:115], a[208:211], a[88:91], v[112:115]
    ds_read_b64_tr_b16 a[128:129], v10 offset:32768
    v_mfma_f32_16x16x32_bf16 v[128:131], a[208:211], a[92:95], v[128:131]
    ds_read_b64_tr_b16 a[130:131], v10 offset:34816
    ds_read_b64_tr_b16 a[132:133], v10 offset:40960
    v_mfma_f32_16x16x32_bf16 v[120:123], a[212:215], a[88:91], v[120:123]
    ds_read_b64_tr_b16 a[134:135], v10 offset:43008
    v_mfma_f32_16x16x32_bf16 v[136:139], a[212:215], a[92:95], v[136:139]
    s_add_u32 m0, s49, 16384
    s_add_u32 s90, s88, 917632
    v_mfma_f32_16x16x32_bf16 v[116:119], a[216:219], a[88:91], v[116:119]
    buffer_load_dwordx4 v240, s[20:23], s90 offen offset:0 lds
    ds_read_b64_tr_b16 a[136:137], v11 offset:32768
    v_mfma_f32_16x16x32_bf16 v[132:135], a[216:219], a[92:95], v[132:135]
    ds_read_b64_tr_b16 a[138:139], v11 offset:34816
    v_mfma_f32_16x16x32_bf16 v[124:127], a[220:223], a[88:91], v[124:127]
    ds_read_b64_tr_b16 a[140:141], v11 offset:40960
    ds_read_b64_tr_b16 a[142:143], v11 offset:43008
    v_mfma_f32_16x16x32_bf16 v[140:143], a[220:223], a[92:95], v[140:143]
    buffer_load_dwordx4 v241, s[20:23], s90 offen offset:1024 lds
    s_waitcnt lgkmcnt(15)
    s_nop 0
    v_mfma_f32_16x16x32_bf16 v[144:147], a[224:227], a[88:91], v[144:147]
    ds_read_b64_tr_b16 a[144:145], v8 offset:36864
    v_mfma_f32_16x16x32_bf16 v[160:163], a[224:227], a[92:95], v[160:163]
    ds_read_b64_tr_b16 a[146:147], v8 offset:38912
    s_waitcnt vmcnt(10)
    v_mfma_f32_16x16x32_bf16 v[152:155], a[228:231], a[88:91], v[152:155]
    s_barrier
    v_mfma_f32_16x16x32_bf16 v[168:171], a[228:231], a[92:95], v[168:171]
    ds_read_b64_tr_b16 a[148:149], v8 offset:45056
    ds_read_b64_tr_b16 a[150:151], v8 offset:47104
    v_mfma_f32_16x16x32_bf16 v[148:151], a[232:235], a[88:91], v[148:151]
    buffer_load_dwordx4 v242, s[20:23], s90 offen offset:2048 lds
    ds_read_b64_tr_b16 a[152:153], v9 offset:36864
    v_mfma_f32_16x16x32_bf16 v[164:167], a[232:235], a[92:95], v[164:167]
    ds_read_b64_tr_b16 a[154:155], v9 offset:38912
    v_mfma_f32_16x16x32_bf16 v[156:159], a[236:239], a[88:91], v[156:159]
    ds_read_b64_tr_b16 a[156:157], v9 offset:45056
    ds_read_b64_tr_b16 a[158:159], v9 offset:47104
    v_mfma_f32_16x16x32_bf16 v[172:175], a[236:239], a[92:95], v[172:175]
    buffer_load_dwordx4 v243, s[20:23], s90 offen offset:3072 lds
    s_waitcnt vmcnt(9) lgkmcnt(15)
    s_nop 0
    v_mfma_f32_16x16x32_bf16 v[112:115], a[112:115], a[96:99], v[112:115]
    ds_read_b64_tr_b16 a[160:161], v10 offset:36864
    v_mfma_f32_16x16x32_bf16 v[128:131], a[112:115], a[100:103], v[128:131]
    ds_read_b64_tr_b16 a[162:163], v10 offset:38912
    ds_read_b64_tr_b16 a[164:165], v10 offset:45056
    v_mfma_f32_16x16x32_bf16 v[120:123], a[116:119], a[96:99], v[120:123]
    ds_read_b64_tr_b16 a[166:167], v10 offset:47104
    v_mfma_f32_16x16x32_bf16 v[136:139], a[116:119], a[100:103], v[136:139]
    s_add_u32 m0, s49, 65536
    s_add_u32 s90, s88, 1147008
    v_mfma_f32_16x16x32_bf16 v[116:119], a[120:123], a[96:99], v[116:119]
    buffer_load_dwordx4 v240, s[20:23], s90 offen offset:0 lds
    ds_read_b64_tr_b16 a[168:169], v11 offset:36864
    v_mfma_f32_16x16x32_bf16 v[132:135], a[120:123], a[100:103], v[132:135]
    ds_read_b64_tr_b16 a[170:171], v11 offset:38912
    v_mfma_f32_16x16x32_bf16 v[124:127], a[124:127], a[96:99], v[124:127]
    ds_read_b64_tr_b16 a[172:173], v11 offset:45056
    ds_read_b64_tr_b16 a[174:175], v11 offset:47104
    v_mfma_f32_16x16x32_bf16 v[140:143], a[124:127], a[100:103], v[140:143]
    buffer_load_dwordx4 v241, s[20:23], s90 offen offset:1024 lds
    s_waitcnt lgkmcnt(15)
    s_nop 0
    v_mfma_f32_16x16x32_bf16 v[144:147], a[128:131], a[96:99], v[144:147]
    ds_read_b64_tr_b16 a[176:177], v8 offset:49152
    v_mfma_f32_16x16x32_bf16 v[160:163], a[128:131], a[100:103], v[160:163]
    ds_read_b64_tr_b16 a[178:179], v8 offset:51200
    v_mfma_f32_16x16x32_bf16 v[152:155], a[132:135], a[96:99], v[152:155]
    ds_read_b64_tr_b16 a[180:181], v8 offset:57344
    ds_read_b64_tr_b16 a[182:183], v8 offset:59392
    v_mfma_f32_16x16x32_bf16 v[168:171], a[132:135], a[100:103], v[168:171]
    buffer_load_dwordx4 v242, s[20:23], s90 offen offset:2048 lds
    v_mfma_f32_16x16x32_bf16 v[148:151], a[136:139], a[96:99], v[148:151]
    ds_read_b64_tr_b16 a[184:185], v9 offset:49152
    v_mfma_f32_16x16x32_bf16 v[164:167], a[136:139], a[100:103], v[164:167]
    ds_read_b64_tr_b16 a[186:187], v9 offset:51200
    ds_read_b64_tr_b16 a[188:189], v9 offset:57344
    v_mfma_f32_16x16x32_bf16 v[156:159], a[140:143], a[96:99], v[156:159]
    ds_read_b64_tr_b16 a[190:191], v9 offset:59392
    v_mfma_f32_16x16x32_bf16 v[172:175], a[140:143], a[100:103], v[172:175]
    buffer_load_dwordx4 v243, s[20:23], s90 offen offset:3072 lds
    s_waitcnt vmcnt(9) lgkmcnt(15)
    s_nop 0
    v_mfma_f32_16x16x32_bf16 v[112:115], a[144:147], a[104:107], v[112:115]
    ds_read_b64_tr_b16 a[192:193], v10 offset:49152
    v_mfma_f32_16x16x32_bf16 v[128:131], a[144:147], a[108:111], v[128:131]
    ds_read_b64_tr_b16 a[194:195], v10 offset:51200
    ds_read_b64_tr_b16 a[196:197], v10 offset:57344
    v_mfma_f32_16x16x32_bf16 v[120:123], a[148:151], a[104:107], v[120:123]
    ds_read_b64_tr_b16 a[198:199], v10 offset:59392
    v_mfma_f32_16x16x32_bf16 v[136:139], a[148:151], a[108:111], v[136:139]
    s_add_u32 m0, s49, 81920
    s_add_u32 s90, s88, 1376384
    v_mfma_f32_16x16x32_bf16 v[116:119], a[152:155], a[104:107], v[116:119]
    buffer_load_dwordx4 v240, s[20:23], s90 offen offset:0 lds
    ds_read_b64_tr_b16 a[200:201], v11 offset:49152
    v_mfma_f32_16x16x32_bf16 v[132:135], a[152:155], a[108:111], v[132:135]
    ds_read_b64_tr_b16 a[202:203], v11 offset:51200
    v_mfma_f32_16x16x32_bf16 v[124:127], a[156:159], a[104:107], v[124:127]
    ds_read_b64_tr_b16 a[204:205], v11 offset:57344
    ds_read_b64_tr_b16 a[206:207], v11 offset:59392
    v_mfma_f32_16x16x32_bf16 v[140:143], a[156:159], a[108:111], v[140:143]
    buffer_load_dwordx4 v241, s[20:23], s90 offen offset:1024 lds
    s_waitcnt lgkmcnt(15)
    s_nop 0
    v_mfma_f32_16x16x32_bf16 v[144:147], a[160:163], a[104:107], v[144:147]
    ds_read_b64_tr_b16 a[208:209], v8 offset:53248
    v_mfma_f32_16x16x32_bf16 v[160:163], a[160:163], a[108:111], v[160:163]
    ds_read_b64_tr_b16 a[210:211], v8 offset:55296
    v_mfma_f32_16x16x32_bf16 v[152:155], a[164:167], a[104:107], v[152:155]
    ds_read_b64_tr_b16 a[212:213], v8 offset:61440
    ds_read_b64_tr_b16 a[214:215], v8 offset:63488
    v_mfma_f32_16x16x32_bf16 v[168:171], a[164:167], a[108:111], v[168:171]
    buffer_load_dwordx4 v242, s[20:23], s90 offen offset:2048 lds
    v_mfma_f32_16x16x32_bf16 v[148:151], a[168:171], a[104:107], v[148:151]
    ds_read_b64_tr_b16 a[216:217], v9 offset:53248
    v_mfma_f32_16x16x32_bf16 v[164:167], a[168:171], a[108:111], v[164:167]
    ds_read_b64_tr_b16 a[218:219], v9 offset:55296
    ds_read_b64_tr_b16 a[220:221], v9 offset:61440
    v_mfma_f32_16x16x32_bf16 v[156:159], a[172:175], a[104:107], v[156:159]
    ds_read_b64_tr_b16 a[222:223], v9 offset:63488
    v_mfma_f32_16x16x32_bf16 v[172:175], a[172:175], a[108:111], v[172:175]
    buffer_load_dwordx4 v243, s[20:23], s90 offen offset:3072 lds
    s_waitcnt lgkmcnt(15)
    s_nop 0
    v_mfma_f32_16x16x32_bf16 v[176:179], a[176:179], a[0:3], 0
    ds_read_b64_tr_b16 a[224:225], v10 offset:53248
    v_mfma_f32_16x16x32_bf16 v[192:195], a[176:179], a[4:7], 0
    ds_read_b64_tr_b16 a[226:227], v10 offset:55296
    ds_read_b64_tr_b16 a[228:229], v10 offset:61440
    v_mfma_f32_16x16x32_bf16 v[184:187], a[180:183], a[0:3], 0
    ds_read_b64_tr_b16 a[230:231], v10 offset:63488
    s_mul_i32 s90, s92, 57344
    v_mfma_f32_16x16x32_bf16 v[200:203], a[180:183], a[4:7], 0
    s_add_u32 m0, s89, 131072
    s_add_u32 s90, s90, s70
    s_nop 0
    v_mfma_f32_16x16x32_bf16 v[180:183], a[184:187], a[0:3], 0
    buffer_load_dwordx4 v244, s[24:27], s90 offen offset:0 lds
    v_mfma_f32_16x16x32_bf16 v[196:199], a[184:187], a[4:7], 0
    ds_read_b64_tr_b16 a[232:233], v11 offset:53248
    ds_read_b64_tr_b16 a[234:235], v11 offset:55296
    v_mfma_f32_16x16x32_bf16 v[188:191], a[188:191], a[0:3], 0
    ds_read_b64_tr_b16 a[236:237], v11 offset:61440
    ds_read_b64_tr_b16 a[238:239], v11 offset:63488
    v_mfma_f32_16x16x32_bf16 v[204:207], a[188:191], a[4:7], 0
    buffer_load_dwordx4 v245, s[24:27], s90 offen offset:1024 lds
    s_waitcnt lgkmcnt(15)
    s_nop 0
    v_mfma_f32_16x16x32_bf16 v[208:211], a[192:195], a[0:3], 0
    ds_read_b64_tr_b16 a[112:113], v4 offset:32768
    ds_read_b64_tr_b16 a[114:115], v4 offset:34816
    v_mfma_f32_16x16x32_bf16 v[224:227], a[192:195], a[4:7], 0
    ds_read_b64_tr_b16 a[116:117], v4 offset:40960
    ds_read_b64_tr_b16 a[118:119], v4 offset:43008
    buffer_load_dwordx4 v246, s[24:27], s90 offen offset:2048 lds
    v_mfma_f32_16x16x32_bf16 v[216:219], a[196:199], a[0:3], 0
    ds_read_b64_tr_b16 a[120:121], v5 offset:32768
    ds_read_b64_tr_b16 a[122:123], v5 offset:34816
    ds_read_b64_tr_b16 a[124:125], v5 offset:40960
    v_mfma_f32_16x16x32_bf16 v[232:235], a[196:199], a[4:7], 0
    ds_read_b64_tr_b16 a[126:127], v5 offset:43008
    buffer_load_dwordx4 v247, s[24:27], s90 offen offset:3072 lds
    v_max_f32_e64 v112, 0, v112
    v_mfma_f32_16x16x32_bf16 v[212:215], a[200:203], a[0:3], 0
    v_max_f32 v113, 0, v113
    v_max_f32 v114, 0, v114
    v_mfma_f32_16x16x32_bf16 v[228:231], a[200:203], a[4:7], 0
    v_max_f32 v115, 0, v115
    v_max_f32 v116, 0, v116
    v_max_f32_e64 v117, 0, v117
    v_mfma_f32_16x16x32_bf16 v[220:223], a[204:207], a[0:3], 0
    v_max_f32 v118, 0, v118
    v_max_f32 v119, 0, v119
    v_mul_f32_e64 v112, v112, v120
    v_mfma_f32_16x16x32_bf16 v[236:239], a[204:207], a[4:7], 0
    v_mul_f32_e64 v113, v113, v121
    v_mul_f32 v114, v114, v122
    s_waitcnt lgkmcnt(15)
    v_mfma_f32_16x16x32_bf16 v[176:179], a[208:211], a[8:11], v[176:179]
    ds_read_b64_tr_b16 a[128:129], v6 offset:32768
    ds_read_b64_tr_b16 a[130:131], v6 offset:34816
    v_mfma_f32_16x16x32_bf16 v[192:195], a[208:211], a[12:15], v[192:195]
    ds_read_b64_tr_b16 a[132:133], v6 offset:40960
    ds_read_b64_tr_b16 a[134:135], v6 offset:43008
    s_add_u32 m0, s89, 135168
    v_mfma_f32_16x16x32_bf16 v[184:187], a[212:215], a[8:11], v[184:187]
    s_add_u32 s90, s90, 28672
    buffer_load_dwordx4 v244, s[24:27], s90 offen offset:0 lds
    ds_read_b64_tr_b16 a[136:137], v7 offset:32768
    v_mfma_f32_16x16x32_bf16 v[200:203], a[212:215], a[12:15], v[200:203]
    ds_read_b64_tr_b16 a[138:139], v7 offset:34816
    ds_read_b64_tr_b16 a[140:141], v7 offset:40960
    ds_read_b64_tr_b16 a[142:143], v7 offset:43008
    v_mfma_f32_16x16x32_bf16 v[180:183], a[216:219], a[8:11], v[180:183]
    buffer_load_dwordx4 v245, s[24:27], s90 offen offset:1024 lds
    v_mul_f32_e64 v115, v115, v123
    v_mfma_f32_16x16x32_bf16 v[196:199], a[216:219], a[12:15], v[196:199]
    v_mul_f32 v116, v116, v124
    v_mul_f32 v117, v117, v125
    v_mul_f32_e64 v118, v118, v126
    v_mfma_f32_16x16x32_bf16 v[188:191], a[220:223], a[8:11], v[188:191]
    v_mul_f32_e64 v119, v119, v127
    v_cvt_pk_bf16_f32 v120, v112, v113
    v_cvt_pk_bf16_f32 v121, v114, v115
    v_mfma_f32_16x16x32_bf16 v[204:207], a[220:223], a[12:15], v[204:207]
    v_cvt_pk_bf16_f32 v122, v116, v117
    v_cvt_pk_bf16_f32 v123, v118, v119
    s_waitcnt lgkmcnt(15)
    s_nop 0
    v_mfma_f32_16x16x32_bf16 v[208:211], a[224:227], a[8:11], v[208:211]
    ds_read_b64_tr_b16 a[144:145], v4 offset:36864
    ds_read_b64_tr_b16 a[146:147], v4 offset:38912
    v_mfma_f32_16x16x32_bf16 v[224:227], a[224:227], a[12:15], v[224:227]
    s_waitcnt vmcnt(14)
    s_barrier
    ds_read_b64_tr_b16 a[148:149], v4 offset:45056
    v_mfma_f32_16x16x32_bf16 v[216:219], a[228:231], a[8:11], v[216:219]
    ds_read_b64_tr_b16 a[150:151], v4 offset:47104
    buffer_load_dwordx4 v246, s[24:27], s90 offen offset:2048 lds
    ds_read_b64_tr_b16 a[152:153], v5 offset:36864
    v_mfma_f32_16x16x32_bf16 v[232:235], a[228:231], a[12:15], v[232:235]
    ds_read_b64_tr_b16 a[154:155], v5 offset:38912
    ds_read_b64_tr_b16 a[156:157], v5 offset:45056
    ds_read_b64_tr_b16 a[158:159], v5 offset:47104
    v_mfma_f32_16x16x32_bf16 v[212:215], a[232:235], a[8:11], v[212:215]
    buffer_load_dwordx4 v247, s[24:27], s90 offen offset:3072 lds
    buffer_store_dwordx4 v[120:123], v253, s[32:35], s69 offen offset:0 sc1
    v_mfma_f32_16x16x32_bf16 v[228:231], a[232:235], a[12:15], v[228:231]
    v_max_f32 v128, 0, v128
    v_max_f32 v129, 0, v129
    v_max_f32_e64 v130, 0, v130
    v_mfma_f32_16x16x32_bf16 v[220:223], a[236:239], a[8:11], v[220:223]
    v_max_f32 v131, 0, v131
    v_max_f32 v132, 0, v132
    v_max_f32_e64 v133, 0, v133
    v_mfma_f32_16x16x32_bf16 v[236:239], a[236:239], a[12:15], v[236:239]
    v_max_f32_e64 v134, 0, v134
    v_max_f32 v135, 0, v135
    s_waitcnt lgkmcnt(15)
    v_mfma_f32_16x16x32_bf16 v[176:179], a[112:115], a[16:19], v[176:179]
    ds_read_b64_tr_b16 a[160:161], v6 offset:36864
    ds_read_b64_tr_b16 a[162:163], v6 offset:38912
    v_mfma_f32_16x16x32_bf16 v[192:195], a[112:115], a[20:23], v[192:195]
    ds_read_b64_tr_b16 a[164:165], v6 offset:45056
    ds_read_b64_tr_b16 a[166:167], v6 offset:47104
    s_mul_i32 s90, s94, 57344
    v_mfma_f32_16x16x32_bf16 v[184:187], a[116:119], a[16:19], v[184:187]
    s_add_u32 m0, s89, 98304
    s_add_u32 s90, s90, s70
    s_nop 0
    buffer_load_dwordx4 v244, s[24:27], s90 offen offset:0 lds
    v_mfma_f32_16x16x32_bf16 v[200:203], a[116:119], a[20:23], v[200:203]
    ds_read_b64_tr_b16 a[168:169], v7 offset:36864
    ds_read_b64_tr_b16 a[170:171], v7 offset:38912
    ds_read_b64_tr_b16 a[172:173], v7 offset:45056
    v_mfma_f32_16x16x32_bf16 v[180:183], a[120:123], a[16:19], v[180:183]
    ds_read_b64_tr_b16 a[174:175], v7 offset:47104
    buffer_load_dwordx4 v245, s[24:27], s90 offen offset:1024 lds
    v_mfma_f32_16x16x32_bf16 v[196:199], a[120:123], a[20:23], v[196:199]
    v_mul_f32 v128, v128, v136
    v_mul_f32 v129, v129, v137
    v_mul_f32_e64 v130, v130, v138
    v_mfma_f32_16x16x32_bf16 v[188:191], a[124:127], a[16:19], v[188:191]
    v_mul_f32 v131, v131, v139
    v_mul_f32 v132, v132, v140
    v_mul_f32_e64 v133, v133, v141
    v_mfma_f32_16x16x32_bf16 v[204:207], a[124:127], a[20:23], v[204:207]
    v_mul_f32_e64 v134, v134, v142
    v_mul_f32 v135, v135, v143
    s_waitcnt lgkmcnt(15)
    v_mfma_f32_16x16x32_bf16 v[208:211], a[128:131], a[16:19], v[208:211]
    ds_read_b64_tr_b16 a[176:177], v4 offset:49152
    ds_read_b64_tr_b16 a[178:179], v4 offset:51200
    v_mfma_f32_16x16x32_bf16 v[224:227], a[128:131], a[20:23], v[224:227]
    ds_read_b64_tr_b16 a[180:181], v4 offset:57344
    ds_read_b64_tr_b16 a[182:183], v4 offset:59392
    buffer_load_dwordx4 v246, s[24:27], s90 offen offset:2048 lds
    v_mfma_f32_16x16x32_bf16 v[216:219], a[132:135], a[16:19], v[216:219]
    ds_read_b64_tr_b16 a[184:185], v5 offset:49152
    ds_read_b64_tr_b16 a[186:187], v5 offset:51200
    ds_read_b64_tr_b16 a[188:189], v5 offset:57344
    v_mfma_f32_16x16x32_bf16 v[232:235], a[132:135], a[20:23], v[232:235]
    ds_read_b64_tr_b16 a[190:191], v5 offset:59392
    buffer_load_dwordx4 v247, s[24:27], s90 offen offset:3072 lds
    v_cvt_pk_bf16_f32 v136, v128, v129
    v_mfma_f32_16x16x32_bf16 v[212:215], a[136:139], a[16:19], v[212:215]
    v_cvt_pk_bf16_f32 v137, v130, v131
    v_cvt_pk_bf16_f32 v138, v132, v133
    v_mfma_f32_16x16x32_bf16 v[228:231], a[136:139], a[20:23], v[228:231]
    v_cvt_pk_bf16_f32 v139, v134, v135
    buffer_store_dwordx4 v[136:139], v253, s[32:35], s69 offen offset:2048 sc1
    v_max_f32_e64 v144, 0, v144
    v_mfma_f32_16x16x32_bf16 v[220:223], a[140:143], a[16:19], v[220:223]
    v_max_f32 v145, 0, v145
    v_max_f32 v146, 0, v146
    v_max_f32_e64 v147, 0, v147
    v_mfma_f32_16x16x32_bf16 v[236:239], a[140:143], a[20:23], v[236:239]
    v_max_f32_e64 v148, 0, v148
    v_max_f32 v149, 0, v149
    s_waitcnt lgkmcnt(15)
    v_mfma_f32_16x16x32_bf16 v[176:179], a[144:147], a[24:27], v[176:179]
    ds_read_b64_tr_b16 a[192:193], v6 offset:49152
    ds_read_b64_tr_b16 a[194:195], v6 offset:51200
    v_mfma_f32_16x16x32_bf16 v[192:195], a[144:147], a[28:31], v[192:195]
    ds_read_b64_tr_b16 a[196:197], v6 offset:57344
    ds_read_b64_tr_b16 a[198:199], v6 offset:59392
    s_add_u32 m0, s89, 102400
    v_mfma_f32_16x16x32_bf16 v[184:187], a[148:151], a[24:27], v[184:187]
    s_add_u32 s90, s90, 28672
    buffer_load_dwordx4 v244, s[24:27], s90 offen offset:0 lds
    ds_read_b64_tr_b16 a[200:201], v7 offset:49152
    v_mfma_f32_16x16x32_bf16 v[200:203], a[148:151], a[28:31], v[200:203]
    ds_read_b64_tr_b16 a[202:203], v7 offset:51200
    ds_read_b64_tr_b16 a[204:205], v7 offset:57344
    ds_read_b64_tr_b16 a[206:207], v7 offset:59392
    v_mfma_f32_16x16x32_bf16 v[180:183], a[152:155], a[24:27], v[180:183]
    buffer_load_dwordx4 v245, s[24:27], s90 offen offset:1024 lds
    v_max_f32_e64 v150, 0, v150
    v_mfma_f32_16x16x32_bf16 v[196:199], a[152:155], a[28:31], v[196:199]
    v_max_f32 v151, 0, v151
    v_mul_f32 v144, v144, v152
    v_mul_f32_e64 v145, v145, v153
    v_mfma_f32_16x16x32_bf16 v[188:191], a[156:159], a[24:27], v[188:191]
    v_mul_f32 v146, v146, v154
    v_mul_f32 v147, v147, v155
    v_mul_f32_e64 v148, v148, v156
    v_mfma_f32_16x16x32_bf16 v[204:207], a[156:159], a[28:31], v[204:207]
    v_mul_f32_e64 v149, v149, v157
    v_mul_f32 v150, v150, v158
    s_waitcnt lgkmcnt(15)
    v_mfma_f32_16x16x32_bf16 v[208:211], a[160:163], a[24:27], v[208:211]
    ds_read_b64_tr_b16 a[208:209], v4 offset:53248
    ds_read_b64_tr_b16 a[210:211], v4 offset:55296
    v_mfma_f32_16x16x32_bf16 v[224:227], a[160:163], a[28:31], v[224:227]
    ds_read_b64_tr_b16 a[212:213], v4 offset:61440
    ds_read_b64_tr_b16 a[214:215], v4 offset:63488
    buffer_load_dwordx4 v246, s[24:27], s90 offen offset:2048 lds
    v_mfma_f32_16x16x32_bf16 v[216:219], a[164:167], a[24:27], v[216:219]
    ds_read_b64_tr_b16 a[216:217], v5 offset:53248
    ds_read_b64_tr_b16 a[218:219], v5 offset:55296
    ds_read_b64_tr_b16 a[220:221], v5 offset:61440
    v_mfma_f32_16x16x32_bf16 v[232:235], a[164:167], a[28:31], v[232:235]
    ds_read_b64_tr_b16 a[222:223], v5 offset:63488
    buffer_load_dwordx4 v247, s[24:27], s90 offen offset:3072 lds
    v_mul_f32_e64 v151, v151, v159
    v_mfma_f32_16x16x32_bf16 v[212:215], a[168:171], a[24:27], v[212:215]
    v_cvt_pk_bf16_f32 v152, v144, v145
    v_cvt_pk_bf16_f32 v153, v146, v147
    v_mfma_f32_16x16x32_bf16 v[228:231], a[168:171], a[28:31], v[228:231]
    v_cvt_pk_bf16_f32 v154, v148, v149
    v_cvt_pk_bf16_f32 v155, v150, v151
    buffer_store_dwordx4 v[152:155], v253, s[32:35], s69 offen offset:1024 sc1
    v_mfma_f32_16x16x32_bf16 v[220:223], a[172:175], a[24:27], v[220:223]
    v_max_f32 v160, 0, v160
    v_max_f32 v161, 0, v161
    v_max_f32_e64 v162, 0, v162
    v_mfma_f32_16x16x32_bf16 v[236:239], a[172:175], a[28:31], v[236:239]
    v_max_f32_e64 v163, 0, v163
    v_max_f32 v164, 0, v164
    s_waitcnt lgkmcnt(15)
    v_mfma_f32_16x16x32_bf16 v[176:179], a[176:179], a[32:35], v[176:179]
    ds_read_b64_tr_b16 a[224:225], v6 offset:53248
    ds_read_b64_tr_b16 a[226:227], v6 offset:55296
    v_mfma_f32_16x16x32_bf16 v[192:195], a[176:179], a[36:39], v[192:195]
    s_waitcnt vmcnt(11)
    s_nop 0
    ds_read_b64_tr_b16 a[228:229], v6 offset:61440
    ds_read_b64_tr_b16 a[230:231], v6 offset:63488
    v_mfma_f32_16x16x32_bf16 v[184:187], a[180:183], a[32:35], v[184:187]
    ds_read_b64_tr_b16 v[48:49], v248 offset:0
    ds_read_b64_tr_b16 a[232:233], v7 offset:53248
    ds_read_b64_tr_b16 a[234:235], v7 offset:55296
    v_mfma_f32_16x16x32_bf16 v[200:203], a[180:183], a[36:39], v[200:203]
    ds_read_b64_tr_b16 v[50:51], v248 offset:2048
    ds_read_b64_tr_b16 a[236:237], v7 offset:61440
    ds_read_b64_tr_b16 a[238:239], v7 offset:63488
    v_mfma_f32_16x16x32_bf16 v[180:183], a[184:187], a[32:35], v[180:183]
    ds_read_b64_tr_b16 v[52:53], v249 offset:0
    v_max_f32_e64 v165, 0, v165
    v_mfma_f32_16x16x32_bf16 v[196:199], a[184:187], a[36:39], v[196:199]
    v_max_f32 v166, 0, v166
    v_max_f32 v167, 0, v167
    v_mul_f32_e64 v160, v160, v168
    v_mfma_f32_16x16x32_bf16 v[188:191], a[188:191], a[32:35], v[188:191]
    v_mul_f32 v161, v161, v169
    v_mul_f32 v162, v162, v170
    v_mul_f32_e64 v163, v163, v171
    v_mfma_f32_16x16x32_bf16 v[204:207], a[188:191], a[36:39], v[204:207]
    v_mul_f32_e64 v164, v164, v172
    v_mul_f32 v165, v165, v173
    s_waitcnt lgkmcnt(15)
    v_mfma_f32_16x16x32_bf16 v[208:211], a[192:195], a[32:35], v[208:211]
    ds_read_b64_tr_b16 a[112:113], v4 offset:0
    ds_read_b64_tr_b16 a[114:115], v4 offset:2048
    v_mfma_f32_16x16x32_bf16 v[224:227], a[192:195], a[36:39], v[224:227]
    ds_read_b64_tr_b16 v[54:55], v249 offset:2048
    ds_read_b64_tr_b16 a[116:117], v4 offset:8192
    ds_read_b64_tr_b16 a[118:119], v4 offset:10240
    v_mfma_f32_16x16x32_bf16 v[216:219], a[196:199], a[32:35], v[216:219]
    ds_read_b64_tr_b16 v[56:57], v250 offset:0
    ds_read_b64_tr_b16 a[120:121], v5 offset:0
    v_mfma_f32_16x16x32_bf16 v[232:235], a[196:199], a[36:39], v[232:235]
    ds_read_b64_tr_b16 a[122:123], v5 offset:2048
    ds_read_b64_tr_b16 v[58:59], v250 offset:2048
    ds_read_b64_tr_b16 a[124:125], v5 offset:8192
    v_mfma_f32_16x16x32_bf16 v[212:215], a[200:203], a[32:35], v[212:215]
    ds_read_b64_tr_b16 a[126:127], v5 offset:10240
    ds_read_b64_tr_b16 v[60:61], v251 offset:0
    v_mfma_f32_16x16x32_bf16 v[228:231], a[200:203], a[36:39], v[228:231]
    v_mul_f32 v166, v166, v174
    v_mul_f32 v167, v167, v175
    v_cvt_pk_bf16_f32 v168, v160, v161
    v_mfma_f32_16x16x32_bf16 v[220:223], a[204:207], a[32:35], v[220:223]
    v_cvt_pk_bf16_f32 v169, v162, v163
    v_cvt_pk_bf16_f32 v170, v164, v165
    v_mfma_f32_16x16x32_bf16 v[236:239], a[204:207], a[36:39], v[236:239]
    v_cvt_pk_bf16_f32 v171, v166, v167
    buffer_store_dwordx4 v[168:171], v253, s[32:35], s69 offen offset:3072 sc1
    s_waitcnt lgkmcnt(15)
    s_nop 0
    v_mfma_f32_16x16x32_bf16 v[176:179], a[208:211], a[40:43], v[176:179]
    ds_read_b64_tr_b16 a[128:129], v6 offset:0
    v_mfma_f32_16x16x32_bf16 v[192:195], a[208:211], a[44:47], v[192:195]
    ds_read_b64_tr_b16 a[130:131], v6 offset:2048
    ds_read_b64_tr_b16 v[62:63], v251 offset:2048
    v_mfma_f32_16x16x32_bf16 v[184:187], a[212:215], a[40:43], v[184:187]
    ds_read_b64_tr_b16 a[132:133], v6 offset:8192
    v_mfma_f32_16x16x32_bf16 v[200:203], a[212:215], a[44:47], v[200:203]
    ds_read_b64_tr_b16 a[134:135], v6 offset:10240
    ds_read_b64_tr_b16 v[64:65], v248 offset:4096
    v_mfma_f32_16x16x32_bf16 v[180:183], a[216:219], a[40:43], v[180:183]
    ds_read_b64_tr_b16 a[136:137], v7 offset:0
    ds_read_b64_tr_b16 a[138:139], v7 offset:2048
    v_mfma_f32_16x16x32_bf16 v[196:199], a[216:219], a[44:47], v[196:199]
    ds_read_b64_tr_b16 v[66:67], v248 offset:6144
    v_mfma_f32_16x16x32_bf16 v[188:191], a[220:223], a[40:43], v[188:191]
    ds_read_b64_tr_b16 a[140:141], v7 offset:8192
    ds_read_b64_tr_b16 a[142:143], v7 offset:10240
    v_mfma_f32_16x16x32_bf16 v[204:207], a[220:223], a[44:47], v[204:207]
    ds_read_b64_tr_b16 v[68:69], v249 offset:4096
    s_waitcnt lgkmcnt(15)
    s_nop 0
    v_mfma_f32_16x16x32_bf16 v[208:211], a[224:227], a[40:43], v[208:211]
    ds_read_b64_tr_b16 a[144:145], v4 offset:4096
    ds_read_b64_tr_b16 a[146:147], v4 offset:6144
    v_mfma_f32_16x16x32_bf16 v[224:227], a[224:227], a[44:47], v[224:227]
    s_waitcnt vmcnt(20)
    s_barrier
    ds_read_b64_tr_b16 v[70:71], v249 offset:6144
    v_mfma_f32_16x16x32_bf16 v[216:219], a[228:231], a[40:43], v[216:219]
    ds_read_b64_tr_b16 a[148:149], v4 offset:12288
    ds_read_b64_tr_b16 a[150:151], v4 offset:14336
    v_mfma_f32_16x16x32_bf16 v[232:235], a[228:231], a[44:47], v[232:235]
    ds_read_b64_tr_b16 v[72:73], v250 offset:4096
    s_mul_i32 s90, s95, 57344
    s_add_u32 m0, s89, 32768
    v_mfma_f32_16x16x32_bf16 v[212:215], a[232:235], a[40:43], v[212:215]
    s_add_u32 s90, s90, s70
    s_nop 0
    buffer_load_dwordx4 v244, s[24:27], s90 offen offset:0 lds
    v_mfma_f32_16x16x32_bf16 v[228:231], a[232:235], a[44:47], v[228:231]
    ds_read_b64_tr_b16 a[152:153], v5 offset:4096
    ds_read_b64_tr_b16 a[154:155], v5 offset:6144
    ds_read_b64_tr_b16 v[74:75], v250 offset:6144
    v_mfma_f32_16x16x32_bf16 v[220:223], a[236:239], a[40:43], v[220:223]
    ds_read_b64_tr_b16 a[156:157], v5 offset:12288
    ds_read_b64_tr_b16 a[158:159], v5 offset:14336
    v_mfma_f32_16x16x32_bf16 v[236:239], a[236:239], a[44:47], v[236:239]
    ds_read_b64_tr_b16 v[76:77], v251 offset:4096
    buffer_load_dwordx4 v245, s[24:27], s90 offen offset:1024 lds
    s_waitcnt lgkmcnt(15)
    s_nop 0
    v_mfma_f32_16x16x32_bf16 v[176:179], a[112:115], a[48:51], v[176:179]
    ds_read_b64_tr_b16 a[160:161], v6 offset:4096
    v_mfma_f32_16x16x32_bf16 v[192:195], a[112:115], a[52:55], v[192:195]
    ds_read_b64_tr_b16 a[162:163], v6 offset:6144
    ds_read_b64_tr_b16 v[78:79], v251 offset:6144
    v_mfma_f32_16x16x32_bf16 v[184:187], a[116:119], a[48:51], v[184:187]
    ds_read_b64_tr_b16 a[164:165], v6 offset:12288
    v_mfma_f32_16x16x32_bf16 v[200:203], a[116:119], a[52:55], v[200:203]
    ds_read_b64_tr_b16 a[166:167], v6 offset:14336
    s_waitcnt lgkmcnt(2)
    s_nop 0
    v_mfma_f32_16x16x32_bf16 v[180:183], a[120:123], a[48:51], v[180:183]
    buffer_load_dwordx4 v246, s[24:27], s90 offen offset:2048 lds
    ds_read_b64_tr_b16 a[168:169], v7 offset:4096
    v_mfma_f32_16x16x32_bf16 v[196:199], a[120:123], a[52:55], v[196:199]
    ds_read_b64_tr_b16 a[170:171], v7 offset:6144
    v_mfma_f32_16x16x32_bf16 v[188:191], a[124:127], a[48:51], v[188:191]
    ds_read_b64_tr_b16 a[172:173], v7 offset:12288
    ds_read_b64_tr_b16 a[174:175], v7 offset:14336
    v_mfma_f32_16x16x32_bf16 v[204:207], a[124:127], a[52:55], v[204:207]
    buffer_load_dwordx4 v247, s[24:27], s90 offen offset:3072 lds
    s_waitcnt lgkmcnt(15)
    s_nop 0
    v_mfma_f32_16x16x32_bf16 v[208:211], a[128:131], a[48:51], v[208:211]
    ds_read_b64_tr_b16 a[176:177], v4 offset:16384
    v_mfma_f32_16x16x32_bf16 v[224:227], a[128:131], a[52:55], v[224:227]
    ds_read_b64_tr_b16 a[178:179], v4 offset:18432
    ds_read_b64_tr_b16 a[180:181], v4 offset:24576
    v_mfma_f32_16x16x32_bf16 v[216:219], a[132:135], a[48:51], v[216:219]
    ds_read_b64_tr_b16 a[182:183], v4 offset:26624
    v_mfma_f32_16x16x32_bf16 v[232:235], a[132:135], a[52:55], v[232:235]
    s_add_u32 m0, s89, 36864
    s_add_u32 s90, s90, 28672
    v_mfma_f32_16x16x32_bf16 v[212:215], a[136:139], a[48:51], v[212:215]
    buffer_load_dwordx4 v244, s[24:27], s90 offen offset:0 lds
    ds_read_b64_tr_b16 a[184:185], v5 offset:16384
    v_mfma_f32_16x16x32_bf16 v[228:231], a[136:139], a[52:55], v[228:231]
    ds_read_b64_tr_b16 a[186:187], v5 offset:18432
    v_mfma_f32_16x16x32_bf16 v[220:223], a[140:143], a[48:51], v[220:223]
    ds_read_b64_tr_b16 a[188:189], v5 offset:24576
    ds_read_b64_tr_b16 a[190:191], v5 offset:26624
    v_mfma_f32_16x16x32_bf16 v[236:239], a[140:143], a[52:55], v[236:239]
    buffer_load_dwordx4 v245, s[24:27], s90 offen offset:1024 lds
    s_waitcnt lgkmcnt(15)
    s_nop 0
    v_mfma_f32_16x16x32_bf16 v[176:179], a[144:147], a[56:59], v[176:179]
    ds_read_b64_tr_b16 a[192:193], v6 offset:16384
    v_mfma_f32_16x16x32_bf16 v[192:195], a[144:147], a[60:63], v[192:195]
    ds_read_b64_tr_b16 a[194:195], v6 offset:18432
    v_mfma_f32_16x16x32_bf16 v[184:187], a[148:151], a[56:59], v[184:187]
    ds_read_b64_tr_b16 a[196:197], v6 offset:24576
    ds_read_b64_tr_b16 a[198:199], v6 offset:26624
    v_mfma_f32_16x16x32_bf16 v[200:203], a[148:151], a[60:63], v[200:203]
    buffer_load_dwordx4 v246, s[24:27], s90 offen offset:2048 lds
    v_mfma_f32_16x16x32_bf16 v[180:183], a[152:155], a[56:59], v[180:183]
    ds_read_b64_tr_b16 a[200:201], v7 offset:16384
    v_mfma_f32_16x16x32_bf16 v[196:199], a[152:155], a[60:63], v[196:199]
    ds_read_b64_tr_b16 a[202:203], v7 offset:18432
    ds_read_b64_tr_b16 a[204:205], v7 offset:24576
    v_mfma_f32_16x16x32_bf16 v[188:191], a[156:159], a[56:59], v[188:191]
    ds_read_b64_tr_b16 a[206:207], v7 offset:26624
    v_mfma_f32_16x16x32_bf16 v[204:207], a[156:159], a[60:63], v[204:207]
    buffer_load_dwordx4 v247, s[24:27], s90 offen offset:3072 lds
    s_waitcnt lgkmcnt(15)
    s_nop 0
    v_mfma_f32_16x16x32_bf16 v[208:211], a[160:163], a[56:59], v[208:211]
    ds_read_b64_tr_b16 a[208:209], v4 offset:20480
    v_mfma_f32_16x16x32_bf16 v[224:227], a[160:163], a[60:63], v[224:227]
    ds_read_b64_tr_b16 a[210:211], v4 offset:22528
    ds_read_b64_tr_b16 a[212:213], v4 offset:28672
    v_mfma_f32_16x16x32_bf16 v[216:219], a[164:167], a[56:59], v[216:219]
    ds_read_b64_tr_b16 a[214:215], v4 offset:30720
    s_mul_i32 s90, s93, 57344
    v_mfma_f32_16x16x32_bf16 v[232:235], a[164:167], a[60:63], v[232:235]
    s_add_u32 m0, s89, 131072
    s_add_u32 s90, s90, s70
    s_nop 0
    v_mfma_f32_16x16x32_bf16 v[212:215], a[168:171], a[56:59], v[212:215]
    buffer_load_dwordx4 v244, s[24:27], s90 offen offset:0 lds
    v_mfma_f32_16x16x32_bf16 v[228:231], a[168:171], a[60:63], v[228:231]
    ds_read_b64_tr_b16 a[216:217], v5 offset:20480
    ds_read_b64_tr_b16 a[218:219], v5 offset:22528
    v_mfma_f32_16x16x32_bf16 v[220:223], a[172:175], a[56:59], v[220:223]
    ds_read_b64_tr_b16 a[220:221], v5 offset:28672
    ds_read_b64_tr_b16 a[222:223], v5 offset:30720
    v_mfma_f32_16x16x32_bf16 v[236:239], a[172:175], a[60:63], v[236:239]
    buffer_load_dwordx4 v245, s[24:27], s90 offen offset:1024 lds
    s_waitcnt lgkmcnt(15)
    s_nop 0
    v_mfma_f32_16x16x32_bf16 v[176:179], a[176:179], a[64:67], v[176:179]
    ds_read_b64_tr_b16 a[224:225], v6 offset:20480
    v_mfma_f32_16x16x32_bf16 v[192:195], a[176:179], a[68:71], v[192:195]
    ds_read_b64_tr_b16 a[226:227], v6 offset:22528
    v_mfma_f32_16x16x32_bf16 v[184:187], a[180:183], a[64:67], v[184:187]
    ds_read_b64_tr_b16 a[228:229], v6 offset:28672
    ds_read_b64_tr_b16 a[230:231], v6 offset:30720
    v_mfma_f32_16x16x32_bf16 v[200:203], a[180:183], a[68:71], v[200:203]
    buffer_load_dwordx4 v246, s[24:27], s90 offen offset:2048 lds
    v_mfma_f32_16x16x32_bf16 v[180:183], a[184:187], a[64:67], v[180:183]
    ds_read_b64_tr_b16 a[232:233], v7 offset:20480
    v_mfma_f32_16x16x32_bf16 v[196:199], a[184:187], a[68:71], v[196:199]
    ds_read_b64_tr_b16 a[234:235], v7 offset:22528
    ds_read_b64_tr_b16 a[236:237], v7 offset:28672
    v_mfma_f32_16x16x32_bf16 v[188:191], a[188:191], a[64:67], v[188:191]
    ds_read_b64_tr_b16 a[238:239], v7 offset:30720
    v_mfma_f32_16x16x32_bf16 v[204:207], a[188:191], a[68:71], v[204:207]
    buffer_load_dwordx4 v247, s[24:27], s90 offen offset:3072 lds
    s_waitcnt lgkmcnt(15)
    s_nop 0
    v_mfma_f32_16x16x32_bf16 v[208:211], a[192:195], a[64:67], v[208:211]
    ds_read_b64_tr_b16 a[112:113], v8 offset:0
    v_mfma_f32_16x16x32_bf16 v[224:227], a[192:195], a[68:71], v[224:227]
    ds_read_b64_tr_b16 a[114:115], v8 offset:2048
    ds_read_b64_tr_b16 a[116:117], v8 offset:8192
    v_mfma_f32_16x16x32_bf16 v[216:219], a[196:199], a[64:67], v[216:219]
    ds_read_b64_tr_b16 a[118:119], v8 offset:10240
    v_mfma_f32_16x16x32_bf16 v[232:235], a[196:199], a[68:71], v[232:235]
    s_add_u32 m0, s89, 135168
    s_add_u32 s90, s90, 28672
    v_mfma_f32_16x16x32_bf16 v[212:215], a[200:203], a[64:67], v[212:215]
    buffer_load_dwordx4 v244, s[24:27], s90 offen offset:0 lds
    ds_read_b64_tr_b16 a[120:121], v9 offset:0
    v_mfma_f32_16x16x32_bf16 v[228:231], a[200:203], a[68:71], v[228:231]
    ds_read_b64_tr_b16 a[122:123], v9 offset:2048
    v_mfma_f32_16x16x32_bf16 v[220:223], a[204:207], a[64:67], v[220:223]
    ds_read_b64_tr_b16 a[124:125], v9 offset:8192
    ds_read_b64_tr_b16 a[126:127], v9 offset:10240
    v_mfma_f32_16x16x32_bf16 v[236:239], a[204:207], a[68:71], v[236:239]
    buffer_load_dwordx4 v245, s[24:27], s90 offen offset:1024 lds
    s_waitcnt lgkmcnt(15)
    s_nop 0
    v_mfma_f32_16x16x32_bf16 v[176:179], a[208:211], a[72:75], v[176:179]
    ds_read_b64_tr_b16 a[128:129], v10 offset:0
    v_mfma_f32_16x16x32_bf16 v[192:195], a[208:211], a[76:79], v[192:195]
    ds_read_b64_tr_b16 a[130:131], v10 offset:2048
    s_waitcnt vmcnt(14)
    v_mfma_f32_16x16x32_bf16 v[184:187], a[212:215], a[72:75], v[184:187]
    s_cmp_eq_u32 s45, 0
    s_mov_b64 exec, 1
    s_cbranch_scc1 Lf_40
    buffer_store_dword v252, off, s[32:35], s59 offset:0
    s_branch Lf_41
Lf_40:
    buffer_store_dword v252, off, s[32:35], s59 offset:0 sc1
Lf_41:
    s_mov_b64 exec, -1
    v_mfma_f32_16x16x32_bf16 v[200:203], a[212:215], a[76:79], v[200:203]
    ds_read_b64_tr_b16 a[132:133], v10 offset:8192
    ds_read_b64_tr_b16 a[134:135], v10 offset:10240
    v_mfma_f32_16x16x32_bf16 v[180:183], a[216:219], a[72:75], v[180:183]
    buffer_load_dwordx4 v246, s[24:27], s90 offen offset:2048 lds
    ds_read_b64_tr_b16 a[136:137], v11 offset:0
    v_mfma_f32_16x16x32_bf16 v[196:199], a[216:219], a[76:79], v[196:199]
    ds_read_b64_tr_b16 a[138:139], v11 offset:2048
    v_mfma_f32_16x16x32_bf16 v[188:191], a[220:223], a[72:75], v[188:191]
    ds_read_b64_tr_b16 a[140:141], v11 offset:8192
    ds_read_b64_tr_b16 a[142:143], v11 offset:10240
    v_mfma_f32_16x16x32_bf16 v[204:207], a[220:223], a[76:79], v[204:207]
    buffer_load_dwordx4 v247, s[24:27], s90 offen offset:3072 lds
    s_waitcnt lgkmcnt(15)
    v_mfma_f32_16x16x32_bf16 v[208:211], a[224:227], a[72:75], v[208:211]
    ds_read_b64_tr_b16 a[144:145], v8 offset:4096
    v_mfma_f32_16x16x32_bf16 v[224:227], a[224:227], a[76:79], v[224:227]
    ds_read_b64_tr_b16 a[146:147], v8 offset:6144
    s_barrier
    v_mfma_f32_16x16x32_bf16 v[216:219], a[228:231], a[72:75], v[216:219]
    ds_read_b64_tr_b16 a[148:149], v8 offset:12288
    ds_read_b64_tr_b16 a[150:151], v8 offset:14336
    v_mfma_f32_16x16x32_bf16 v[232:235], a[228:231], a[76:79], v[232:235]
    s_mul_i32 s90, s97, 57344
    s_add_u32 m0, s89, 0
    v_mfma_f32_16x16x32_bf16 v[212:215], a[232:235], a[72:75], v[212:215]
    s_add_u32 s90, s90, s70
    buffer_load_dwordx4 v244, s[24:27], s90 offen offset:0 lds
    v_mfma_f32_16x16x32_bf16 v[228:231], a[232:235], a[76:79], v[228:231]
    ds_read_b64_tr_b16 a[152:153], v9 offset:4096
    ds_read_b64_tr_b16 a[154:155], v9 offset:6144
    v_mfma_f32_16x16x32_bf16 v[220:223], a[236:239], a[72:75], v[220:223]
    ds_read_b64_tr_b16 a[156:157], v9 offset:12288
    ds_read_b64_tr_b16 a[158:159], v9 offset:14336
    v_mfma_f32_16x16x32_bf16 v[236:239], a[236:239], a[76:79], v[236:239]
    buffer_load_dwordx4 v245, s[24:27], s90 offen offset:1024 lds
    s_waitcnt lgkmcnt(15)
    s_nop 0
    v_mfma_f32_16x16x32_bf16 v[176:179], a[112:115], a[80:83], v[176:179]
    ds_read_b64_tr_b16 a[160:161], v10 offset:4096
    v_mfma_f32_16x16x32_bf16 v[192:195], a[112:115], a[84:87], v[192:195]
    ds_read_b64_tr_b16 a[162:163], v10 offset:6144
    v_mfma_f32_16x16x32_bf16 v[184:187], a[116:119], a[80:83], v[184:187]
    ds_read_b64_tr_b16 a[164:165], v10 offset:12288
    ds_read_b64_tr_b16 a[166:167], v10 offset:14336
    v_mfma_f32_16x16x32_bf16 v[200:203], a[116:119], a[84:87], v[200:203]
    buffer_load_dwordx4 v246, s[24:27], s90 offen offset:2048 lds
    v_mfma_f32_16x16x32_bf16 v[180:183], a[120:123], a[80:83], v[180:183]
    ds_read_b64_tr_b16 a[168:169], v11 offset:4096
    v_mfma_f32_16x16x32_bf16 v[196:199], a[120:123], a[84:87], v[196:199]
    ds_read_b64_tr_b16 a[170:171], v11 offset:6144
    ds_read_b64_tr_b16 a[172:173], v11 offset:12288
    v_mfma_f32_16x16x32_bf16 v[188:191], a[124:127], a[80:83], v[188:191]
    ds_read_b64_tr_b16 a[174:175], v11 offset:14336
    v_mfma_f32_16x16x32_bf16 v[204:207], a[124:127], a[84:87], v[204:207]
    buffer_load_dwordx4 v247, s[24:27], s90 offen offset:3072 lds
    s_waitcnt lgkmcnt(15)
    s_nop 0
    v_mfma_f32_16x16x32_bf16 v[208:211], a[128:131], a[80:83], v[208:211]
    ds_read_b64_tr_b16 a[176:177], v8 offset:16384
    v_mfma_f32_16x16x32_bf16 v[224:227], a[128:131], a[84:87], v[224:227]
    ds_read_b64_tr_b16 a[178:179], v8 offset:18432
    ds_read_b64_tr_b16 a[180:181], v8 offset:24576
    v_mfma_f32_16x16x32_bf16 v[216:219], a[132:135], a[80:83], v[216:219]
    ds_read_b64_tr_b16 a[182:183], v8 offset:26624
    s_add_u32 m0, s89, 4096
    v_mfma_f32_16x16x32_bf16 v[232:235], a[132:135], a[84:87], v[232:235]
    s_add_u32 s90, s90, 28672
    buffer_load_dwordx4 v244, s[24:27], s90 offen offset:0 lds
    v_mfma_f32_16x16x32_bf16 v[212:215], a[136:139], a[80:83], v[212:215]
    ds_read_b64_tr_b16 a[184:185], v9 offset:16384
    ds_read_b64_tr_b16 a[186:187], v9 offset:18432
    v_mfma_f32_16x16x32_bf16 v[228:231], a[136:139], a[84:87], v[228:231]
    buffer_load_dword v15, v2, s[32:35], s71 offen sc1
    buffer_load_dword v14, v1, s[32:35], s83 offen sc1
    v_mfma_f32_16x16x32_bf16 v[220:223], a[140:143], a[80:83], v[220:223]
    ds_read_b64_tr_b16 a[188:189], v9 offset:24576
    ds_read_b64_tr_b16 a[190:191], v9 offset:26624
    v_mfma_f32_16x16x32_bf16 v[236:239], a[140:143], a[84:87], v[236:239]
    buffer_load_dwordx4 v245, s[24:27], s90 offen offset:1024 lds
    s_waitcnt lgkmcnt(15)
    s_nop 0
    v_mfma_f32_16x16x32_bf16 v[176:179], a[144:147], a[88:91], v[176:179]
    ds_read_b64_tr_b16 a[192:193], v8 offset:20480
    v_mfma_f32_16x16x32_bf16 v[192:195], a[144:147], a[92:95], v[192:195]
    ds_read_b64_tr_b16 a[194:195], v8 offset:22528
    v_mfma_f32_16x16x32_bf16 v[184:187], a[148:151], a[88:91], v[184:187]
    ds_read_b64_tr_b16 a[196:197], v8 offset:28672
    ds_read_b64_tr_b16 a[198:199], v8 offset:30720
    v_mfma_f32_16x16x32_bf16 v[200:203], a[148:151], a[92:95], v[200:203]
    buffer_load_dwordx4 v246, s[24:27], s90 offen offset:2048 lds
    v_mfma_f32_16x16x32_bf16 v[180:183], a[152:155], a[88:91], v[180:183]
    ds_read_b64_tr_b16 a[200:201], v9 offset:20480
    v_mfma_f32_16x16x32_bf16 v[196:199], a[152:155], a[92:95], v[196:199]
    ds_read_b64_tr_b16 a[202:203], v9 offset:22528
    ds_read_b64_tr_b16 a[204:205], v9 offset:28672
    v_mfma_f32_16x16x32_bf16 v[188:191], a[156:159], a[88:91], v[188:191]
    ds_read_b64_tr_b16 a[206:207], v9 offset:30720
    v_mfma_f32_16x16x32_bf16 v[204:207], a[156:159], a[92:95], v[204:207]
    buffer_load_dwordx4 v247, s[24:27], s90 offen offset:3072 lds
    s_waitcnt lgkmcnt(15)
    v_mfma_f32_16x16x32_bf16 v[208:211], a[160:163], a[88:91], v[208:211]
    ds_read_b64_tr_b16 a[208:209], v10 offset:16384
    v_mfma_f32_16x16x32_bf16 v[224:227], a[160:163], a[92:95], v[224:227]
    ds_read_b64_tr_b16 a[210:211], v10 offset:18432
    s_waitcnt vmcnt(10)
    v_mfma_f32_16x16x32_bf16 v[216:219], a[164:167], a[88:91], v[216:219]
    ds_read_b64_tr_b16 a[212:213], v10 offset:24576
    v_mfma_f32_16x16x32_bf16 v[232:235], a[164:167], a[92:95], v[232:235]
    ds_read_b64_tr_b16 a[214:215], v10 offset:26624
    ds_read_b64_tr_b16 v[80:81], v248 offset:0
    v_mfma_f32_16x16x32_bf16 v[212:215], a[168:171], a[88:91], v[212:215]
    ds_read_b64_tr_b16 a[216:217], v11 offset:16384
    ds_read_b64_tr_b16 a[218:219], v11 offset:18432
    v_mfma_f32_16x16x32_bf16 v[228:231], a[168:171], a[92:95], v[228:231]
    ds_read_b64_tr_b16 v[82:83], v248 offset:2048
    v_mfma_f32_16x16x32_bf16 v[220:223], a[172:175], a[88:91], v[220:223]
    ds_read_b64_tr_b16 a[220:221], v11 offset:24576
    ds_read_b64_tr_b16 a[222:223], v11 offset:26624
    v_mfma_f32_16x16x32_bf16 v[236:239], a[172:175], a[92:95], v[236:239]
    ds_read_b64_tr_b16 v[84:85], v249 offset:0
    s_waitcnt lgkmcnt(15)
    s_nop 0
    v_mfma_f32_16x16x32_bf16 v[176:179], a[176:179], a[96:99], v[176:179]
    ds_read_b64_tr_b16 a[224:225], v10 offset:20480
    ds_read_b64_tr_b16 a[226:227], v10 offset:22528
    v_mfma_f32_16x16x32_bf16 v[192:195], a[176:179], a[100:103], v[192:195]
    ds_read_b64_tr_b16 v[86:87], v249 offset:2048
    ds_read_b64_tr_b16 a[228:229], v10 offset:28672
    v_mfma_f32_16x16x32_bf16 v[184:187], a[180:183], a[96:99], v[184:187]
    ds_read_b64_tr_b16 a[230:231], v10 offset:30720
    ds_read_b64_tr_b16 v[88:89], v250 offset:0
    v_mfma_f32_16x16x32_bf16 v[200:203], a[180:183], a[100:103], v[200:203]
    ds_read_b64_tr_b16 a[232:233], v11 offset:20480
    ds_read_b64_tr_b16 a[234:235], v11 offset:22528
    v_mfma_f32_16x16x32_bf16 v[180:183], a[184:187], a[96:99], v[180:183]
    ds_read_b64_tr_b16 v[90:91], v250 offset:2048
    s_waitcnt vmcnt(3)
    v_mfma_f32_16x16x32_bf16 v[196:199], a[184:187], a[100:103], v[196:199]
    v_cmp_ne_u32 vcc, s46, v15
    s_cbranch_vccz Lc_42
    s_mov_b32 s50, 0x40000
Lp_43:
    buffer_load_dword v15, v2, s[32:35], s71 offen sc1
    s_waitcnt vmcnt(0)
    v_cmp_ne_u32 vcc, s46, v15
    s_cbranch_vccz Lp_44
    s_sub_u32 s50, s50, 1
    s_cmp_lg_u32 s50, 0
    s_cbranch_scc1 Lp_43
Lp_44:
Lc_42:
    s_waitcnt vmcnt(3)
    v_cmp_ne_u32 vcc, s46, v14
    s_cbranch_vccz Lc_45
    s_mov_b32 s50, 0x40000
Lp_46:
    buffer_load_dword v15, v1, s[32:35], s83 offen sc1
    s_waitcnt vmcnt(0)
    v_cmp_ne_u32 vcc, s46, v15
    s_cbranch_vccz Lp_47
    s_sub_u32 s50, s50, 1
    s_cmp_lg_u32 s50, 0
    s_cbranch_scc1 Lp_46
Lp_47:
Lc_45:
    ds_read_b64_tr_b16 a[236:237], v11 offset:28672
    v_mfma_f32_16x16x32_bf16 v[188:191], a[188:191], a[96:99], v[188:191]
    ds_read_b64_tr_b16 a[238:239], v11 offset:30720
    ds_read_b64_tr_b16 v[92:93], v251 offset:0
    v_mfma_f32_16x16x32_bf16 v[204:207], a[188:191], a[100:103], v[204:207]
    buffer_load_dwordx4 v[112:115], v253, s[32:35], s72 offen offset:0 sc1
    s_waitcnt lgkmcnt(15)
    s_nop 0
    v_mfma_f32_16x16x32_bf16 v[176:179], a[192:195], a[104:107], v[176:179]
    ds_read_b64_tr_b16 v[94:95], v251 offset:2048
    v_mfma_f32_16x16x32_bf16 v[192:195], a[192:195], a[108:111], v[192:195]
    buffer_load_dwordx4 v[116:119], v253, s[32:35], s72 offen offset:1024 sc1
    v_mfma_f32_16x16x32_bf16 v[184:187], a[196:199], a[104:107], v[184:187]
    ds_read_b64_tr_b16 v[96:97], v248 offset:4096
    v_mfma_f32_16x16x32_bf16 v[200:203], a[196:199], a[108:111], v[200:203]
    buffer_load_dwordx4 v[120:123], v253, s[32:35], s73 offen offset:0 sc1
    v_mfma_f32_16x16x32_bf16 v[180:183], a[200:203], a[104:107], v[180:183]
    ds_read_b64_tr_b16 v[98:99], v248 offset:6144
    v_mfma_f32_16x16x32_bf16 v[196:199], a[200:203], a[108:111], v[196:199]
    buffer_load_dwordx4 v[124:127], v253, s[32:35], s73 offen offset:1024 sc1
    v_mfma_f32_16x16x32_bf16 v[188:191], a[204:207], a[104:107], v[188:191]
    ds_read_b64_tr_b16 v[100:101], v249 offset:4096
    v_mfma_f32_16x16x32_bf16 v[204:207], a[204:207], a[108:111], v[204:207]
    buffer_load_dwordx4 v[128:131], v253, s[32:35], s74 offen offset:0 sc1
    s_waitcnt lgkmcnt(15)
    s_nop 0
    v_mfma_f32_16x16x32_bf16 v[208:211], a[208:211], a[96:99], v[208:211]
    ds_read_b64_tr_b16 v[102:103], v249 offset:6144
    buffer_load_dwordx4 v[132:135], v253, s[32:35], s74 offen offset:1024 sc1
    v_mfma_f32_16x16x32_bf16 v[224:227], a[208:211], a[100:103], v[224:227]
    ds_read_b64_tr_b16 v[104:105], v250 offset:4096
    buffer_load_dwordx4 v[136:139], v253, s[32:35], s72 offen offset:2048 sc1
    ds_read_b64_tr_b16 v[106:107], v250 offset:6144
    v_mfma_f32_16x16x32_bf16 v[216:219], a[212:215], a[96:99], v[216:219]
    buffer_load_dwordx4 v[140:143], v253, s[32:35], s72 offen offset:3072 sc1
    ds_read_b64_tr_b16 v[108:109], v251 offset:4096
    v_max_f32_e64 v176, 0, v176
    v_mfma_f32_16x16x32_bf16 v[232:235], a[212:215], a[100:103], v[232:235]
    v_max_f32 v177, 0, v177
    v_max_f32 v178, 0, v178
    v_max_f32_e64 v179, 0, v179
    v_mfma_f32_16x16x32_bf16 v[212:215], a[216:219], a[96:99], v[212:215]
    v_max_f32 v180, 0, v180
    v_max_f32 v181, 0, v181
    v_mfma_f32_16x16x32_bf16 v[228:231], a[216:219], a[100:103], v[228:231]
    v_max_f32 v182, 0, v182
    v_max_f32 v183, 0, v183
    v_mul_f32_e64 v176, v176, v184
    v_mfma_f32_16x16x32_bf16 v[220:223], a[220:223], a[96:99], v[220:223]
    v_mul_f32 v177, v177, v185
    v_mul_f32 v178, v178, v186
    v_mul_f32_e64 v179, v179, v187
    v_mfma_f32_16x16x32_bf16 v[236:239], a[220:223], a[100:103], v[236:239]
    v_mul_f32 v180, v180, v188
    v_mul_f32 v181, v181, v189
    s_waitcnt lgkmcnt(9)
    v_mfma_f32_16x16x32_bf16 v[208:211], a[224:227], a[104:107], v[208:211]
    s_barrier
    ds_read_b64_tr_b16 v[110:111], v251 offset:6144
    v_mfma_f32_16x16x32_bf16 v[224:227], a[224:227], a[108:111], v[224:227]
    s_waitcnt lgkmcnt(0)
    s_mul_i32 s90, s96, 57344
    s_add_u32 m0, s89, 131072
    v_mfma_f32_16x16x32_bf16 v[216:219], a[228:231], a[104:107], v[216:219]
    s_add_u32 s90, s90, s70
    buffer_load_dwordx4 v244, s[24:27], s90 offen offset:0 lds
    buffer_load_dwordx4 v245, s[24:27], s90 offen offset:1024 lds
    v_mfma_f32_16x16x32_bf16 v[232:235], a[228:231], a[108:111], v[232:235]
    buffer_load_dwordx4 v246, s[24:27], s90 offen offset:2048 lds
    v_mul_f32 v182, v182, v190
    v_mul_f32 v183, v183, v191
    v_mfma_f32_16x16x32_bf16 v[212:215], a[232:235], a[104:107], v[212:215]
    v_cvt_pk_bf16_f32 v184, v176, v177
    v_cvt_pk_bf16_f32 v185, v178, v179
    v_mfma_f32_16x16x32_bf16 v[228:231], a[232:235], a[108:111], v[228:231]
    v_cvt_pk_bf16_f32 v186, v180, v181
    v_cvt_pk_bf16_f32 v187, v182, v183
    v_max_f32_e64 v192, 0, v192
    v_mfma_f32_16x16x32_bf16 v[220:223], a[236:239], a[104:107], v[220:223]
    v_max_f32 v193, 0, v193
    v_max_f32 v194, 0, v194
    v_max_f32_e64 v195, 0, v195
    v_mfma_f32_16x16x32_bf16 v[236:239], a[236:239], a[108:111], v[236:239]
    v_max_f32 v196, 0, v196
    v_max_f32 v197, 0, v197
    buffer_load_dwordx4 v247, s[24:27], s90 offen offset:3072 lds
    s_add_u32 m0, s89, 135168
    s_add_u32 s90, s90, 28672
    buffer_load_dwordx4 v244, s[24:27], s90 offen offset:0 lds
    buffer_load_dwordx4 v245, s[24:27], s90 offen offset:1024 lds
    buffer_load_dwordx4 v246, s[24:27], s90 offen offset:2048 lds
    buffer_load_dwordx4 v247, s[24:27], s90 offen offset:3072 lds
    v_max_f32 v198, 0, v198
    v_max_f32 v199, 0, v199
    v_mul_f32 v192, v192, v200
    v_mul_f32 v193, v193, v201
    v_mul_f32 v194, v194, v202
    v_mul_f32 v195, v195, v203
    v_mul_f32 v196, v196, v204
    v_mul_f32 v197, v197, v205
    v_mul_f32 v198, v198, v206
    v_mul_f32 v199, v199, v207
    v_cvt_pk_bf16_f32 v200, v192, v193
    v_cvt_pk_bf16_f32 v201, v194, v195
    v_cvt_pk_bf16_f32 v202, v196, v197
    v_cvt_pk_bf16_f32 v203, v198, v199
    v_max_f32 v208, 0, v208
    v_max_f32 v209, 0, v209
    v_max_f32 v210, 0, v210
    v_max_f32 v211, 0, v211
    v_max_f32 v212, 0, v212
    v_max_f32 v213, 0, v213
    v_max_f32 v214, 0, v214
    v_max_f32 v215, 0, v215
    v_pk_mul_f32 v[208:209], v[208:209], v[216:217]
    v_pk_mul_f32 v[210:211], v[210:211], v[218:219]
    v_pk_mul_f32 v[212:213], v[212:213], v[220:221]
    v_pk_mul_f32 v[214:215], v[214:215], v[222:223]
    v_cvt_pk_bf16_f32 v216, v208, v209
    v_cvt_pk_bf16_f32 v217, v210, v211
    v_cvt_pk_bf16_f32 v218, v212, v213
    v_cvt_pk_bf16_f32 v219, v214, v215
    v_max_f32 v224, 0, v224
    v_max_f32 v225, 0, v225
    v_max_f32 v226, 0, v226
    v_max_f32 v227, 0, v227
    v_max_f32 v228, 0, v228
    v_max_f32 v229, 0, v229
    v_max_f32 v230, 0, v230
    v_max_f32 v231, 0, v231
    v_pk_mul_f32 v[224:225], v[224:225], v[232:233]
    v_pk_mul_f32 v[226:227], v[226:227], v[234:235]
    v_pk_mul_f32 v[228:229], v[228:229], v[236:237]
    v_pk_mul_f32 v[230:231], v[230:231], v[238:239]
    v_cvt_pk_bf16_f32 v232, v224, v225
    v_cvt_pk_bf16_f32 v233, v226, v227
    v_cvt_pk_bf16_f32 v234, v228, v229
    v_cvt_pk_bf16_f32 v235, v230, v231
    s_cmp_eq_u32 s45, 0
    s_cbranch_scc1 Ls_48
    buffer_store_dwordx4 v[184:187], v253, s[32:35], s82 offen offset:0
    buffer_store_dwordx4 v[200:203], v253, s[32:35], s82 offen offset:2048
    buffer_store_dwordx4 v[216:219], v253, s[32:35], s82 offen offset:1024
    buffer_store_dwordx4 v[232:235], v253, s[32:35], s82 offen offset:3072
    s_branch Ls_49
Ls_48:
    s_nop 7
    s_nop 3
    buffer_store_dwordx4 v[184:187], v253, s[32:35], s82 offen offset:0 sc1
    buffer_store_dwordx4 v[200:203], v253, s[32:35], s82 offen offset:2048 sc1
    buffer_store_dwordx4 v[216:219], v253, s[32:35], s82 offen offset:1024 sc1
    buffer_store_dwordx4 v[232:235], v253, s[32:35], s82 offen offset:3072 sc1
Ls_49:
    s_waitcnt vmcnt(19)
    v_mfma_f32_16x16x32_bf16 v[176:179], v[16:19], v[112:115], 0
    buffer_load_dwordx4 v[144:147], v253, s[32:35], s73 offen offset:2048 sc1
    v_mfma_f32_16x16x32_bf16 v[180:183], v[20:23], v[112:115], 0
    v_add_u32 v4, s89, v4
    v_add_u32 v5, s89, v5
    v_mfma_f32_16x16x32_bf16 v[184:187], v[24:27], v[112:115], 0
    v_add_u32_e64 v6, s89, v6
    v_mfma_f32_16x16x32_bf16 v[188:191], v[28:31], v[112:115], 0
    v_add_u32 v7, s89, v7
    s_waitcnt vmcnt(19)
    v_mfma_f32_16x16x32_bf16 v[176:179], v[32:35], v[116:119], v[176:179]
    buffer_load_dwordx4 v[148:151], v253, s[32:35], s73 offen offset:3072 sc1
    v_mfma_f32_16x16x32_bf16 v[180:183], v[36:39], v[116:119], v[180:183]
    v_add_u32 v8, s89, v8
    v_add_u32 v9, s89, v9
    v_mfma_f32_16x16x32_bf16 v[184:187], v[40:43], v[116:119], v[184:187]
    v_add_u32_e64 v10, s89, v10
    v_mfma_f32_16x16x32_bf16 v[188:191], v[44:47], v[116:119], v[188:191]
    v_add_u32 v11, s89, v11
    s_waitcnt vmcnt(19)
    v_mfma_f32_16x16x32_bf16 v[176:179], v[48:51], v[120:123], v[176:179]
    buffer_load_dwordx4 v[152:155], v253, s[32:35], s74 offen offset:2048 sc1
    v_mfma_f32_16x16x32_bf16 v[180:183], v[52:55], v[120:123], v[180:183]
    s_waitcnt vmcnt(52)
    ds_read_b64_tr_b16 a[0:1], v8 offset:32768
    v_mfma_f32_16x16x32_bf16 v[184:187], v[56:59], v[120:123], v[184:187]
    ds_read_b64_tr_b16 a[2:3], v8 offset:34816
    v_mfma_f32_16x16x32_bf16 v[188:191], v[60:63], v[120:123], v[188:191]
    ds_read_b64_tr_b16 a[4:5], v9 offset:32768
    s_waitcnt vmcnt(19)
    v_mfma_f32_16x16x32_bf16 v[176:179], v[64:67], v[124:127], v[176:179]
    buffer_load_dwordx4 v[156:159], v253, s[32:35], s74 offen offset:3072 sc1
    v_mfma_f32_16x16x32_bf16 v[180:183], v[68:71], v[124:127], v[180:183]
    ds_read_b64_tr_b16 a[6:7], v9 offset:34816
    ds_read_b64_tr_b16 a[8:9], v10 offset:32768
    v_mfma_f32_16x16x32_bf16 v[184:187], v[72:75], v[124:127], v[184:187]
    ds_read_b64_tr_b16 a[10:11], v10 offset:34816
    v_mfma_f32_16x16x32_bf16 v[188:191], v[76:79], v[124:127], v[188:191]
    ds_read_b64_tr_b16 a[12:13], v11 offset:32768
    s_waitcnt vmcnt(19)
    s_nop 0
    v_mfma_f32_16x16x32_bf16 v[176:179], v[80:83], v[128:131], v[176:179]
    buffer_load_dwordx4 v[160:163], v3, s[32:35], s72 offen offset:0 sc1
    v_mfma_f32_16x16x32_bf16 v[180:183], v[84:87], v[128:131], v[180:183]
    ds_read_b64_tr_b16 a[14:15], v11 offset:34816
    ds_read_b64_tr_b16 a[16:17], v8 offset:36864
    v_mfma_f32_16x16x32_bf16 v[184:187], v[88:91], v[128:131], v[184:187]
    ds_read_b64_tr_b16 a[18:19], v8 offset:38912
    v_mfma_f32_16x16x32_bf16 v[188:191], v[92:95], v[128:131], v[188:191]
    ds_read_b64_tr_b16 a[20:21], v9 offset:36864
    s_waitcnt vmcnt(19)
    s_nop 0
    v_mfma_f32_16x16x32_bf16 v[176:179], v[96:99], v[132:135], v[176:179]
    buffer_load_dwordx4 v[164:167], v3, s[32:35], s72 offen offset:1024 sc1
    v_mfma_f32_16x16x32_bf16 v[180:183], v[100:103], v[132:135], v[180:183]
    ds_read_b64_tr_b16 a[22:23], v9 offset:38912
    ds_read_b64_tr_b16 a[24:25], v10 offset:36864
    v_mfma_f32_16x16x32_bf16 v[184:187], v[104:107], v[132:135], v[184:187]
    ds_read_b64_tr_b16 a[26:27], v10 offset:38912
    v_mfma_f32_16x16x32_bf16 v[188:191], v[108:111], v[132:135], v[188:191]
    ds_read_b64_tr_b16 a[28:29], v11 offset:36864
    s_waitcnt vmcnt(6)
    s_cmp_eq_u32 s45, 0
    s_mov_b64 exec, 1
    s_cbranch_scc1 Lf_50
    buffer_store_dword v252, off, s[32:35], s59 offset:512
    s_branch Lf_51
Lf_50:
    s_nop 0
    buffer_store_dword v252, off, s[32:35], s59 offset:512 sc1
Lf_51:
    s_mov_b64 exec, -1
    s_waitcnt vmcnt(20)
    v_mfma_f32_16x16x32_bf16 v[192:195], v[16:19], v[136:139], 0
    buffer_load_dwordx4 v[168:171], v3, s[32:35], s73 offen offset:0 sc1
    v_mfma_f32_16x16x32_bf16 v[196:199], v[20:23], v[136:139], 0
    ds_read_b64_tr_b16 a[30:31], v11 offset:38912
    s_waitcnt vmcnt(47)
    v_mfma_f32_16x16x32_bf16 v[200:203], v[24:27], v[136:139], 0
    ds_read_b64_tr_b16 a[32:33], v4 offset:32768
    v_mfma_f32_16x16x32_bf16 v[204:207], v[28:31], v[136:139], 0
    ds_read_b64_tr_b16 a[34:35], v4 offset:34816
    s_waitcnt vmcnt(20)
    v_mfma_f32_16x16x32_bf16 v[192:195], v[32:35], v[140:143], v[192:195]
    buffer_load_dwordx4 v[172:175], v3, s[32:35], s73 offen offset:1024 sc1
    v_mfma_f32_16x16x32_bf16 v[196:199], v[36:39], v[140:143], v[196:199]
    ds_read_b64_tr_b16 a[36:37], v5 offset:32768
    ds_read_b64_tr_b16 a[38:39], v5 offset:34816
    v_mfma_f32_16x16x32_bf16 v[200:203], v[40:43], v[140:143], v[200:203]
    ds_read_b64_tr_b16 a[40:41], v6 offset:32768
    v_mfma_f32_16x16x32_bf16 v[204:207], v[44:47], v[140:143], v[204:207]
    ds_read_b64_tr_b16 a[42:43], v6 offset:34816
    s_waitcnt vmcnt(8)
    s_nop 0
    v_mfma_f32_16x16x32_bf16 v[192:195], v[48:51], v[144:147], v[192:195]
    buffer_load_dwordx4 v[112:115], v3, s[32:35], s74 offen offset:0 sc1
    v_mfma_f32_16x16x32_bf16 v[196:199], v[52:55], v[144:147], v[196:199]
    ds_read_b64_tr_b16 a[44:45], v7 offset:32768
    ds_read_b64_tr_b16 a[46:47], v7 offset:34816
    v_mfma_f32_16x16x32_bf16 v[200:203], v[56:59], v[144:147], v[200:203]
    ds_read_b64_tr_b16 a[48:49], v4 offset:36864
    v_mfma_f32_16x16x32_bf16 v[204:207], v[60:63], v[144:147], v[204:207]
    ds_read_b64_tr_b16 a[50:51], v4 offset:38912
    s_waitcnt vmcnt(8)
    s_nop 0
    v_mfma_f32_16x16x32_bf16 v[192:195], v[64:67], v[148:151], v[192:195]
    buffer_load_dwordx4 v[116:119], v3, s[32:35], s74 offen offset:1024 sc1
    v_mfma_f32_16x16x32_bf16 v[196:199], v[68:71], v[148:151], v[196:199]
    ds_read_b64_tr_b16 a[52:53], v5 offset:36864
    ds_read_b64_tr_b16 a[54:55], v5 offset:38912
    v_mfma_f32_16x16x32_bf16 v[200:203], v[72:75], v[148:151], v[200:203]
    ds_read_b64_tr_b16 a[56:57], v6 offset:36864
    v_mfma_f32_16x16x32_bf16 v[204:207], v[76:79], v[148:151], v[204:207]
    ds_read_b64_tr_b16 a[58:59], v6 offset:38912
    s_waitcnt vmcnt(8)
    s_nop 0
    v_mfma_f32_16x16x32_bf16 v[192:195], v[80:83], v[152:155], v[192:195]
    buffer_load_dwordx4 v[120:123], v3, s[32:35], s72 offen offset:2048 sc1
    v_mfma_f32_16x16x32_bf16 v[196:199], v[84:87], v[152:155], v[196:199]
    ds_read_b64_tr_b16 a[60:61], v7 offset:36864
    ds_read_b64_tr_b16 a[62:63], v7 offset:38912
    v_mfma_f32_16x16x32_bf16 v[200:203], v[88:91], v[152:155], v[200:203]
    s_waitcnt vmcnt(16)
    v_mfma_f32_16x16x32_bf16 v[204:207], v[92:95], v[152:155], v[204:207]
    ds_read_b64_tr_b16 a[64:65], v248 offset:0
    s_waitcnt vmcnt(8)
    v_mfma_f32_16x16x32_bf16 v[192:195], v[96:99], v[156:159], v[192:195]
    buffer_load_dwordx4 v[124:127], v3, s[32:35], s72 offen offset:3072 sc1
    v_mfma_f32_16x16x32_bf16 v[196:199], v[100:103], v[156:159], v[196:199]
    ds_read_b64_tr_b16 a[66:67], v248 offset:2048
    ds_read_b64_tr_b16 a[68:69], v249 offset:0
    v_mfma_f32_16x16x32_bf16 v[200:203], v[104:107], v[156:159], v[200:203]
    ds_read_b64_tr_b16 a[70:71], v249 offset:2048
    v_mfma_f32_16x16x32_bf16 v[204:207], v[108:111], v[156:159], v[204:207]
    ds_read_b64_tr_b16 a[72:73], v250 offset:0
    s_waitcnt vmcnt(8)
    s_nop 0
    v_mfma_f32_16x16x32_bf16 v[208:211], v[16:19], v[160:163], 0
    buffer_load_dwordx4 v[128:131], v3, s[32:35], s73 offen offset:2048 sc1
    v_mfma_f32_16x16x32_bf16 v[212:215], v[20:23], v[160:163], 0
    ds_read_b64_tr_b16 a[74:75], v250 offset:2048
    ds_read_b64_tr_b16 a[76:77], v251 offset:0
    v_mfma_f32_16x16x32_bf16 v[216:219], v[24:27], v[160:163], 0
    ds_read_b64_tr_b16 a[78:79], v251 offset:2048
    v_mfma_f32_16x16x32_bf16 v[220:223], v[28:31], v[160:163], 0
    ds_read_b64_tr_b16 a[80:81], v248 offset:4096
    s_waitcnt vmcnt(8)
    s_nop 0
    v_mfma_f32_16x16x32_bf16 v[208:211], v[32:35], v[164:167], v[208:211]
    buffer_load_dwordx4 v[132:135], v3, s[32:35], s73 offen offset:3072 sc1
    v_mfma_f32_16x16x32_bf16 v[212:215], v[36:39], v[164:167], v[212:215]
    ds_read_b64_tr_b16 a[82:83], v248 offset:6144
    ds_read_b64_tr_b16 a[84:85], v249 offset:4096
    v_mfma_f32_16x16x32_bf16 v[216:219], v[40:43], v[164:167], v[216:219]
    ds_read_b64_tr_b16 a[86:87], v249 offset:6144
    v_mfma_f32_16x16x32_bf16 v[220:223], v[44:47], v[164:167], v[220:223]
    ds_read_b64_tr_b16 a[88:89], v250 offset:4096
    buffer_load_dword v15, v2, s[32:35], s79 offen sc1
    s_waitcnt vmcnt(8)
    s_nop 0
    v_mfma_f32_16x16x32_bf16 v[208:211], v[48:51], v[168:171], v[208:211]
    buffer_load_dwordx4 v[136:139], v3, s[32:35], s74 offen offset:2048 sc1
    v_mfma_f32_16x16x32_bf16 v[212:215], v[52:55], v[168:171], v[212:215]
    ds_read_b64_tr_b16 a[90:91], v250 offset:6144
    ds_read_b64_tr_b16 a[92:93], v251 offset:4096
    v_mfma_f32_16x16x32_bf16 v[216:219], v[56:59], v[168:171], v[216:219]
    ds_read_b64_tr_b16 a[94:95], v251 offset:6144
    v_mfma_f32_16x16x32_bf16 v[220:223], v[60:63], v[168:171], v[220:223]
    s_waitcnt vmcnt(37)
    s_waitcnt vmcnt(8)
    v_mfma_f32_16x16x32_bf16 v[208:211], v[64:67], v[172:175], v[208:211]
    buffer_load_dwordx4 v[140:143], v3, s[32:35], s74 offen offset:3072 sc1
    v_mfma_f32_16x16x32_bf16 v[212:215], v[68:71], v[172:175], v[212:215]
    ds_read_b64_tr_b16 a[96:97], v4 offset:0
    ds_read_b64_tr_b16 a[98:99], v4 offset:2048
    v_mfma_f32_16x16x32_bf16 v[216:219], v[72:75], v[172:175], v[216:219]
    ds_read_b64_tr_b16 a[100:101], v5 offset:0
    v_mfma_f32_16x16x32_bf16 v[220:223], v[76:79], v[172:175], v[220:223]
    ds_read_b64_tr_b16 a[102:103], v5 offset:2048
    s_waitcnt vmcnt(8)
    s_nop 0
    v_mfma_f32_16x16x32_bf16 v[208:211], v[80:83], v[112:115], v[208:211]
    ds_read_b64_tr_b16 a[104:105], v6 offset:0
    v_mfma_f32_16x16x32_bf16 v[212:215], v[84:87], v[112:115], v[212:215]
    ds_read_b64_tr_b16 a[106:107], v6 offset:2048
    v_mfma_f32_16x16x32_bf16 v[216:219], v[88:91], v[112:115], v[216:219]
    ds_read_b64_tr_b16 a[108:109], v7 offset:0
    v_mfma_f32_16x16x32_bf16 v[220:223], v[92:95], v[112:115], v[220:223]
    ds_read_b64_tr_b16 a[110:111], v7 offset:2048
    s_waitcnt vmcnt(7)
    s_nop 0
    v_mfma_f32_16x16x32_bf16 v[208:211], v[96:99], v[116:119], v[208:211]
    ds_read_b64_tr_b16 a[112:113], v4 offset:4096
    v_mfma_f32_16x16x32_bf16 v[212:215], v[100:103], v[116:119], v[212:215]
    ds_read_b64_tr_b16 a[114:115], v4 offset:6144
    v_mfma_f32_16x16x32_bf16 v[216:219], v[104:107], v[116:119], v[216:219]
    ds_read_b64_tr_b16 a[116:117], v5 offset:4096
    v_mfma_f32_16x16x32_bf16 v[220:223], v[108:111], v[116:119], v[220:223]
    ds_read_b64_tr_b16 a[118:119], v5 offset:6144
    s_waitcnt vmcnt(6)
    s_nop 0
    v_mfma_f32_16x16x32_bf16 v[224:227], v[16:19], v[120:123], 0
    ds_read_b64_tr_b16 a[120:121], v6 offset:4096
    v_mfma_f32_16x16x32_bf16 v[228:231], v[20:23], v[120:123], 0
    ds_read_b64_tr_b16 a[122:123], v6 offset:6144
    ds_read_b64_tr_b16 a[124:125], v7 offset:4096
    v_mfma_f32_16x16x32_bf16 v[232:235], v[24:27], v[120:123], 0
    ds_read_b64_tr_b16 a[126:127], v7 offset:6144
    v_and_b32_e64 v11, 15, v0
    v_mfma_f32_16x16x32_bf16 v[236:239], v[28:31], v[120:123], 0
    v_mul_u32_u24 v10, 272, v11
    s_waitcnt vmcnt(5)
    v_mfma_f32_16x16x32_bf16 v[224:227], v[32:35], v[124:127], v[224:227]
    v_lshrrev_b32 v11, 4, v0
    v_lshl_add_u32 v10, v11, 4, v10
    v_mfma_f32_16x16x32_bf16 v[228:231], v[36:39], v[124:127], v[228:231]
    v_add_u32 v10, s89, v10
    v_add_u32 v9, 65536, v10
    s_lshr_b32 s80, s42, 1
    v_mfma_f32_16x16x32_bf16 v[232:235], v[40:43], v[124:127], v[232:235]
    s_and_b32 s81, s42, 1
    s_lshl_b32 s82, s80, 15
    v_mfma_f32_16x16x32_bf16 v[236:239], v[44:47], v[124:127], v[236:239]
    s_mul_i32 s83, s81, 2176
    s_add_u32 s82, s82, s83
    s_waitcnt vmcnt(2)
    v_cmp_ne_u32 vcc, s46, v15
    s_cbranch_vccz Lc_52
    s_mov_b32 s50, 0x40000
Lp_53:
    buffer_load_dword v15, v2, s[32:35], s79 offen sc1
    s_waitcnt vmcnt(0)
    v_cmp_ne_u32 vcc, s46, v15
    s_cbranch_vccz Lp_54
    s_sub_u32 s50, s50, 1
    s_cmp_lg_u32 s50, 0
    s_cbranch_scc1 Lp_53
Lp_54:
Lc_52:
    s_waitcnt vmcnt(4)
    v_mfma_f32_16x16x32_bf16 v[224:227], v[48:51], v[128:131], v[224:227]
    buffer_load_dwordx4 v[144:147], v253, s[32:35], s75 offen offset:0 sc1
    v_lshrrev_b32 v11, 3, v0
    v_mfma_f32_16x16x32_bf16 v[228:231], v[52:55], v[128:131], v[228:231]
    v_and_b32_e64 v8, 7, v0
    v_mul_u32_u24 v4, 272, v11
    v_lshl_add_u32 v4, v8, 5, v4
    v_mfma_f32_16x16x32_bf16 v[232:235], v[56:59], v[128:131], v[232:235]
    v_add_u32_e64 v4, s82, v4
    buffer_load_dwordx4 v[148:151], v253, s[32:35], s75 offen offset:1024 sc1
    v_mul_u32_u24 v6, 1792, v11
    v_mfma_f32_16x16x32_bf16 v[236:239], v[60:63], v[128:131], v[236:239]
    v_lshl_add_u32 v6, v8, 4, v6
    v_add_u32 v8, 65536, v4
    s_waitcnt vmcnt(5)
    v_mfma_f32_16x16x32_bf16 v[224:227], v[64:67], v[132:135], v[224:227]
    buffer_load_dwordx4 v[152:155], v253, s[32:35], s76 offen offset:0 sc1
    s_lshl_b32 s82, s80, 13
    v_mfma_f32_16x16x32_bf16 v[228:231], v[68:71], v[132:135], v[228:231]
    s_lshl_b32 s83, s81, 10
    s_add_u32 s82, s82, s83
    s_add_u32 s82, s82, 131072
    v_mfma_f32_16x16x32_bf16 v[232:235], v[72:75], v[132:135], v[232:235]
    buffer_load_dwordx4 v[156:159], v253, s[32:35], s76 offen offset:1024 sc1
    v_add_u32_e64 v11, s82, v253
    v_mfma_f32_16x16x32_bf16 v[236:239], v[76:79], v[132:135], v[236:239]
    s_add_u32 s82, s89, 131072
    v_add_u32 v5, s82, v253
    s_waitcnt vmcnt(5)
    v_mfma_f32_16x16x32_bf16 v[224:227], v[80:83], v[136:139], v[224:227]
    buffer_load_dwordx4 v[160:163], v253, s[32:35], s77 offen offset:0 sc1
    s_lshl_b32 s66, s40, 8
    v_mfma_f32_16x16x32_bf16 v[228:231], v[84:87], v[136:139], v[228:231]
    s_lshl_b32 s82, s43, 6
    s_add_u32 s66, s66, s82
    s_add_u32 s66, s66, s80
    v_mfma_f32_16x16x32_bf16 v[232:235], v[88:91], v[136:139], v[232:235]
    buffer_load_dwordx4 v[164:167], v253, s[32:35], s77 offen offset:1024 sc1
    s_lshl_b32 s81, s81, 4
    s_nop 0
    v_mfma_f32_16x16x32_bf16 v[236:239], v[92:95], v[136:139], v[236:239]
    s_add_u32 s66, s66, s81
    s_mul_i32 s66, s66, 896
    s_waitcnt vmcnt(6)
    v_mfma_f32_16x16x32_bf16 v[224:227], v[96:99], v[140:143], v[224:227]
    buffer_load_dwordx4 v[168:171], v253, s[32:35], s78 offen offset:0 sc1
    v_mfma_f32_16x16x32_bf16 v[228:231], v[100:103], v[140:143], v[228:231]
    s_lshl_b32 s80, s44, 7
    s_add_u32 s66, s66, s80
    v_mfma_f32_16x16x32_bf16 v[232:235], v[104:107], v[140:143], v[232:235]
    s_add_u32 s67, s66, 28672
    v_mfma_f32_16x16x32_bf16 v[236:239], v[108:111], v[140:143], v[236:239]
    buffer_load_dwordx4 v[172:175], v253, s[32:35], s78 offen offset:1024 sc1
    s_waitcnt lgkmcnt(0)
    ds_write_b128 v5, a[240:243] offset:0
    ds_write_b128 v5, a[244:247] offset:1024
    s_waitcnt vmcnt(7)
    v_mfma_f32_16x16x32_bf16 v[176:179], a[0:3], v[144:147], v[176:179]
    v_mfma_f32_16x16x32_bf16 v[180:183], a[4:7], v[144:147], v[180:183]
    buffer_load_dwordx4 v[112:115], v253, s[32:35], s75 offen offset:2048 sc1
    v_mfma_f32_16x16x32_bf16 v[184:187], a[8:11], v[144:147], v[184:187]
    v_mfma_f32_16x16x32_bf16 v[188:191], a[12:15], v[144:147], v[188:191]
    s_waitcnt vmcnt(7)
    v_mfma_f32_16x16x32_bf16 v[176:179], a[16:19], v[148:151], v[176:179]
    v_mfma_f32_16x16x32_bf16 v[180:183], a[20:23], v[148:151], v[180:183]
    buffer_load_dwordx4 v[116:119], v253, s[32:35], s75 offen offset:3072 sc1
    v_mfma_f32_16x16x32_bf16 v[184:187], a[24:27], v[148:151], v[184:187]
    v_mfma_f32_16x16x32_bf16 v[188:191], a[28:31], v[148:151], v[188:191]
    s_waitcnt vmcnt(7)
    v_mfma_f32_16x16x32_bf16 v[176:179], a[32:35], v[152:155], v[176:179]
    v_mfma_f32_16x16x32_bf16 v[180:183], a[36:39], v[152:155], v[180:183]
    buffer_load_dwordx4 v[120:123], v253, s[32:35], s76 offen offset:2048 sc1
    v_mfma_f32_16x16x32_bf16 v[184:187], a[40:43], v[152:155], v[184:187]
    v_mfma_f32_16x16x32_bf16 v[188:191], a[44:47], v[152:155], v[188:191]
    s_waitcnt vmcnt(7)
    v_mfma_f32_16x16x32_bf16 v[176:179], a[48:51], v[156:159], v[176:179]
    v_mfma_f32_16x16x32_bf16 v[180:183], a[52:55], v[156:159], v[180:183]
    buffer_load_dwordx4 v[124:127], v253, s[32:35], s76 offen offset:3072 sc1
    v_mfma_f32_16x16x32_bf16 v[184:187], a[56:59], v[156:159], v[184:187]
    v_mfma_f32_16x16x32_bf16 v[188:191], a[60:63], v[156:159], v[188:191]
    s_waitcnt vmcnt(7)
    v_mfma_f32_16x16x32_bf16 v[176:179], a[64:67], v[160:163], v[176:179]
    v_mfma_f32_16x16x32_bf16 v[180:183], a[68:71], v[160:163], v[180:183]
    buffer_load_dwordx4 v[128:131], v253, s[32:35], s77 offen offset:2048 sc1
    v_mfma_f32_16x16x32_bf16 v[184:187], a[72:75], v[160:163], v[184:187]
    v_mfma_f32_16x16x32_bf16 v[188:191], a[76:79], v[160:163], v[188:191]
    s_waitcnt vmcnt(7)
    v_mfma_f32_16x16x32_bf16 v[176:179], a[80:83], v[164:167], v[176:179]
    v_mfma_f32_16x16x32_bf16 v[180:183], a[84:87], v[164:167], v[180:183]
    buffer_load_dwordx4 v[132:135], v253, s[32:35], s77 offen offset:3072 sc1
    v_mfma_f32_16x16x32_bf16 v[184:187], a[88:91], v[164:167], v[184:187]
    v_mfma_f32_16x16x32_bf16 v[188:191], a[92:95], v[164:167], v[188:191]
    s_waitcnt vmcnt(7)
    v_mfma_f32_16x16x32_bf16 v[176:179], a[96:99], v[168:171], v[176:179]
    v_mfma_f32_16x16x32_bf16 v[180:183], a[100:103], v[168:171], v[180:183]
    buffer_load_dwordx4 v[136:139], v253, s[32:35], s78 offen offset:2048 sc1
    v_mfma_f32_16x16x32_bf16 v[184:187], a[104:107], v[168:171], v[184:187]
    v_mfma_f32_16x16x32_bf16 v[188:191], a[108:111], v[168:171], v[188:191]
    s_waitcnt vmcnt(7)
    v_mfma_f32_16x16x32_bf16 v[176:179], a[112:115], v[172:175], v[176:179]
    v_mfma_f32_16x16x32_bf16 v[180:183], a[116:119], v[172:175], v[180:183]
    buffer_load_dwordx4 v[140:143], v253, s[32:35], s78 offen offset:3072 sc1
    v_mfma_f32_16x16x32_bf16 v[184:187], a[120:123], v[172:175], v[184:187]
    v_mfma_f32_16x16x32_bf16 v[188:191], a[124:127], v[172:175], v[188:191]
    s_waitcnt vmcnt(7)
    v_mfma_f32_16x16x32_bf16 v[192:195], a[0:3], v[112:115], v[192:195]
    v_mfma_f32_16x16x32_bf16 v[196:199], a[4:7], v[112:115], v[196:199]
    buffer_load_dwordx4 v[144:147], v3, s[32:35], s75 offen offset:0 sc1
    v_mfma_f32_16x16x32_bf16 v[200:203], a[8:11], v[112:115], v[200:203]
    v_mfma_f32_16x16x32_bf16 v[204:207], a[12:15], v[112:115], v[204:207]
    s_waitcnt vmcnt(7)
    v_mfma_f32_16x16x32_bf16 v[192:195], a[16:19], v[116:119], v[192:195]
    v_mfma_f32_16x16x32_bf16 v[196:199], a[20:23], v[116:119], v[196:199]
    buffer_load_dwordx4 v[148:151], v3, s[32:35], s75 offen offset:1024 sc1
    v_mfma_f32_16x16x32_bf16 v[200:203], a[24:27], v[116:119], v[200:203]
    ds_write_b128 v10, v[176:179] offset:0
    v_mfma_f32_16x16x32_bf16 v[204:207], a[28:31], v[116:119], v[204:207]
    s_waitcnt vmcnt(7)
    v_mfma_f32_16x16x32_bf16 v[192:195], a[32:35], v[120:123], v[192:195]
    buffer_load_dwordx4 v[152:155], v3, s[32:35], s76 offen offset:0 sc1
    v_mfma_f32_16x16x32_bf16 v[196:199], a[36:39], v[120:123], v[196:199]
    ds_write_b128 v10, v[180:183] offset:64
    v_mfma_f32_16x16x32_bf16 v[200:203], a[40:43], v[120:123], v[200:203]
    ds_write_b128 v10, v[184:187] offset:128
    v_mfma_f32_16x16x32_bf16 v[204:207], a[44:47], v[120:123], v[204:207]
    s_waitcnt vmcnt(7)
    s_nop 0
    v_mfma_f32_16x16x32_bf16 v[192:195], a[48:51], v[124:127], v[192:195]
    v_mfma_f32_16x16x32_bf16 v[196:199], a[52:55], v[124:127], v[196:199]
    buffer_load_dwordx4 v[156:159], v3, s[32:35], s76 offen offset:1024 sc1
    v_mfma_f32_16x16x32_bf16 v[200:203], a[56:59], v[124:127], v[200:203]
    ds_write_b128 v10, v[188:191] offset:192
    v_mfma_f32_16x16x32_bf16 v[204:207], a[60:63], v[124:127], v[204:207]
    s_waitcnt vmcnt(7)
    v_mfma_f32_16x16x32_bf16 v[192:195], a[64:67], v[128:131], v[192:195]
    v_mfma_f32_16x16x32_bf16 v[196:199], a[68:71], v[128:131], v[196:199]
    buffer_load_dwordx4 v[160:163], v3, s[32:35], s77 offen offset:0 sc1
    v_mfma_f32_16x16x32_bf16 v[200:203], a[72:75], v[128:131], v[200:203]
    v_mfma_f32_16x16x32_bf16 v[204:207], a[76:79], v[128:131], v[204:207]
    s_waitcnt vmcnt(7)
    v_mfma_f32_16x16x32_bf16 v[192:195], a[80:83], v[132:135], v[192:195]
    v_mfma_f32_16x16x32_bf16 v[196:199], a[84:87], v[132:135], v[196:199]
    buffer_load_dwordx4 v[164:167], v3, s[32:35], s77 offen offset:1024 sc1
    v_mfma_f32_16x16x32_bf16 v[200:203], a[88:91], v[132:135], v[200:203]
    v_mfma_f32_16x16x32_bf16 v[204:207], a[92:95], v[132:135], v[204:207]
    s_waitcnt vmcnt(7)
    v_mfma_f32_16x16x32_bf16 v[192:195], a[96:99], v[136:139], v[192:195]
    v_mfma_f32_16x16x32_bf16 v[196:199], a[100:103], v[136:139], v[196:199]
    buffer_load_dwordx4 v[168:171], v3, s[32:35], s78 offen offset:0 sc1
    v_mfma_f32_16x16x32_bf16 v[200:203], a[104:107], v[136:139], v[200:203]
    v_mfma_f32_16x16x32_bf16 v[204:207], a[108:111], v[136:139], v[204:207]
    s_waitcnt vmcnt(7)
    v_mfma_f32_16x16x32_bf16 v[192:195], a[112:115], v[140:143], v[192:195]
    v_mfma_f32_16x16x32_bf16 v[196:199], a[116:119], v[140:143], v[196:199]
    buffer_load_dwordx4 v[172:175], v3, s[32:35], s78 offen offset:1024 sc1
    v_mfma_f32_16x16x32_bf16 v[200:203], a[120:123], v[140:143], v[200:203]
    v_mfma_f32_16x16x32_bf16 v[204:207], a[124:127], v[140:143], v[204:207]
    s_waitcnt vmcnt(7)
    v_mfma_f32_16x16x32_bf16 v[208:211], a[0:3], v[144:147], v[208:211]
    v_mfma_f32_16x16x32_bf16 v[212:215], a[4:7], v[144:147], v[212:215]
    buffer_load_dwordx4 v[112:115], v3, s[32:35], s75 offen offset:2048 sc1
    v_mfma_f32_16x16x32_bf16 v[216:219], a[8:11], v[144:147], v[216:219]
    v_mfma_f32_16x16x32_bf16 v[220:223], a[12:15], v[144:147], v[220:223]
    s_waitcnt vmcnt(7)
    v_mfma_f32_16x16x32_bf16 v[208:211], a[16:19], v[148:151], v[208:211]
    v_mfma_f32_16x16x32_bf16 v[212:215], a[20:23], v[148:151], v[212:215]
    buffer_load_dwordx4 v[116:119], v3, s[32:35], s75 offen offset:3072 sc1
    v_mfma_f32_16x16x32_bf16 v[216:219], a[24:27], v[148:151], v[216:219]
    ds_write_b128 v10, v[192:195] offset:32768
    v_mfma_f32_16x16x32_bf16 v[220:223], a[28:31], v[148:151], v[220:223]
    s_waitcnt vmcnt(7)
    s_nop 0
    v_mfma_f32_16x16x32_bf16 v[208:211], a[32:35], v[152:155], v[208:211]
    buffer_load_dwordx4 v[120:123], v3, s[32:35], s76 offen offset:2048 sc1
    v_mfma_f32_16x16x32_bf16 v[212:215], a[36:39], v[152:155], v[212:215]
    ds_write_b128 v10, v[196:199] offset:32832
    v_mfma_f32_16x16x32_bf16 v[216:219], a[40:43], v[152:155], v[216:219]
    ds_write_b128 v10, v[200:203] offset:32896
    v_mfma_f32_16x16x32_bf16 v[220:223], a[44:47], v[152:155], v[220:223]
    s_waitcnt vmcnt(7)
    v_mfma_f32_16x16x32_bf16 v[208:211], a[48:51], v[156:159], v[208:211]
    v_mfma_f32_16x16x32_bf16 v[212:215], a[52:55], v[156:159], v[212:215]
    buffer_load_dwordx4 v[124:127], v3, s[32:35], s76 offen offset:3072 sc1
    v_mfma_f32_16x16x32_bf16 v[216:219], a[56:59], v[156:159], v[216:219]
    ds_write_b128 v10, v[204:207] offset:32960
    v_mfma_f32_16x16x32_bf16 v[220:223], a[60:63], v[156:159], v[220:223]
    s_waitcnt vmcnt(7)
    v_mfma_f32_16x16x32_bf16 v[208:211], a[64:67], v[160:163], v[208:211]
    buffer_load_dwordx4 v[128:131], v3, s[32:35], s77 offen offset:2048 sc1
    v_mfma_f32_16x16x32_bf16 v[212:215], a[68:71], v[160:163], v[212:215]
    s_waitcnt lgkmcnt(0)
    s_barrier
    v_mfma_f32_16x16x32_bf16 v[216:219], a[72:75], v[160:163], v[216:219]
    ds_read_b128 v[240:243], v11 offset:0
    ds_read_b128 v[244:247], v11 offset:16384
    v_mfma_f32_16x16x32_bf16 v[220:223], a[76:79], v[160:163], v[220:223]
    ds_read_b128 v[40:43], v4 offset:0
    s_waitcnt vmcnt(7)
    v_mfma_f32_16x16x32_bf16 v[208:211], a[80:83], v[164:167], v[208:211]
    buffer_load_dwordx4 v[132:135], v3, s[32:35], s77 offen offset:3072 sc1
    s_cmp_lg_u32 s42, 0
    s_cbranch_scc1 L_55
    s_lshl_b32 s50, s41, 2
    s_add_u32 s50, s50, 7168
    s_mov_b64 exec, 1
    buffer_store_dword v252, off, s[32:35], s50
    s_mov_b64 exec, -1
L_55:
    v_mfma_f32_16x16x32_bf16 v[212:215], a[84:87], v[164:167], v[212:215]
    ds_read_b128 v[44:47], v4 offset:16
    ds_read_b128 v[48:51], v4 offset:8192
    v_mfma_f32_16x16x32_bf16 v[216:219], a[88:91], v[164:167], v[216:219]
    ds_read_b128 v[52:55], v4 offset:8208
    ds_read_b128 v[56:59], v4 offset:16384
    v_mfma_f32_16x16x32_bf16 v[220:223], a[92:95], v[164:167], v[220:223]
    ds_read_b128 v[60:63], v4 offset:16400
    ds_read_b128 v[64:67], v4 offset:24576
    s_waitcnt vmcnt(7)
    s_nop 0
    v_mfma_f32_16x16x32_bf16 v[208:211], a[96:99], v[168:171], v[208:211]
    buffer_load_dwordx4 v[136:139], v3, s[32:35], s78 offen offset:2048 sc1
    ds_read_b128 v[68:71], v4 offset:24592
    v_mfma_f32_16x16x32_bf16 v[212:215], a[100:103], v[168:171], v[212:215]
    s_waitcnt lgkmcnt(8)
    v_lshlrev_b32 v16, 16, v240
    v_mfma_f32_16x16x32_bf16 v[216:219], a[104:107], v[168:171], v[216:219]
    v_and_b32 v17, s61, v240
    v_lshlrev_b32 v18, 16, v241
    v_mfma_f32_16x16x32_bf16 v[220:223], a[108:111], v[168:171], v[220:223]
    v_and_b32 v19, s61, v241
    s_waitcnt vmcnt(7)
    v_mfma_f32_16x16x32_bf16 v[208:211], a[112:115], v[172:175], v[208:211]
    buffer_load_dwordx4 v[140:143], v3, s[32:35], s78 offen offset:3072 sc1
    v_lshlrev_b32_e64 v20, 16, v242
    v_mfma_f32_16x16x32_bf16 v[212:215], a[116:119], v[172:175], v[212:215]
    v_and_b32 v21, s61, v242
    v_lshlrev_b32 v22, 16, v243
    v_mfma_f32_16x16x32_bf16 v[216:219], a[120:123], v[172:175], v[216:219]
    v_and_b32 v23, s61, v243
    v_lshlrev_b32 v24, 16, v244
    v_mfma_f32_16x16x32_bf16 v[220:223], a[124:127], v[172:175], v[220:223]
    v_and_b32 v25, s61, v244
    s_waitcnt vmcnt(7)
    v_mfma_f32_16x16x32_bf16 v[224:227], a[0:3], v[112:115], v[224:227]
    v_lshlrev_b32_e64 v26, 16, v245
    v_mfma_f32_16x16x32_bf16 v[228:231], a[4:7], v[112:115], v[228:231]
    v_and_b32 v27, s61, v245
    v_lshlrev_b32 v28, 16, v246
    v_mfma_f32_16x16x32_bf16 v[232:235], a[8:11], v[112:115], v[232:235]
    v_and_b32 v29, s61, v246
    v_lshlrev_b32 v30, 16, v247
    v_mfma_f32_16x16x32_bf16 v[236:239], a[12:15], v[112:115], v[236:239]
    v_and_b32 v31, s61, v247
    s_waitcnt vmcnt(6)
    v_mfma_f32_16x16x32_bf16 v[224:227], a[16:19], v[116:119], v[224:227]
    s_waitcnt lgkmcnt(6)
    v_add_f32 v16, v16, v40
    v_mfma_f32_16x16x32_bf16 v[228:231], a[20:23], v[116:119], v[228:231]
    v_add_f32_e64 v17, v17, v41
    ds_write_b128 v9, v[208:211] offset:0
    v_mfma_f32_16x16x32_bf16 v[232:235], a[24:27], v[116:119], v[232:235]
    v_add_f32 v18, v18, v42
    v_add_f32 v19, v19, v43
    v_mfma_f32_16x16x32_bf16 v[236:239], a[28:31], v[116:119], v[236:239]
    v_add_f32 v20, v20, v44
    s_waitcnt vmcnt(5)
    v_mfma_f32_16x16x32_bf16 v[224:227], a[32:35], v[120:123], v[224:227]
    ds_write_b128 v9, v[212:215] offset:64
    v_add_f32_e64 v21, v21, v45
    v_mfma_f32_16x16x32_bf16 v[228:231], a[36:39], v[120:123], v[228:231]
    v_add_f32 v22, v22, v46
    v_add_f32 v23, v23, v47
    v_mfma_f32_16x16x32_bf16 v[232:235], a[40:43], v[120:123], v[232:235]
    ds_write_b128 v9, v[216:219] offset:128
    s_waitcnt lgkmcnt(7)
    v_mfma_f32_16x16x32_bf16 v[236:239], a[44:47], v[120:123], v[236:239]
    v_add_f32 v16, v16, v48
    v_add_f32 v17, v17, v49
    s_waitcnt vmcnt(4)
    v_mfma_f32_16x16x32_bf16 v[224:227], a[48:51], v[124:127], v[224:227]
    ds_write_b128 v9, v[220:223] offset:192
    v_add_f32_e64 v18, v18, v50
    v_mfma_f32_16x16x32_bf16 v[228:231], a[52:55], v[124:127], v[228:231]
    v_add_f32 v19, v19, v51
    v_add_f32 v20, v20, v52
    v_mfma_f32_16x16x32_bf16 v[232:235], a[56:59], v[124:127], v[232:235]
    v_add_f32 v21, v21, v53
    v_add_f32 v22, v22, v54
    v_mfma_f32_16x16x32_bf16 v[236:239], a[60:63], v[124:127], v[236:239]
    v_add_f32 v23, v23, v55
    s_waitcnt vmcnt(3)
    v_mfma_f32_16x16x32_bf16 v[224:227], a[64:67], v[128:131], v[224:227]
    s_waitcnt lgkmcnt(6)
    v_mfma_f32_16x16x32_bf16 v[228:231], a[68:71], v[128:131], v[228:231]
    v_add_f32 v16, v16, v56
    v_add_f32_e64 v17, v17, v57
    v_mfma_f32_16x16x32_bf16 v[232:235], a[72:75], v[128:131], v[232:235]
    v_add_f32 v18, v18, v58
    v_add_f32 v19, v19, v59
    v_mfma_f32_16x16x32_bf16 v[236:239], a[76:79], v[128:131], v[236:239]
    v_add_f32 v20, v20, v60
    s_waitcnt vmcnt(2)
    v_mfma_f32_16x16x32_bf16 v[224:227], a[80:83], v[132:135], v[224:227]
    v_add_f32_e64 v21, v21, v61
    v_mfma_f32_16x16x32_bf16 v[228:231], a[84:87], v[132:135], v[228:231]
    v_add_f32 v22, v22, v62
    v_add_f32 v23, v23, v63
    v_mfma_f32_16x16x32_bf16 v[232:235], a[88:91], v[132:135], v[232:235]
    s_waitcnt lgkmcnt(4)
    v_add_f32 v16, v16, v64
    v_mfma_f32_16x16x32_bf16 v[236:239], a[92:95], v[132:135], v[236:239]
    v_add_f32 v17, v17, v65
    s_waitcnt vmcnt(1)
    v_mfma_f32_16x16x32_bf16 v[224:227], a[96:99], v[136:139], v[224:227]
    v_add_f32_e64 v18, v18, v66
    v_mfma_f32_16x16x32_bf16 v[228:231], a[100:103], v[136:139], v[228:231]
    v_add_f32 v19, v19, v67
    v_add_f32 v20, v20, v68
    v_mfma_f32_16x16x32_bf16 v[232:235], a[104:107], v[136:139], v[232:235]
    v_add_f32 v21, v21, v69
    v_add_f32 v22, v22, v70
    v_mfma_f32_16x16x32_bf16 v[236:239], a[108:111], v[136:139], v[236:239]
    v_add_f32 v23, v23, v71
    s_waitcnt vmcnt(0)
    v_mfma_f32_16x16x32_bf16 v[224:227], a[112:115], v[140:143], v[224:227]
    v_cvt_pk_bf16_f32 v32, v16, v17
    v_mfma_f32_16x16x32_bf16 v[228:231], a[116:119], v[140:143], v[228:231]
    v_cvt_pk_bf16_f32 v33, v18, v19
    v_cvt_pk_bf16_f32 v34, v20, v21
    v_mfma_f32_16x16x32_bf16 v[232:235], a[120:123], v[140:143], v[232:235]
    v_cvt_pk_bf16_f32 v35, v22, v23
    v_mfma_f32_16x16x32_bf16 v[236:239], a[124:127], v[140:143], v[236:239]
    buffer_store_dwordx4 v[32:35], v6, s[28:31], s66 offen sc1
    ds_write_b128 v9, v[224:227] offset:32768
    s_nop 0
    s_nop 0
    ds_write_b128 v9, v[228:231] offset:32832
    s_nop 1
    ds_write_b128 v9, v[232:235] offset:32896
    s_nop 0
    ds_write_b128 v9, v[236:239] offset:32960
    s_waitcnt lgkmcnt(0)
    s_barrier
    ds_read_b128 v[72:75], v8 offset:0
    ds_read_b128 v[76:79], v8 offset:16
    ds_read_b128 v[80:83], v8 offset:8192
    ds_read_b128 v[84:87], v8 offset:8208
    ds_read_b128 v[88:91], v8 offset:16384
    ds_read_b128 v[92:95], v8 offset:16400
    ds_read_b128 v[96:99], v8 offset:24576
    ds_read_b128 v[100:103], v8 offset:24592
    s_waitcnt lgkmcnt(6)
    v_pk_add_f32 v[24:25], v[24:25], v[72:73]
    v_pk_add_f32 v[26:27], v[26:27], v[74:75]
    v_pk_add_f32 v[28:29], v[28:29], v[76:77]
    v_pk_add_f32 v[30:31], v[30:31], v[78:79]
    s_waitcnt lgkmcnt(4)
    v_pk_add_f32 v[24:25], v[24:25], v[80:81]
    v_pk_add_f32 v[26:27], v[26:27], v[82:83]
    v_pk_add_f32 v[28:29], v[28:29], v[84:85]
    v_pk_add_f32 v[30:31], v[30:31], v[86:87]
    s_waitcnt lgkmcnt(2)
    v_pk_add_f32 v[24:25], v[24:25], v[88:89]
    v_pk_add_f32 v[26:27], v[26:27], v[90:91]
    v_pk_add_f32 v[28:29], v[28:29], v[92:93]
    v_pk_add_f32 v[30:31], v[30:31], v[94:95]
    s_waitcnt lgkmcnt(0)
    v_pk_add_f32 v[24:25], v[24:25], v[96:97]
    v_pk_add_f32 v[26:27], v[26:27], v[98:99]
    v_pk_add_f32 v[28:29], v[28:29], v[100:101]
    v_pk_add_f32 v[30:31], v[30:31], v[102:103]
    v_cvt_pk_bf16_f32 v36, v24, v25
    v_cvt_pk_bf16_f32 v37, v26, v27
    v_cvt_pk_bf16_f32 v38, v28, v29
    v_cvt_pk_bf16_f32 v39, v30, v31
    buffer_store_dwordx4 v[36:39], v6, s[28:31], s67 offen sc1
    s_branch L_fin
L_bserv:
    s_waitcnt vmcnt(0)
    s_barrier
    v_lshlrev_b32 v168, 7, v0
    s_lshl_b32 s66, s40, 3
    s_add_u32 s66, s66, s78
    s_mul_i32 s66, s66, 25088
    s_add_u32 s66, s66, 128
    v_lshlrev_b32_e64 v169, 8, v0
    buffer_load_dword a255, v169, s[20:23], s66 offen sc1
    s_add_u32 s66, s66, 8704
    buffer_load_dword a255, v169, s[20:23], s66 offen sc1
    s_lshl_b32 s66, s40, 4
    s_add_u32 s66, s66, s80
    s_mul_i32 s66, s66, 12544
    buffer_load_dword a255, v168, s[24:27], s66 offen sc1
    s_add_u32 s66, s66, 4352
    buffer_load_dword a255, v168, s[24:27], s66 offen sc1
    s_lshr_b32 s66, s80, 2
    s_mul_i32 s66, s66, 401408
    s_and_b32 s67, s80, 3
    s_mul_i32 s67, s67, 14336
    s_add_u32 s66, s66, s67
    s_bfe_u32 s67, s80, 0x10002
    s_xor_b32 s67, s67, 0
    s_min_u32 s67, s67, 6
    s_mul_i32 s67, s67, 57344
    s_add_u32 s66, s66, s67
    buffer_load_dword a255, v168, s[24:27], s66 offen sc1
    s_add_u32 s66, s66, 6144
    buffer_load_dword a255, v168, s[24:27], s66 offen sc1
    s_lshr_b32 s66, s80, 2
    s_mul_i32 s66, s66, 401408
    s_and_b32 s67, s80, 3
    s_mul_i32 s67, s67, 14336
    s_add_u32 s66, s66, s67
    s_bfe_u32 s67, s80, 0x10002
    s_xor_b32 s67, s67, 2
    s_min_u32 s67, s67, 6
    s_mul_i32 s67, s67, 57344
    s_add_u32 s66, s66, s67
    buffer_load_dword a255, v168, s[24:27], s66 offen sc1
    s_add_u32 s66, s66, 6144
    buffer_load_dword a255, v168, s[24:27], s66 offen sc1
    s_lshr_b32 s66, s80, 2
    s_mul_i32 s66, s66, 401408
    s_and_b32 s67, s80, 3
    s_mul_i32 s67, s67, 14336
    s_add_u32 s66, s66, s67
    s_bfe_u32 s67, s80, 0x10002
    s_xor_b32 s67, s67, 4
    s_min_u32 s67, s67, 6
    s_mul_i32 s67, s67, 57344
    s_add_u32 s66, s66, s67
    buffer_load_dword a255, v168, s[24:27], s66 offen sc1
    s_add_u32 s66, s66, 6144
    buffer_load_dword a255, v168, s[24:27], s66 offen sc1
    s_add_u32 s66, s78, 32
    s_cmp_ge_u32 s66, 28
    s_cselect_b32 s67, 1605504, 0
    s_mul_i32 s66, s66, 57344
    s_sub_u32 s66, s66, s67
    v_lshlrev_b32 v169, 8, v0
    buffer_load_dword a255, v169, s[20:23], s66 offen sc1
    s_add_u32 s66, s66, 16384
    buffer_load_dword a255, v169, s[20:23], s66 offen sc1
    s_add_u32 s66, s66, 16384
    buffer_load_dword a255, v169, s[20:23], s66 offen sc1
    s_add_u32 s66, s66, 8192
    buffer_load_dword a255, v169, s[20:23], s66 offen sc1
    s_cmp_eq_u32 s45, 0
    s_cbranch_scc1 L_56
    s_mul_i32 s66, s80, 14336
    s_add_u32 s66, s66, 65536
    buffer_load_dword a255, v168, s[32:35], s66 offen sc1
    s_add_u32 s66, s66, 6144
    buffer_load_dword a255, v168, s[32:35], s66 offen sc1
L_56:
    s_add_u32 s66, s78, 40
    s_cmp_ge_u32 s66, 28
    s_cselect_b32 s67, 1605504, 0
    s_mul_i32 s66, s66, 57344
    s_sub_u32 s66, s66, s67
    v_lshlrev_b32 v169, 8, v0
    buffer_load_dword a255, v169, s[20:23], s66 offen sc1
    s_add_u32 s66, s66, 16384
    buffer_load_dword a255, v169, s[20:23], s66 offen sc1
    s_add_u32 s66, s66, 16384
    buffer_load_dword a255, v169, s[20:23], s66 offen sc1
    s_add_u32 s66, s66, 8192
    buffer_load_dword a255, v169, s[20:23], s66 offen sc1
    s_lshr_b32 s66, s80, 2
    s_mul_i32 s66, s66, 401408
    s_and_b32 s67, s80, 3
    s_mul_i32 s67, s67, 14336
    s_add_u32 s66, s66, s67
    s_bfe_u32 s67, s80, 0x10002
    s_xor_b32 s67, s67, 1
    s_min_u32 s67, s67, 6
    s_mul_i32 s67, s67, 57344
    s_add_u32 s66, s66, s67
    buffer_load_dword a255, v168, s[24:27], s66 offen sc1
    s_add_u32 s66, s66, 6144
    buffer_load_dword a255, v168, s[24:27], s66 offen sc1
    s_lshr_b32 s66, s80, 2
    s_mul_i32 s66, s66, 401408
    s_and_b32 s67, s80, 3
    s_mul_i32 s67, s67, 14336
    s_add_u32 s66, s66, s67
    s_bfe_u32 s67, s80, 0x10002
    s_xor_b32 s67, s67, 3
    s_min_u32 s67, s67, 6
    s_mul_i32 s67, s67, 57344
    s_add_u32 s66, s66, s67
    buffer_load_dword a255, v168, s[24:27], s66 offen sc1
    s_add_u32 s66, s66, 6144
    buffer_load_dword a255, v168, s[24:27], s66 offen sc1
    s_lshr_b32 s66, s80, 2
    s_mul_i32 s66, s66, 401408
    s_and_b32 s67, s80, 3
    s_mul_i32 s67, s67, 14336
    s_add_u32 s66, s66, s67
    s_bfe_u32 s67, s80, 0x10002
    s_xor_b32 s67, s67, 5
    s_min_u32 s67, s67, 6
    s_mul_i32 s67, s67, 57344
    s_add_u32 s66, s66, s67
    buffer_load_dword a255, v168, s[24:27], s66 offen sc1
    s_add_u32 s66, s66, 6144
    buffer_load_dword a255, v168, s[24:27], s66 offen sc1
    s_lshr_b32 s66, s80, 2
    s_mul_i32 s66, s66, 401408
    s_and_b32 s67, s80, 3
    s_mul_i32 s67, s67, 14336
    s_add_u32 s66, s66, s67
    s_bfe_u32 s67, s80, 0x10002
    s_xor_b32 s67, s67, 6
    s_min_u32 s67, s67, 6
    s_mul_i32 s67, s67, 57344
    s_add_u32 s66, s66, s67
    buffer_load_dword a255, v168, s[24:27], s66 offen sc1
    s_add_u32 s66, s66, 6144
    buffer_load_dword a255, v168, s[24:27], s66 offen sc1
    s_cmp_lg_u32 s80, 0
    s_cbranch_scc1 L_fin
    s_cmp_eq_u32 s45, 0
    s_cbranch_scc1 L_fin
    v_min_u32 v169, 27, v0
    v_lshlrev_b32 v169, 2, v169
    s_mov_b32 s66, 7168
    s_mov_b32 s50, 0x40000
Lp_57:
    buffer_load_dword v15, v169, s[32:35], s66 offen sc1
    s_waitcnt vmcnt(0)
    v_cmp_ne_u32 vcc, s46, v15
    s_cbranch_vccz Lp_58
    s_sleep 2
    s_sub_u32 s50, s50, 1
    s_cmp_lg_u32 s50, 0
    s_cbranch_scc1 Lp_57
Lp_58:
    buffer_wbl2 sc1
L_fin:
L_end:
    s_endpgm
.section .rodata,"a"
.p2align 6
.amdhsa_kernel sequential_preLN__sliding_local_dilated__glu_gated_reglu__prompt_kernel
  .amdhsa_next_free_vgpr 512
  .amdhsa_next_free_sgpr 102
  .amdhsa_accum_offset 256
  .amdhsa_group_segment_fixed_size 0
  .amdhsa_kernarg_size 80
  .amdhsa_user_sgpr_count 2
  .amdhsa_user_sgpr_kernarg_segment_ptr 1
  .amdhsa_system_sgpr_workgroup_id_x 1
.end_amdhsa_kernel
```
